```python
import torch

def _softmax(x, axis=-1):
    return torch.softmax(x, dim=axis)
def _gelu(x):
    return torch.nn.functional.gelu(x, approximate="tanh")
def _silu(x):
    return torch.nn.functional.silu(x)
def _sigmoid(x):
    return torch.sigmoid(x)
def _layernorm(x, axis=-1, eps=1e-5):
    m = x.mean(dim=axis, keepdim=True)
    v = x.var(dim=axis, keepdim=True, unbiased=False)
    return (x - m) / torch.sqrt(v + eps)
def _scatter_add(tgt, idx, src, axis=0):
    return tgt.clone().index_add_(axis, idx, src)
def _segment_sum(src, seg, n):
    out = torch.zeros((n,) + src.shape[1:], dtype=src.dtype)
    return out.index_add_(0, seg, src)
def _pad(x, pw):
    flat = tuple(v for pair in reversed(pw) for v in pair)
    return torch.nn.functional.pad(x, flat)

kernel_name = 'interleave_layers__grouped_kv_mqa__sliding_local_dilated__prompt'

def setup_inputs():

    _w = (lambda a: (lambda t: t.to(torch.bfloat16) if t.is_floating_point() else t)(torch.as_tensor(a)))
    def _A_setup():
        B, S, D, H = 1, 2048, 512, 32
        Dh = D // H
        return {
            "x": _w((lambda *s: torch.randn(*s, dtype=torch.bfloat16) * 0.05)(B, S, D)),
            "wq": _w((lambda *s: torch.randn(*s, dtype=torch.bfloat16) * 0.05)(D, H * Dh)),
            "wk": _w((lambda *s: torch.randn(*s, dtype=torch.bfloat16) * 0.05)(D, Dh)),
            "wv": _w((lambda *s: torch.randn(*s, dtype=torch.bfloat16) * 0.05)(D, Dh)),
            "wo": _w((lambda *s: torch.randn(*s, dtype=torch.bfloat16) * 0.05)(H * Dh, D)),
        }
    _A_in = _A_setup()

    def _B_setup():
        B, S, D = 1, 2048, 512
        return {
            "x": _w((lambda *s: torch.randn(*s, dtype=torch.bfloat16) * 0.05)(B, S, D)),
            "wqkv": _w((lambda *s: torch.randn(*s, dtype=torch.bfloat16) * 0.05)(D, 3 * D)),
            "wo": _w((lambda *s: torch.randn(*s, dtype=torch.bfloat16) * 0.05)(D, D)),
        }
    _B_in = _B_setup()

    return {
        "A_x": _A_in["x"],
        "A_wq": _A_in["wq"],
        "A_wk": _A_in["wk"],
        "A_wv": _A_in["wv"],
        "A_wo": _A_in["wo"],
        "B_x": _B_in["x"],
        "B_wqkv": _B_in["wqkv"],
        "B_wo": _B_in["wo"],
    }

def reference(A_x, A_wq, A_wk, A_wv, A_wo, B_x, B_wqkv, B_wo):
    def _A_ref(x, wq, wk, wv, wo):
        B, S, D = x.shape
        H = 32
        Dh = D // H
        q = (lambda x, *d: x.permute(*d))((x @ wq).reshape(B, S, H, Dh), 0, 2, 1, 3)
        k = x @ wk
        v = x @ wv
        scores = torch.einsum("bhqd,bkd->bhqk", q, k) * (Dh ** -0.5)
        p = _softmax(scores, axis=-1)
        o = torch.einsum("bhqk,bkd->bhqd", p, v)
        return (lambda x, *d: x.permute(*d))(o, 0, 2, 1, 3).reshape(B, S, H * Dh) @ wo

    def _B_ref(x, wqkv, wo):
        B, S, D = x.shape
        H = 32; Dh = D // H
        W, dil = 8, 2
        qkv = (lambda x, *d: x.permute(*d))((x @ wqkv).reshape(B, S, 3, H, Dh), 2, 0, 3, 1, 4)
        q, k, v = qkv[0], qkv[1], qkv[2]
        scale = Dh ** -0.5
        pos = torch.arange(S)
        off = torch.arange(W) * dil
        idx = pos[:, None] - off[None, :]
        mask = idx >= 0
        idx_c = torch.where(mask, idx, 0).reshape(-1)
        kg = k[:, :, idx_c, :].reshape(B, H, S, W, Dh)
        vg = v[:, :, idx_c, :].reshape(B, H, S, W, Dh)
        logits = torch.einsum("bhsd,bhswd->bhsw", q, kg) * scale
        logits = torch.where(mask[None, None, :, :], logits, -1e9)
        attn = _softmax(logits, axis=-1)
        o = torch.einsum("bhsw,bhswd->bhsd", attn, vg)
        return (lambda x, *d: x.permute(*d))(o, 0, 2, 1, 3).reshape(B, S, D) @ wo

    x = A_x
    x = x + _A_ref(_layernorm(x, axis=-1), A_wq, A_wk, A_wv, A_wo)
    x = x + _B_ref(_layernorm(x, axis=-1), B_wqkv, B_wo)
    x = x + _A_ref(_layernorm(x, axis=-1), A_wq, A_wk, A_wv, A_wo)
    x = x + _B_ref(_layernorm(x, axis=-1), B_wqkv, B_wo)
    return x
```

```asm
; @launch grid=(256,1,1) block=(256,1,1) lds=163840
.amdgcn_target "amdgcn-amd-amdhsa--gfx950"
.text
.globl interleave_layers__grouped_kv_mqa__sliding_local_dilated__prompt_kernel
.p2align 8
.type interleave_layers__grouped_kv_mqa__sliding_local_dilated__prompt_kernel,@function
interleave_layers__grouped_kv_mqa__sliding_local_dilated__prompt_kernel:
  s_cmp_ge_u32 s2, 256
  s_cbranch_scc1 L_END
  s_load_dwordx16 s[64:79], s[0:1], 0
  s_getpc_b64 s[40:41]
L_PFBASE:
  s_mov_b32 s86, s40
  s_mov_b32 s87, s41
  s_lshr_b32 s42, s2, 3
  s_mul_i32 s42, s42, 3072
  s_add_u32 s43, s42, 3072
  s_cmp_gt_u32 s43, L_CODE_END-L_PFBASE
  s_cbranch_scc1 PF_1
  s_add_u32 s40, s40, s42
  s_addc_u32 s41, s41, 0
  v_and_b32 v250, 63, v0
  v_lshrrev_b32 v251, 6, v0
  v_lshlrev_b32 v250, 4, v250
  v_min_u32 v251, 2, v251
  v_lshl_add_u32 v250, v251, 10, v250
  global_load_dwordx4 v[252:255], v250, s[40:41]
PF_1:
  s_load_dwordx4 s[80:83], s[0:1], 64
  s_load_dwordx2 s[84:85], s[0:1], 80
  v_and_b32 v1, 63, v0
  v_lshrrev_b32 v14, 6, v0
  v_lshlrev_b32 v2, 4, v1
  v_lshlrev_b32 v3, 2, v1
  v_readfirstlane_b32 s18, v14
  s_and_b32 s40, s2, 7
  s_lshr_b32 s41, s2, 3
  s_and_b32 s42, s41, 3
  s_lshl_b32 s16, s40, 2
  s_add_u32 s16, s16, s42
  s_lshr_b32 s17, s41, 2
  s_and_b32 s19, s18, 1
  s_lshr_b32 s20, s18, 1
  s_max_u32 s23, s16, 1
  s_sub_u32 s23, s23, 1
  s_lshl_b32 s26, s16, 1
  s_add_u32 s26, s26, s19
  s_lshl_b32 s27, s17, 1
  s_add_u32 s27, s27, s20
  s_lshl_b32 s24, s26, 15
  s_lshl_b32 s40, s27, 11
  s_add_u32 s24, s24, s40
  s_lshl_b32 s25, s26, 12
  s_lshl_b32 s40, s27, 8
  s_add_u32 s25, s25, s40
  v_and_b32 v14, 31, v1
  v_lshrrev_b32 v15, 5, v1
  v_lshlrev_b32 v12, 3, v14
  v_lshl_add_u32 v12, v15, 2, v12
  s_lshl_b32 s40, s19, 4
  s_sub_u32 s40, s40, 16
  v_add_u32 v13, s40, v1
  v_lshlrev_b32 v13, 4, v13
  s_waitcnt lgkmcnt(0)
  s_mov_b32 s4, s84
  s_mov_b32 s5, s85
  s_mov_b32 s6, 268435456
  s_mov_b32 s7, 0x20000
  s_mov_b32 s12, s80
  s_mov_b32 s13, s81
  s_mov_b32 s14, 2097152
  s_mov_b32 s15, 0x20000
  s_mov_b32 s22, 0
  s_getreg_b32 s3, hwreg(HW_REG_XCC_ID)
  s_and_b32 s3, s3, 15
  s_mov_b32 s39, 0
  s_lshl_b32 s40, s22, 22
  s_add_u32 s28, s40, 5242880
  s_add_u32 s29, s28, 0x200000
  s_add_u32 s30, s28, 0x400000
  s_lshl_b32 s40, s22, 19
  s_add_u32 s31, s40, 24117248
  s_add_u32 s32, s31, 0x40000
  s_add_u32 s33, s31, 0x80000
  s_lshl_b32 s40, s22, 21
  s_add_u32 s34, s40, 13631488
  s_add_u32 s35, s40, 17825792
  s_lshl_b32 s40, s22, 20
  s_add_u32 s36, s40, 22020096
  s_lshl_b32 s40, s22, 18
  s_add_u32 s37, s40, 25165824
  s_lshl_b32 s40, s22, 14
  s_add_u32 s38, s40, 65536
  s_lshl_b32 s40, s22, 18
  s_add_u32 s53, s40, 27262976
  s_mov_b32 s88, s66
  s_mov_b32 s89, s67
  s_mov_b32 s90, s68
  s_mov_b32 s91, s69
  s_mov_b32 s92, s70
  s_mov_b32 s93, s71
  s_mov_b32 s94, s72
  s_mov_b32 s95, s73
  s_mov_b32 s96, s76
  s_mov_b32 s97, s77
  s_mov_b32 s98, s78
  s_mov_b32 s99, s79
  s_mov_b32 s8, s64
  s_mov_b32 s9, s65
  s_mov_b32 s10, 2097152
  s_mov_b32 s11, 0x20000
  s_mov_b32 s68, s88
  s_mov_b32 s69, s89
  s_mov_b32 s70, 524288
  s_mov_b32 s71, 0x20000
  v_mov_b32 v230, 0
  buffer_load_dword v231, v230, s[4:7], 0 offen sc0 sc1
  v_lshrrev_b32 v233, 3, v1
  v_lshlrev_b32 v233, 10, v233
  v_and_b32 v234, 7, v1
  v_lshl_add_u32 v233, v234, 4, v233
  s_sub_u32 s57, s17, 2
  s_lshl_b32 s57, s57, 5
  s_add_u32 s57, s57, s16
  s_cmp_lt_u32 s17, 2
  s_cselect_b32 s57, 255, s57
  s_cmp_ge_u32 s17, 2
  s_cbranch_scc1 FNK_2
  s_mov_b32 s72, s92
  s_mov_b32 s73, s93
  s_mov_b32 s74, 16384
  s_mov_b32 s75, 0x20000
  s_lshl_b32 s40, s18, 12
  s_add_u32 s41, s40, 131072
  s_mov_b32 m0, s41
  s_nop 0
  buffer_load_dwordx4 v2, s[72:75], s40 offen offset:0 lds
  buffer_load_dwordx4 v2, s[72:75], s40 offen offset:1024 lds
  buffer_load_dwordx4 v2, s[72:75], s40 offen offset:2048 lds
  buffer_load_dwordx4 v2, s[72:75], s40 offen offset:3072 lds
  s_mov_b32 s72, s90
  s_mov_b32 s73, s91
  s_mov_b32 s74, 16384
  s_mov_b32 s75, 0x20000
  s_lshl_b32 s40, s18, 12
  s_add_u32 s41, s40, 147456
  s_mov_b32 m0, s41
  s_nop 0
  buffer_load_dwordx4 v2, s[72:75], s40 offen offset:0 lds
  buffer_load_dwordx4 v2, s[72:75], s40 offen offset:1024 lds
  buffer_load_dwordx4 v2, s[72:75], s40 offen offset:2048 lds
  buffer_load_dwordx4 v2, s[72:75], s40 offen offset:3072 lds
  s_lshl_b32 s46, s18, 3
  s_lshl_b32 s76, s46, 1
  s_add_u32 s76, s76, s17
  s_lshl_b32 s44, s16, 6
  s_add_u32 s76, s76, s44
  s_lshl_b32 s76, s76, 10
  s_lshl_b32 s77, s17, 5
  s_add_u32 s77, s77, s46
  s_lshl_b32 s77, s77, 10
  s_and_b32 s78, s46, 15
  s_mul_i32 s79, s17, 1
  s_and_b32 s79, s79, 7
  s_add_u32 s45, s78, s79
  s_lshl_b32 s45, s45, 4
  s_lshl_b32 s43, s79, 11
  s_add_u32 s43, s43, s76
  s_lshl_b32 s44, s79, 10
  s_add_u32 s44, s44, s77
  v_xor_b32 v232, s45, v2
  s_mov_b32 m0, s44
  s_nop 0
  buffer_load_dwordx4 v232, s[8:11], s43 offen lds
  s_add_u32 s79, s79, 1
  s_and_b32 s79, s79, 7
  s_add_u32 s45, s78, s79
  s_lshl_b32 s45, s45, 4
  s_lshl_b32 s43, s79, 11
  s_add_u32 s43, s43, s76
  s_lshl_b32 s44, s79, 10
  s_add_u32 s44, s44, s77
  v_xor_b32 v232, s45, v2
  s_mov_b32 m0, s44
  s_nop 0
  buffer_load_dwordx4 v232, s[8:11], s43 offen lds
  s_add_u32 s79, s79, 1
  s_and_b32 s79, s79, 7
  s_add_u32 s45, s78, s79
  s_lshl_b32 s45, s45, 4
  s_lshl_b32 s43, s79, 11
  s_add_u32 s43, s43, s76
  s_lshl_b32 s44, s79, 10
  s_add_u32 s44, s44, s77
  v_xor_b32 v232, s45, v2
  s_mov_b32 m0, s44
  s_nop 0
  buffer_load_dwordx4 v232, s[8:11], s43 offen lds
  s_add_u32 s79, s79, 1
  s_and_b32 s79, s79, 7
  s_add_u32 s45, s78, s79
  s_lshl_b32 s45, s45, 4
  s_lshl_b32 s43, s79, 11
  s_add_u32 s43, s43, s76
  s_lshl_b32 s44, s79, 10
  s_add_u32 s44, s44, s77
  v_xor_b32 v232, s45, v2
  s_mov_b32 m0, s44
  s_nop 0
  buffer_load_dwordx4 v232, s[8:11], s43 offen lds
  s_add_u32 s79, s79, 1
  s_and_b32 s79, s79, 7
  s_add_u32 s45, s78, s79
  s_lshl_b32 s45, s45, 4
  s_lshl_b32 s43, s79, 11
  s_add_u32 s43, s43, s76
  s_lshl_b32 s44, s79, 10
  s_add_u32 s44, s44, s77
  v_xor_b32 v232, s45, v2
  s_mov_b32 m0, s44
  s_nop 0
  buffer_load_dwordx4 v232, s[8:11], s43 offen lds
  s_add_u32 s79, s79, 1
  s_and_b32 s79, s79, 7
  s_add_u32 s45, s78, s79
  s_lshl_b32 s45, s45, 4
  s_lshl_b32 s43, s79, 11
  s_add_u32 s43, s43, s76
  s_lshl_b32 s44, s79, 10
  s_add_u32 s44, s44, s77
  v_xor_b32 v232, s45, v2
  s_mov_b32 m0, s44
  s_nop 0
  buffer_load_dwordx4 v232, s[8:11], s43 offen lds
  s_add_u32 s79, s79, 1
  s_and_b32 s79, s79, 7
  s_add_u32 s45, s78, s79
  s_lshl_b32 s45, s45, 4
  s_lshl_b32 s43, s79, 11
  s_add_u32 s43, s43, s76
  s_lshl_b32 s44, s79, 10
  s_add_u32 s44, s44, s77
  v_xor_b32 v232, s45, v2
  s_mov_b32 m0, s44
  s_nop 0
  buffer_load_dwordx4 v232, s[8:11], s43 offen lds
  s_add_u32 s79, s79, 1
  s_and_b32 s79, s79, 7
  s_add_u32 s45, s78, s79
  s_lshl_b32 s45, s45, 4
  s_lshl_b32 s43, s79, 11
  s_add_u32 s43, s43, s76
  s_lshl_b32 s44, s79, 10
  s_add_u32 s44, s44, s77
  v_xor_b32 v232, s45, v2
  s_mov_b32 m0, s44
  s_nop 0
  buffer_load_dwordx4 v232, s[8:11], s43 offen lds
  s_add_u32 s79, s79, 1
  s_and_b32 s79, s79, 7
  s_branch FCOM_3
FNK_2:
  s_cmp_ge_u32 s57, 97
  s_cbranch_scc1 FNP_5
  s_cmp_eq_u32 s57, 16
  s_cbranch_scc1 FKVB_7
  s_mov_b32 s72, s88
  s_mov_b32 s73, s89
  s_mov_b32 s74, 524288
  s_mov_b32 s59, 1024
  s_lshl_b32 s60, s57, 6
  s_cmp_lt_u32 s57, 16
  s_cbranch_scc1 FGO_6
  s_mov_b32 s72, s94
  s_mov_b32 s73, s95
  s_sub_u32 s60, s57, 17
  s_lshl_b32 s60, s60, 6
  s_cmp_lt_u32 s57, 33
  s_cbranch_scc1 FGO_6
  s_mov_b32 s72, s96
  s_mov_b32 s73, s97
  s_mov_b32 s74, 1572864
  s_mov_b32 s59, 3072
  s_sub_u32 s60, s57, 33
  s_lshl_b32 s60, s60, 6
  s_cmp_lt_u32 s57, 81
  s_cbranch_scc1 FGO_6
  s_mov_b32 s72, s98
  s_mov_b32 s73, s99
  s_mov_b32 s74, 524288
  s_mov_b32 s59, 1024
  s_sub_u32 s60, s57, 81
  s_lshl_b32 s60, s60, 6
FGO_6:
  s_mov_b32 s75, 0x20000
  v_lshrrev_b32 v235, 2, v1
  v_mul_lo_u32 v235, v235, s59
  v_and_b32 v236, 3, v1
  v_lshl_add_u32 v235, v236, 4, v235
  s_lshl_b32 s40, s18, 7
  s_mul_i32 s40, s40, s59
  s_add_u32 s40, s40, s60
  s_lshl_b32 s41, s59, 4
  buffer_load_dwordx4 a[0:3], v235, s[72:75], s40 offen
  s_add_u32 s40, s40, s41
  buffer_load_dwordx4 a[4:7], v235, s[72:75], s40 offen
  s_add_u32 s40, s40, s41
  buffer_load_dwordx4 a[8:11], v235, s[72:75], s40 offen
  s_add_u32 s40, s40, s41
  buffer_load_dwordx4 a[12:15], v235, s[72:75], s40 offen
  s_add_u32 s40, s40, s41
  buffer_load_dwordx4 a[16:19], v235, s[72:75], s40 offen
  s_add_u32 s40, s40, s41
  buffer_load_dwordx4 a[20:23], v235, s[72:75], s40 offen
  s_add_u32 s40, s40, s41
  buffer_load_dwordx4 a[24:27], v235, s[72:75], s40 offen
  s_add_u32 s40, s40, s41
  buffer_load_dwordx4 a[28:31], v235, s[72:75], s40 offen
  s_branch FNP_5
FKVB_7:
  v_lshrrev_b32 v235, 2, v1
  v_lshlrev_b32 v235, 5, v235
  v_and_b32 v236, 1, v1
  v_lshl_add_u32 v235, v236, 4, v235
  s_lshl_b32 s40, s18, 12
  v_and_b32 v236, 2, v1
  v_cmp_eq_u32 vcc, 0, v236
  s_mov_b32 s72, s92
  s_mov_b32 s73, s93
  s_mov_b32 s74, 16384
  s_mov_b32 s75, 0x20000
  s_mov_b64 s[48:49], vcc
  s_mov_b64 exec, s[48:49]
  buffer_load_dwordx4 a[0:3], v235, s[72:75], s40 offen offset:0
  buffer_load_dwordx4 a[4:7], v235, s[72:75], s40 offen offset:512
  buffer_load_dwordx4 a[8:11], v235, s[72:75], s40 offen offset:1024
  buffer_load_dwordx4 a[12:15], v235, s[72:75], s40 offen offset:1536
  buffer_load_dwordx4 a[16:19], v235, s[72:75], s40 offen offset:2048
  buffer_load_dwordx4 a[20:23], v235, s[72:75], s40 offen offset:2560
  buffer_load_dwordx4 a[24:27], v235, s[72:75], s40 offen offset:3072
  buffer_load_dwordx4 a[28:31], v235, s[72:75], s40 offen offset:3584
  s_mov_b64 exec, -1
  s_andn2_b64 exec, exec, s[48:49]
  s_mov_b32 s72, s90
  s_mov_b32 s73, s91
  s_mov_b32 s74, 16384
  s_mov_b32 s75, 0x20000
  buffer_load_dwordx4 a[0:3], v235, s[72:75], s40 offen offset:0
  buffer_load_dwordx4 a[4:7], v235, s[72:75], s40 offen offset:512
  buffer_load_dwordx4 a[8:11], v235, s[72:75], s40 offen offset:1024
  buffer_load_dwordx4 a[12:15], v235, s[72:75], s40 offen offset:1536
  buffer_load_dwordx4 a[16:19], v235, s[72:75], s40 offen offset:2048
  buffer_load_dwordx4 a[20:23], v235, s[72:75], s40 offen offset:2560
  buffer_load_dwordx4 a[24:27], v235, s[72:75], s40 offen offset:3072
  buffer_load_dwordx4 a[28:31], v235, s[72:75], s40 offen offset:3584
  s_mov_b64 exec, -1
FNP_5:
  s_lshl_b32 s46, s18, 7
  s_lshl_b32 s64, s46, 10
  s_lshl_b32 s44, s17, 7
  s_add_u32 s64, s64, s44
  s_lshl_b32 s65, s46, 7
  s_add_u32 s65, s65, 65536
  s_and_b32 s66, s16, 3
  s_mul_i32 s66, s66, 4
  s_lshl_b32 s44, s66, 10
  s_add_u32 s44, s44, s65
  s_mov_b32 m0, s44
  s_lshl_b32 s43, s66, 13
  s_add_u32 s43, s43, s64
  buffer_load_dwordx4 v233, s[68:71], s43 offen lds
  s_add_u32 s66, s66, 1
  s_and_b32 s66, s66, 15
  s_lshl_b32 s44, s66, 10
  s_add_u32 s44, s44, s65
  s_mov_b32 m0, s44
  s_lshl_b32 s43, s66, 13
  s_add_u32 s43, s43, s64
  buffer_load_dwordx4 v233, s[68:71], s43 offen lds
  s_add_u32 s66, s66, 1
  s_and_b32 s66, s66, 15
  s_lshl_b32 s44, s66, 10
  s_add_u32 s44, s44, s65
  s_mov_b32 m0, s44
  s_lshl_b32 s43, s66, 13
  s_add_u32 s43, s43, s64
  buffer_load_dwordx4 v233, s[68:71], s43 offen lds
  s_add_u32 s66, s66, 1
  s_and_b32 s66, s66, 15
  s_lshl_b32 s44, s66, 10
  s_add_u32 s44, s44, s65
  s_mov_b32 m0, s44
  s_lshl_b32 s43, s66, 13
  s_add_u32 s43, s43, s64
  buffer_load_dwordx4 v233, s[68:71], s43 offen lds
  s_add_u32 s66, s66, 1
  s_and_b32 s66, s66, 15
  s_lshr_b32 s47, s18, 1
  s_and_b32 s46, s18, 1
  s_lshl_b32 s46, s46, 4
  s_lshl_b32 s76, s46, 1
  s_add_u32 s76, s76, s47
  s_lshl_b32 s44, s16, 6
  s_add_u32 s76, s76, s44
  s_lshl_b32 s76, s76, 10
  s_lshl_b32 s77, s47, 5
  s_add_u32 s77, s77, s46
  s_lshl_b32 s77, s77, 10
  s_and_b32 s78, s46, 15
  s_mul_i32 s79, s17, 2
  s_and_b32 s79, s79, 15
  s_add_u32 s45, s78, s79
  s_lshl_b32 s45, s45, 4
  s_lshl_b32 s43, s79, 11
  s_add_u32 s43, s43, s76
  s_lshl_b32 s44, s79, 10
  s_add_u32 s44, s44, s77
  v_xor_b32 v232, s45, v2
  s_mov_b32 m0, s44
  s_nop 0
  buffer_load_dwordx4 v232, s[8:11], s43 offen lds
  s_add_u32 s79, s79, 1
  s_and_b32 s79, s79, 15
  s_add_u32 s45, s78, s79
  s_lshl_b32 s45, s45, 4
  s_lshl_b32 s43, s79, 11
  s_add_u32 s43, s43, s76
  s_lshl_b32 s44, s79, 10
  s_add_u32 s44, s44, s77
  v_xor_b32 v232, s45, v2
  s_mov_b32 m0, s44
  s_nop 0
  buffer_load_dwordx4 v232, s[8:11], s43 offen lds
  s_add_u32 s79, s79, 1
  s_and_b32 s79, s79, 15
  s_waitcnt vmcnt(0)
  s_add_u32 s45, s78, s79
  s_lshl_b32 s45, s45, 4
  s_lshl_b32 s43, s79, 11
  s_add_u32 s43, s43, s76
  s_lshl_b32 s44, s79, 10
  s_add_u32 s44, s44, s77
  v_xor_b32 v232, s45, v2
  s_mov_b32 m0, s44
  s_nop 0
  buffer_load_dwordx4 v232, s[8:11], s43 offen lds
  s_add_u32 s79, s79, 1
  s_and_b32 s79, s79, 15
  s_add_u32 s45, s78, s79
  s_lshl_b32 s45, s45, 4
  s_lshl_b32 s43, s79, 11
  s_add_u32 s43, s43, s76
  s_lshl_b32 s44, s79, 10
  s_add_u32 s44, s44, s77
  v_xor_b32 v232, s45, v2
  s_mov_b32 m0, s44
  s_nop 0
  buffer_load_dwordx4 v232, s[8:11], s43 offen lds
  s_add_u32 s79, s79, 1
  s_and_b32 s79, s79, 15
  s_add_u32 s45, s78, s79
  s_lshl_b32 s45, s45, 4
  s_lshl_b32 s43, s79, 11
  s_add_u32 s43, s43, s76
  s_lshl_b32 s44, s79, 10
  s_add_u32 s44, s44, s77
  v_xor_b32 v232, s45, v2
  s_mov_b32 m0, s44
  s_nop 0
  buffer_load_dwordx4 v232, s[8:11], s43 offen lds
  s_add_u32 s79, s79, 1
  s_and_b32 s79, s79, 15
  s_add_u32 s45, s78, s79
  s_lshl_b32 s45, s45, 4
  s_lshl_b32 s43, s79, 11
  s_add_u32 s43, s43, s76
  s_lshl_b32 s44, s79, 10
  s_add_u32 s44, s44, s77
  v_xor_b32 v232, s45, v2
  s_mov_b32 m0, s44
  s_nop 0
  buffer_load_dwordx4 v232, s[8:11], s43 offen lds
  s_add_u32 s79, s79, 1
  s_and_b32 s79, s79, 15
  s_add_u32 s45, s78, s79
  s_lshl_b32 s45, s45, 4
  s_lshl_b32 s43, s79, 11
  s_add_u32 s43, s43, s76
  s_lshl_b32 s44, s79, 10
  s_add_u32 s44, s44, s77
  v_xor_b32 v232, s45, v2
  s_mov_b32 m0, s44
  s_nop 0
  buffer_load_dwordx4 v232, s[8:11], s43 offen lds
  s_add_u32 s79, s79, 1
  s_and_b32 s79, s79, 15
  s_add_u32 s45, s78, s79
  s_lshl_b32 s45, s45, 4
  s_lshl_b32 s43, s79, 11
  s_add_u32 s43, s43, s76
  s_lshl_b32 s44, s79, 10
  s_add_u32 s44, s44, s77
  v_xor_b32 v232, s45, v2
  s_mov_b32 m0, s44
  s_nop 0
  buffer_load_dwordx4 v232, s[8:11], s43 offen lds
  s_add_u32 s79, s79, 1
  s_and_b32 s79, s79, 15
  s_add_u32 s45, s78, s79
  s_lshl_b32 s45, s45, 4
  s_lshl_b32 s43, s79, 11
  s_add_u32 s43, s43, s76
  s_lshl_b32 s44, s79, 10
  s_add_u32 s44, s44, s77
  v_xor_b32 v232, s45, v2
  s_mov_b32 m0, s44
  s_nop 0
  buffer_load_dwordx4 v232, s[8:11], s43 offen lds
  s_add_u32 s79, s79, 1
  s_and_b32 s79, s79, 15
  s_add_u32 s45, s78, s79
  s_lshl_b32 s45, s45, 4
  s_lshl_b32 s43, s79, 11
  s_add_u32 s43, s43, s76
  s_lshl_b32 s44, s79, 10
  s_add_u32 s44, s44, s77
  v_xor_b32 v232, s45, v2
  s_mov_b32 m0, s44
  s_nop 0
  buffer_load_dwordx4 v232, s[8:11], s43 offen lds
  s_add_u32 s79, s79, 1
  s_and_b32 s79, s79, 15
  s_add_u32 s45, s78, s79
  s_lshl_b32 s45, s45, 4
  s_lshl_b32 s43, s79, 11
  s_add_u32 s43, s43, s76
  s_lshl_b32 s44, s79, 10
  s_add_u32 s44, s44, s77
  v_xor_b32 v232, s45, v2
  s_mov_b32 m0, s44
  s_nop 0
  buffer_load_dwordx4 v232, s[8:11], s43 offen lds
  s_add_u32 s79, s79, 1
  s_and_b32 s79, s79, 15
  s_add_u32 s45, s78, s79
  s_lshl_b32 s45, s45, 4
  s_lshl_b32 s43, s79, 11
  s_add_u32 s43, s43, s76
  s_lshl_b32 s44, s79, 10
  s_add_u32 s44, s44, s77
  v_xor_b32 v232, s45, v2
  s_mov_b32 m0, s44
  s_nop 0
  buffer_load_dwordx4 v232, s[8:11], s43 offen lds
  s_add_u32 s79, s79, 1
  s_and_b32 s79, s79, 15
  s_add_u32 s45, s78, s79
  s_lshl_b32 s45, s45, 4
  s_lshl_b32 s43, s79, 11
  s_add_u32 s43, s43, s76
  s_lshl_b32 s44, s79, 10
  s_add_u32 s44, s44, s77
  v_xor_b32 v232, s45, v2
  s_mov_b32 m0, s44
  s_nop 0
  buffer_load_dwordx4 v232, s[8:11], s43 offen lds
  s_add_u32 s79, s79, 1
  s_and_b32 s79, s79, 15
  s_add_u32 s45, s78, s79
  s_lshl_b32 s45, s45, 4
  s_lshl_b32 s43, s79, 11
  s_add_u32 s43, s43, s76
  s_lshl_b32 s44, s79, 10
  s_add_u32 s44, s44, s77
  v_xor_b32 v232, s45, v2
  s_mov_b32 m0, s44
  s_nop 0
  buffer_load_dwordx4 v232, s[8:11], s43 offen lds
  s_add_u32 s79, s79, 1
  s_and_b32 s79, s79, 15
  s_add_u32 s45, s78, s79
  s_lshl_b32 s45, s45, 4
  s_lshl_b32 s43, s79, 11
  s_add_u32 s43, s43, s76
  s_lshl_b32 s44, s79, 10
  s_add_u32 s44, s44, s77
  v_xor_b32 v232, s45, v2
  s_mov_b32 m0, s44
  s_nop 0
  buffer_load_dwordx4 v232, s[8:11], s43 offen lds
  s_add_u32 s79, s79, 1
  s_and_b32 s79, s79, 15
  s_add_u32 s45, s78, s79
  s_lshl_b32 s45, s45, 4
  s_lshl_b32 s43, s79, 11
  s_add_u32 s43, s43, s76
  s_lshl_b32 s44, s79, 10
  s_add_u32 s44, s44, s77
  v_xor_b32 v232, s45, v2
  s_mov_b32 m0, s44
  s_nop 0
  buffer_load_dwordx4 v232, s[8:11], s43 offen lds
  s_add_u32 s79, s79, 1
  s_and_b32 s79, s79, 15
  s_lshl_b32 s44, s66, 10
  s_add_u32 s44, s44, s65
  s_mov_b32 m0, s44
  s_lshl_b32 s43, s66, 13
  s_add_u32 s43, s43, s64
  buffer_load_dwordx4 v233, s[68:71], s43 offen lds
  s_add_u32 s66, s66, 1
  s_and_b32 s66, s66, 15
  s_lshl_b32 s44, s66, 10
  s_add_u32 s44, s44, s65
  s_mov_b32 m0, s44
  s_lshl_b32 s43, s66, 13
  s_add_u32 s43, s43, s64
  buffer_load_dwordx4 v233, s[68:71], s43 offen lds
  s_add_u32 s66, s66, 1
  s_and_b32 s66, s66, 15
  s_lshl_b32 s44, s66, 10
  s_add_u32 s44, s44, s65
  s_mov_b32 m0, s44
  s_lshl_b32 s43, s66, 13
  s_add_u32 s43, s43, s64
  buffer_load_dwordx4 v233, s[68:71], s43 offen lds
  s_add_u32 s66, s66, 1
  s_and_b32 s66, s66, 15
  s_lshl_b32 s44, s66, 10
  s_add_u32 s44, s44, s65
  s_mov_b32 m0, s44
  s_lshl_b32 s43, s66, 13
  s_add_u32 s43, s43, s64
  buffer_load_dwordx4 v233, s[68:71], s43 offen lds
  s_add_u32 s66, s66, 1
  s_and_b32 s66, s66, 15
  s_lshl_b32 s44, s66, 10
  s_add_u32 s44, s44, s65
  s_mov_b32 m0, s44
  s_lshl_b32 s43, s66, 13
  s_add_u32 s43, s43, s64
  buffer_load_dwordx4 v233, s[68:71], s43 offen lds
  s_add_u32 s66, s66, 1
  s_and_b32 s66, s66, 15
  s_lshl_b32 s44, s66, 10
  s_add_u32 s44, s44, s65
  s_mov_b32 m0, s44
  s_lshl_b32 s43, s66, 13
  s_add_u32 s43, s43, s64
  buffer_load_dwordx4 v233, s[68:71], s43 offen lds
  s_add_u32 s66, s66, 1
  s_and_b32 s66, s66, 15
  s_lshl_b32 s44, s66, 10
  s_add_u32 s44, s44, s65
  s_mov_b32 m0, s44
  s_lshl_b32 s43, s66, 13
  s_add_u32 s43, s43, s64
  buffer_load_dwordx4 v233, s[68:71], s43 offen lds
  s_add_u32 s66, s66, 1
  s_and_b32 s66, s66, 15
  s_lshl_b32 s44, s66, 10
  s_add_u32 s44, s44, s65
  s_mov_b32 m0, s44
  s_lshl_b32 s43, s66, 13
  s_add_u32 s43, s43, s64
  buffer_load_dwordx4 v233, s[68:71], s43 offen lds
  s_add_u32 s66, s66, 1
  s_and_b32 s66, s66, 15
  s_lshl_b32 s44, s66, 10
  s_add_u32 s44, s44, s65
  s_mov_b32 m0, s44
  s_lshl_b32 s43, s66, 13
  s_add_u32 s43, s43, s64
  buffer_load_dwordx4 v233, s[68:71], s43 offen lds
  s_add_u32 s66, s66, 1
  s_and_b32 s66, s66, 15
  s_lshl_b32 s44, s66, 10
  s_add_u32 s44, s44, s65
  s_mov_b32 m0, s44
  s_lshl_b32 s43, s66, 13
  s_add_u32 s43, s43, s64
  buffer_load_dwordx4 v233, s[68:71], s43 offen lds
  s_add_u32 s66, s66, 1
  s_and_b32 s66, s66, 15
  s_lshl_b32 s44, s66, 10
  s_add_u32 s44, s44, s65
  s_mov_b32 m0, s44
  s_lshl_b32 s43, s66, 13
  s_add_u32 s43, s43, s64
  buffer_load_dwordx4 v233, s[68:71], s43 offen lds
  s_add_u32 s66, s66, 1
  s_and_b32 s66, s66, 15
  s_lshl_b32 s44, s66, 10
  s_add_u32 s44, s44, s65
  s_mov_b32 m0, s44
  s_lshl_b32 s43, s66, 13
  s_add_u32 s43, s43, s64
  buffer_load_dwordx4 v233, s[68:71], s43 offen lds
  s_add_u32 s66, s66, 1
  s_and_b32 s66, s66, 15
FCOM_3:
  v_and_b32 v16, 31, v1
  v_lshlrev_b32 v16, 11, v16
  v_lshrrev_b32 v17, 5, v1
  v_lshl_add_u32 v16, v17, 3, v16
  s_lshl_b32 s40, s16, 6
  s_add_u32 s40, s40, s19
  s_lshl_b32 s40, s40, 10
  s_lshl_b32 s41, s27, 6
  s_add_u32 s40, s40, s41
  buffer_load_dwordx2 v[4:5], v16, s[8:11], s40 offen offset:0
  buffer_load_dwordx2 v[6:7], v16, s[8:11], s40 offen offset:16
  buffer_load_dwordx2 v[8:9], v16, s[8:11], s40 offen offset:32
  buffer_load_dwordx2 v[10:11], v16, s[8:11], s40 offen offset:48
  v_and_b32 v16, 31, v1
  v_lshrrev_b32 v17, 5, v1
  v_and_b32 v18, 15, v16
  v_lshlrev_b32 v19, 10, v16
  s_lshl_b32 s40, s19, 15
  s_lshl_b32 s41, s20, 9
  s_add_u32 s40, s40, s41
  v_add_u32 v19, s40, v19
  v_add_u32 v20, 0, v17
  v_xor_b32 v20, v20, v18
  v_lshl_add_u32 v240, v20, 4, v19
  v_add_u32 v20, 2, v17
  v_xor_b32 v20, v20, v18
  v_lshl_add_u32 v241, v20, 4, v19
  v_add_u32 v20, 4, v17
  v_xor_b32 v20, v20, v18
  v_lshl_add_u32 v242, v20, 4, v19
  v_add_u32 v20, 6, v17
  v_xor_b32 v20, v20, v18
  v_lshl_add_u32 v243, v20, 4, v19
  v_add_u32 v20, 8, v17
  v_xor_b32 v20, v20, v18
  v_lshl_add_u32 v244, v20, 4, v19
  v_add_u32 v20, 10, v17
  v_xor_b32 v20, v20, v18
  v_lshl_add_u32 v245, v20, 4, v19
  v_add_u32 v20, 12, v17
  v_xor_b32 v20, v20, v18
  v_lshl_add_u32 v246, v20, 4, v19
  v_add_u32 v20, 14, v17
  v_xor_b32 v20, v20, v18
  v_lshl_add_u32 v247, v20, 4, v19
  v_and_b32 v18, 15, v1
  v_lshrrev_b32 v20, 2, v18
  v_lshl_add_u32 v20, v17, 3, v20
  v_lshlrev_b32 v21, 7, v20
  v_bfe_u32 v22, v1, 4, 1
  v_lshl_add_u32 v21, v22, 5, v21
  v_and_b32 v23, 3, v18
  v_lshl_add_u32 v21, v23, 3, v21
  s_lshl_b32 s40, s20, 15
  s_add_u32 s40, s40, 65536
  s_lshl_b32 s41, s20, 6
  s_add_u32 s42, s40, s41
  v_add_u32 v248, s42, v21
  s_xor_b32 s41, s41, 64
  s_add_u32 s42, s40, s41
  v_add_u32 v249, s42, v21
  v_lshlrev_b32 v21, 5, v20
  v_lshl_add_u32 v21, v22, 14, v21
  v_lshl_add_u32 v21, v23, 3, v21
  s_lshl_b32 s40, s20, 13
  s_add_u32 s40, s40, 131072
  v_add_u32 v250, s40, v21
  s_cmp_ge_u32 s17, 2
  s_cbranch_scc1 FNKW_9
  s_cmp_eq_u32 s19, s17
  s_cbranch_scc1 FKVP_8
  s_waitcnt vmcnt(4)
  v_readfirstlane_b32 s21, v231
  s_nop 1
  s_mul_i32 s21, s21, 0x9E3779B1
  s_add_u32 s21, s21, 0x7F4A7C15
  s_cmp_lg_u32 s18, 0
  s_cbranch_scc1 XW_14
  s_add_u32 s40, s21, s3
  s_add_u32 s40, s40, 16
  v_mov_b32 v14, s40
  s_lshl_b32 s41, s16, 3
  s_add_u32 s41, s41, s17
  s_lshl_b32 s41, s41, 2
  s_add_u32 s41, s41, 114688
  v_mov_b32 v15, 0
  s_mov_b64 exec, 1
  buffer_store_dword v14, v15, s[4:7], s41 offen sc1
  s_mov_b64 exec, -1
XW_14:
  s_barrier
  s_xor_b32 s47, s17, 1
  s_lshl_b32 s46, s20, 4
  s_lshl_b32 s76, s46, 1
  s_add_u32 s76, s76, s47
  s_lshl_b32 s44, s16, 6
  s_add_u32 s76, s76, s44
  s_lshl_b32 s76, s76, 10
  s_lshl_b32 s77, s47, 5
  s_add_u32 s77, s77, s46
  s_lshl_b32 s77, s77, 10
  s_and_b32 s78, s46, 15
  s_mul_i32 s79, s17, 2
  s_and_b32 s79, s79, 15
  s_add_u32 s45, s78, s79
  s_lshl_b32 s45, s45, 4
  s_lshl_b32 s43, s79, 11
  s_add_u32 s43, s43, s76
  s_lshl_b32 s44, s79, 10
  s_add_u32 s44, s44, s77
  v_xor_b32 v232, s45, v2
  s_mov_b32 m0, s44
  s_nop 0
  buffer_load_dwordx4 v232, s[8:11], s43 offen lds
  s_add_u32 s79, s79, 1
  s_and_b32 s79, s79, 15
  s_add_u32 s45, s78, s79
  s_lshl_b32 s45, s45, 4
  s_lshl_b32 s43, s79, 11
  s_add_u32 s43, s43, s76
  s_lshl_b32 s44, s79, 10
  s_add_u32 s44, s44, s77
  v_xor_b32 v232, s45, v2
  s_mov_b32 m0, s44
  s_nop 0
  buffer_load_dwordx4 v232, s[8:11], s43 offen lds
  s_add_u32 s79, s79, 1
  s_and_b32 s79, s79, 15
  s_add_u32 s45, s78, s79
  s_lshl_b32 s45, s45, 4
  s_lshl_b32 s43, s79, 11
  s_add_u32 s43, s43, s76
  s_lshl_b32 s44, s79, 10
  s_add_u32 s44, s44, s77
  v_xor_b32 v232, s45, v2
  s_mov_b32 m0, s44
  s_nop 0
  buffer_load_dwordx4 v232, s[8:11], s43 offen lds
  s_add_u32 s79, s79, 1
  s_and_b32 s79, s79, 15
  s_add_u32 s45, s78, s79
  s_lshl_b32 s45, s45, 4
  s_lshl_b32 s43, s79, 11
  s_add_u32 s43, s43, s76
  s_lshl_b32 s44, s79, 10
  s_add_u32 s44, s44, s77
  v_xor_b32 v232, s45, v2
  s_mov_b32 m0, s44
  s_nop 0
  buffer_load_dwordx4 v232, s[8:11], s43 offen lds
  s_add_u32 s79, s79, 1
  s_and_b32 s79, s79, 15
  s_add_u32 s45, s78, s79
  s_lshl_b32 s45, s45, 4
  s_lshl_b32 s43, s79, 11
  s_add_u32 s43, s43, s76
  s_lshl_b32 s44, s79, 10
  s_add_u32 s44, s44, s77
  v_xor_b32 v232, s45, v2
  s_mov_b32 m0, s44
  s_nop 0
  buffer_load_dwordx4 v232, s[8:11], s43 offen lds
  s_add_u32 s79, s79, 1
  s_and_b32 s79, s79, 15
  s_add_u32 s45, s78, s79
  s_lshl_b32 s45, s45, 4
  s_lshl_b32 s43, s79, 11
  s_add_u32 s43, s43, s76
  s_lshl_b32 s44, s79, 10
  s_add_u32 s44, s44, s77
  v_xor_b32 v232, s45, v2
  s_mov_b32 m0, s44
  s_nop 0
  buffer_load_dwordx4 v232, s[8:11], s43 offen lds
  s_add_u32 s79, s79, 1
  s_and_b32 s79, s79, 15
  s_add_u32 s45, s78, s79
  s_lshl_b32 s45, s45, 4
  s_lshl_b32 s43, s79, 11
  s_add_u32 s43, s43, s76
  s_lshl_b32 s44, s79, 10
  s_add_u32 s44, s44, s77
  v_xor_b32 v232, s45, v2
  s_mov_b32 m0, s44
  s_nop 0
  buffer_load_dwordx4 v232, s[8:11], s43 offen lds
  s_add_u32 s79, s79, 1
  s_and_b32 s79, s79, 15
  s_add_u32 s45, s78, s79
  s_lshl_b32 s45, s45, 4
  s_lshl_b32 s43, s79, 11
  s_add_u32 s43, s43, s76
  s_lshl_b32 s44, s79, 10
  s_add_u32 s44, s44, s77
  v_xor_b32 v232, s45, v2
  s_mov_b32 m0, s44
  s_nop 0
  buffer_load_dwordx4 v232, s[8:11], s43 offen lds
  s_add_u32 s79, s79, 1
  s_and_b32 s79, s79, 15
  s_add_u32 s45, s78, s79
  s_lshl_b32 s45, s45, 4
  s_lshl_b32 s43, s79, 11
  s_add_u32 s43, s43, s76
  s_lshl_b32 s44, s79, 10
  s_add_u32 s44, s44, s77
  v_xor_b32 v232, s45, v2
  s_mov_b32 m0, s44
  s_nop 0
  buffer_load_dwordx4 v232, s[8:11], s43 offen lds
  s_add_u32 s79, s79, 1
  s_and_b32 s79, s79, 15
  s_add_u32 s45, s78, s79
  s_lshl_b32 s45, s45, 4
  s_lshl_b32 s43, s79, 11
  s_add_u32 s43, s43, s76
  s_lshl_b32 s44, s79, 10
  s_add_u32 s44, s44, s77
  v_xor_b32 v232, s45, v2
  s_mov_b32 m0, s44
  s_nop 0
  buffer_load_dwordx4 v232, s[8:11], s43 offen lds
  s_add_u32 s79, s79, 1
  s_and_b32 s79, s79, 15
  s_add_u32 s45, s78, s79
  s_lshl_b32 s45, s45, 4
  s_lshl_b32 s43, s79, 11
  s_add_u32 s43, s43, s76
  s_lshl_b32 s44, s79, 10
  s_add_u32 s44, s44, s77
  v_xor_b32 v232, s45, v2
  s_mov_b32 m0, s44
  s_nop 0
  buffer_load_dwordx4 v232, s[8:11], s43 offen lds
  s_add_u32 s79, s79, 1
  s_and_b32 s79, s79, 15
  s_add_u32 s45, s78, s79
  s_lshl_b32 s45, s45, 4
  s_lshl_b32 s43, s79, 11
  s_add_u32 s43, s43, s76
  s_lshl_b32 s44, s79, 10
  s_add_u32 s44, s44, s77
  v_xor_b32 v232, s45, v2
  s_mov_b32 m0, s44
  s_nop 0
  buffer_load_dwordx4 v232, s[8:11], s43 offen lds
  s_add_u32 s79, s79, 1
  s_and_b32 s79, s79, 15
  s_add_u32 s45, s78, s79
  s_lshl_b32 s45, s45, 4
  s_lshl_b32 s43, s79, 11
  s_add_u32 s43, s43, s76
  s_lshl_b32 s44, s79, 10
  s_add_u32 s44, s44, s77
  v_xor_b32 v232, s45, v2
  s_mov_b32 m0, s44
  s_nop 0
  buffer_load_dwordx4 v232, s[8:11], s43 offen lds
  s_add_u32 s79, s79, 1
  s_and_b32 s79, s79, 15
  s_add_u32 s45, s78, s79
  s_lshl_b32 s45, s45, 4
  s_lshl_b32 s43, s79, 11
  s_add_u32 s43, s43, s76
  s_lshl_b32 s44, s79, 10
  s_add_u32 s44, s44, s77
  v_xor_b32 v232, s45, v2
  s_mov_b32 m0, s44
  s_nop 0
  buffer_load_dwordx4 v232, s[8:11], s43 offen lds
  s_add_u32 s79, s79, 1
  s_and_b32 s79, s79, 15
  s_add_u32 s45, s78, s79
  s_lshl_b32 s45, s45, 4
  s_lshl_b32 s43, s79, 11
  s_add_u32 s43, s43, s76
  s_lshl_b32 s44, s79, 10
  s_add_u32 s44, s44, s77
  v_xor_b32 v232, s45, v2
  s_mov_b32 m0, s44
  s_nop 0
  buffer_load_dwordx4 v232, s[8:11], s43 offen lds
  s_add_u32 s79, s79, 1
  s_and_b32 s79, s79, 15
  s_add_u32 s45, s78, s79
  s_lshl_b32 s45, s45, 4
  s_lshl_b32 s43, s79, 11
  s_add_u32 s43, s43, s76
  s_lshl_b32 s44, s79, 10
  s_add_u32 s44, s44, s77
  v_xor_b32 v232, s45, v2
  s_mov_b32 m0, s44
  s_nop 0
  buffer_load_dwordx4 v232, s[8:11], s43 offen lds
  s_add_u32 s79, s79, 1
  s_and_b32 s79, s79, 15
  s_lshl_b32 s46, s20, 8
  s_lshl_b32 s64, s46, 10
  s_lshl_b32 s44, s17, 7
  s_add_u32 s64, s64, s44
  s_lshl_b32 s65, s46, 7
  s_add_u32 s65, s65, 65536
  s_mov_b32 s66, 0
  s_lshl_b32 s44, s66, 10
  s_add_u32 s44, s44, s65
  s_mov_b32 m0, s44
  s_lshl_b32 s43, s66, 13
  s_add_u32 s43, s43, s64
  buffer_load_dwordx4 v233, s[68:71], s43 offen lds
  s_add_u32 s66, s66, 1
  s_lshl_b32 s44, s66, 10
  s_add_u32 s44, s44, s65
  s_mov_b32 m0, s44
  s_lshl_b32 s43, s66, 13
  s_add_u32 s43, s43, s64
  buffer_load_dwordx4 v233, s[68:71], s43 offen lds
  s_add_u32 s66, s66, 1
  s_lshl_b32 s44, s66, 10
  s_add_u32 s44, s44, s65
  s_mov_b32 m0, s44
  s_lshl_b32 s43, s66, 13
  s_add_u32 s43, s43, s64
  buffer_load_dwordx4 v233, s[68:71], s43 offen lds
  s_add_u32 s66, s66, 1
  s_lshl_b32 s44, s66, 10
  s_add_u32 s44, s44, s65
  s_mov_b32 m0, s44
  s_lshl_b32 s43, s66, 13
  s_add_u32 s43, s43, s64
  buffer_load_dwordx4 v233, s[68:71], s43 offen lds
  s_add_u32 s66, s66, 1
  s_lshl_b32 s44, s66, 10
  s_add_u32 s44, s44, s65
  s_mov_b32 m0, s44
  s_lshl_b32 s43, s66, 13
  s_add_u32 s43, s43, s64
  buffer_load_dwordx4 v233, s[68:71], s43 offen lds
  s_add_u32 s66, s66, 1
  s_lshl_b32 s44, s66, 10
  s_add_u32 s44, s44, s65
  s_mov_b32 m0, s44
  s_lshl_b32 s43, s66, 13
  s_add_u32 s43, s43, s64
  buffer_load_dwordx4 v233, s[68:71], s43 offen lds
  s_add_u32 s66, s66, 1
  s_lshl_b32 s44, s66, 10
  s_add_u32 s44, s44, s65
  s_mov_b32 m0, s44
  s_lshl_b32 s43, s66, 13
  s_add_u32 s43, s43, s64
  buffer_load_dwordx4 v233, s[68:71], s43 offen lds
  s_add_u32 s66, s66, 1
  s_lshl_b32 s44, s66, 10
  s_add_u32 s44, s44, s65
  s_mov_b32 m0, s44
  s_lshl_b32 s43, s66, 13
  s_add_u32 s43, s43, s64
  buffer_load_dwordx4 v233, s[68:71], s43 offen lds
  s_add_u32 s66, s66, 1
  s_lshl_b32 s44, s66, 10
  s_add_u32 s44, s44, s65
  s_mov_b32 m0, s44
  s_lshl_b32 s43, s66, 13
  s_add_u32 s43, s43, s64
  buffer_load_dwordx4 v233, s[68:71], s43 offen lds
  s_add_u32 s66, s66, 1
  s_lshl_b32 s44, s66, 10
  s_add_u32 s44, s44, s65
  s_mov_b32 m0, s44
  s_lshl_b32 s43, s66, 13
  s_add_u32 s43, s43, s64
  buffer_load_dwordx4 v233, s[68:71], s43 offen lds
  s_add_u32 s66, s66, 1
  s_lshl_b32 s44, s66, 10
  s_add_u32 s44, s44, s65
  s_mov_b32 m0, s44
  s_lshl_b32 s43, s66, 13
  s_add_u32 s43, s43, s64
  buffer_load_dwordx4 v233, s[68:71], s43 offen lds
  s_add_u32 s66, s66, 1
  s_lshl_b32 s44, s66, 10
  s_add_u32 s44, s44, s65
  s_mov_b32 m0, s44
  s_lshl_b32 s43, s66, 13
  s_add_u32 s43, s43, s64
  buffer_load_dwordx4 v233, s[68:71], s43 offen lds
  s_add_u32 s66, s66, 1
  s_barrier
  s_lshl_b32 s46, s20, 8
  s_add_u32 s46, s46, 96
  s_lshl_b32 s64, s46, 10
  s_lshl_b32 s44, s17, 7
  s_add_u32 s64, s64, s44
  s_lshl_b32 s65, s46, 7
  s_add_u32 s65, s65, 65536
  s_mov_b32 s66, 0
  s_lshl_b32 s44, s66, 10
  s_add_u32 s44, s44, s65
  s_mov_b32 m0, s44
  s_lshl_b32 s43, s66, 13
  s_add_u32 s43, s43, s64
  buffer_load_dwordx4 v233, s[68:71], s43 offen lds
  s_add_u32 s66, s66, 1
  s_lshl_b32 s44, s66, 10
  s_add_u32 s44, s44, s65
  s_mov_b32 m0, s44
  s_lshl_b32 s43, s66, 13
  s_add_u32 s43, s43, s64
  buffer_load_dwordx4 v233, s[68:71], s43 offen lds
  s_add_u32 s66, s66, 1
  s_lshl_b32 s44, s66, 10
  s_add_u32 s44, s44, s65
  s_mov_b32 m0, s44
  s_lshl_b32 s43, s66, 13
  s_add_u32 s43, s43, s64
  buffer_load_dwordx4 v233, s[68:71], s43 offen lds
  s_add_u32 s66, s66, 1
  s_lshl_b32 s44, s66, 10
  s_add_u32 s44, s44, s65
  s_mov_b32 m0, s44
  s_lshl_b32 s43, s66, 13
  s_add_u32 s43, s43, s64
  buffer_load_dwordx4 v233, s[68:71], s43 offen lds
  s_add_u32 s66, s66, 1
  s_lshl_b32 s44, s66, 10
  s_add_u32 s44, s44, s65
  s_mov_b32 m0, s44
  s_lshl_b32 s43, s66, 13
  s_add_u32 s43, s43, s64
  buffer_load_dwordx4 v233, s[68:71], s43 offen lds
  s_add_u32 s66, s66, 1
  s_lshl_b32 s44, s66, 10
  s_add_u32 s44, s44, s65
  s_mov_b32 m0, s44
  s_lshl_b32 s43, s66, 13
  s_add_u32 s43, s43, s64
  buffer_load_dwordx4 v233, s[68:71], s43 offen lds
  s_add_u32 s66, s66, 1
  s_lshl_b32 s44, s66, 10
  s_add_u32 s44, s44, s65
  s_mov_b32 m0, s44
  s_lshl_b32 s43, s66, 13
  s_add_u32 s43, s43, s64
  buffer_load_dwordx4 v233, s[68:71], s43 offen lds
  s_add_u32 s66, s66, 1
  s_lshl_b32 s44, s66, 10
  s_add_u32 s44, s44, s65
  s_mov_b32 m0, s44
  s_lshl_b32 s43, s66, 13
  s_add_u32 s43, s43, s64
  buffer_load_dwordx4 v233, s[68:71], s43 offen lds
  s_add_u32 s66, s66, 1
  s_lshl_b32 s44, s66, 10
  s_add_u32 s44, s44, s65
  s_mov_b32 m0, s44
  s_lshl_b32 s43, s66, 13
  s_add_u32 s43, s43, s64
  buffer_load_dwordx4 v233, s[68:71], s43 offen lds
  s_add_u32 s66, s66, 1
  s_lshl_b32 s44, s66, 10
  s_add_u32 s44, s44, s65
  s_mov_b32 m0, s44
  s_lshl_b32 s43, s66, 13
  s_add_u32 s43, s43, s64
  buffer_load_dwordx4 v233, s[68:71], s43 offen lds
  s_add_u32 s66, s66, 1
  s_lshl_b32 s44, s66, 10
  s_add_u32 s44, s44, s65
  s_mov_b32 m0, s44
  s_lshl_b32 s43, s66, 13
  s_add_u32 s43, s43, s64
  buffer_load_dwordx4 v233, s[68:71], s43 offen lds
  s_add_u32 s66, s66, 1
  s_lshl_b32 s44, s66, 10
  s_add_u32 s44, s44, s65
  s_mov_b32 m0, s44
  s_lshl_b32 s43, s66, 13
  s_add_u32 s43, s43, s64
  buffer_load_dwordx4 v233, s[68:71], s43 offen lds
  s_add_u32 s66, s66, 1
  s_lshl_b32 s44, s66, 10
  s_add_u32 s44, s44, s65
  s_mov_b32 m0, s44
  s_lshl_b32 s43, s66, 13
  s_add_u32 s43, s43, s64
  buffer_load_dwordx4 v233, s[68:71], s43 offen lds
  s_add_u32 s66, s66, 1
  s_lshl_b32 s44, s66, 10
  s_add_u32 s44, s44, s65
  s_mov_b32 m0, s44
  s_lshl_b32 s43, s66, 13
  s_add_u32 s43, s43, s64
  buffer_load_dwordx4 v233, s[68:71], s43 offen lds
  s_add_u32 s66, s66, 1
  s_lshl_b32 s44, s66, 10
  s_add_u32 s44, s44, s65
  s_mov_b32 m0, s44
  s_lshl_b32 s43, s66, 13
  s_add_u32 s43, s43, s64
  buffer_load_dwordx4 v233, s[68:71], s43 offen lds
  s_add_u32 s66, s66, 1
  s_lshl_b32 s44, s66, 10
  s_add_u32 s44, s44, s65
  s_mov_b32 m0, s44
  s_lshl_b32 s43, s66, 13
  s_add_u32 s43, s43, s64
  buffer_load_dwordx4 v233, s[68:71], s43 offen lds
  s_add_u32 s66, s66, 1
  s_lshl_b32 s44, s66, 10
  s_add_u32 s44, s44, s65
  s_mov_b32 m0, s44
  s_lshl_b32 s43, s66, 13
  s_add_u32 s43, s43, s64
  buffer_load_dwordx4 v233, s[68:71], s43 offen lds
  s_add_u32 s66, s66, 1
  s_lshl_b32 s44, s66, 10
  s_add_u32 s44, s44, s65
  s_mov_b32 m0, s44
  s_lshl_b32 s43, s66, 13
  s_add_u32 s43, s43, s64
  buffer_load_dwordx4 v233, s[68:71], s43 offen lds
  s_add_u32 s66, s66, 1
  s_lshl_b32 s44, s66, 10
  s_add_u32 s44, s44, s65
  s_mov_b32 m0, s44
  s_lshl_b32 s43, s66, 13
  s_add_u32 s43, s43, s64
  buffer_load_dwordx4 v233, s[68:71], s43 offen lds
  s_add_u32 s66, s66, 1
  s_lshl_b32 s44, s66, 10
  s_add_u32 s44, s44, s65
  s_mov_b32 m0, s44
  s_lshl_b32 s43, s66, 13
  s_add_u32 s43, s43, s64
  buffer_load_dwordx4 v233, s[68:71], s43 offen lds
  s_add_u32 s66, s66, 1
  s_waitcnt vmcnt(0)
  s_barrier
  s_branch FQS_10
FKVP_8:
  s_waitcnt vmcnt(4)
  v_readfirstlane_b32 s21, v231
  s_nop 1
  s_mul_i32 s21, s21, 0x9E3779B1
  s_add_u32 s21, s21, 0x7F4A7C15
  s_cmp_lg_u32 s18, 0
  s_cbranch_scc1 XW_15
  s_add_u32 s40, s21, s3
  s_add_u32 s40, s40, 16
  v_mov_b32 v14, s40
  s_lshl_b32 s41, s16, 3
  s_add_u32 s41, s41, s17
  s_lshl_b32 s41, s41, 2
  s_add_u32 s41, s41, 114688
  v_mov_b32 v15, 0
  s_mov_b64 exec, 1
  buffer_store_dword v14, v15, s[4:7], s41 offen sc1
  s_mov_b64 exec, -1
XW_15:
  s_barrier
  ds_read_b128 v[16:19], v240 offset:0
  ds_read_b128 v[20:23], v241 offset:0
  ds_read_b128 v[24:27], v242 offset:0
  ds_read_b128 v[28:31], v243 offset:0
  ds_read_b128 v[32:35], v244 offset:0
  ds_read_b128 v[36:39], v245 offset:0
  ds_read_b128 v[40:43], v246 offset:0
  ds_read_b128 v[44:47], v247 offset:0
  ds_read_b128 v[48:51], v240 offset:256
  ds_read_b128 v[52:55], v241 offset:256
  ds_read_b128 v[56:59], v242 offset:256
  ds_read_b128 v[60:63], v243 offset:256
  ds_read_b128 v[64:67], v244 offset:256
  ds_read_b128 v[68:71], v245 offset:256
  ds_read_b128 v[72:75], v246 offset:256
  ds_read_b128 v[76:79], v247 offset:256
  v_mov_b32 v229, 0x3f803f80
  v_mov_b32 v224, 0
  v_mov_b32 v225, 0
  v_mov_b32 v226, 0
  v_mov_b32 v236, 0
  v_mov_b32 v237, 0
  v_mov_b32 v238, 0
  s_waitcnt lgkmcnt(0)
  ds_read_b64_tr_b16 v[160:161], v250 offset:0
  ds_read_b64_tr_b16 v[162:163], v250 offset:128
  ds_read_b64_tr_b16 v[164:165], v250 offset:512
  ds_read_b64_tr_b16 v[166:167], v250 offset:640
  ds_read_b64_tr_b16 v[168:169], v250 offset:1024
  ds_read_b64_tr_b16 v[170:171], v250 offset:1152
  ds_read_b64_tr_b16 v[172:173], v250 offset:1536
  ds_read_b64_tr_b16 v[174:175], v250 offset:1664
  ds_read_b64_tr_b16 v[176:177], v250 offset:2048
  ds_read_b64_tr_b16 v[178:179], v250 offset:2176
  ds_read_b64_tr_b16 v[180:181], v250 offset:2560
  ds_read_b64_tr_b16 v[182:183], v250 offset:2688
  v_dot2c_f32_bf16 v224, v229, v16
  v_dot2c_f32_bf16 v225, v16, v16
  v_dot2c_f32_bf16 v236, v229, v17
  v_dot2c_f32_bf16 v237, v17, v17
  v_dot2c_f32_bf16 v224, v229, v18
  v_dot2c_f32_bf16 v225, v18, v18
  v_dot2c_f32_bf16 v236, v229, v19
  v_dot2c_f32_bf16 v237, v19, v19
  ds_read_b64_tr_b16 v[184:185], v250 offset:3072
  ds_read_b64_tr_b16 v[186:187], v250 offset:3200
  v_dot2c_f32_bf16 v224, v229, v20
  v_dot2c_f32_bf16 v225, v20, v20
  v_dot2c_f32_bf16 v236, v229, v21
  v_dot2c_f32_bf16 v237, v21, v21
  v_dot2c_f32_bf16 v224, v229, v22
  v_dot2c_f32_bf16 v225, v22, v22
  v_dot2c_f32_bf16 v236, v229, v23
  v_dot2c_f32_bf16 v237, v23, v23
  ds_read_b64_tr_b16 v[188:189], v250 offset:3584
  ds_read_b64_tr_b16 v[190:191], v250 offset:3712
  v_dot2c_f32_bf16 v224, v229, v24
  v_dot2c_f32_bf16 v225, v24, v24
  v_dot2c_f32_bf16 v236, v229, v25
  v_dot2c_f32_bf16 v237, v25, v25
  v_dot2c_f32_bf16 v224, v229, v26
  v_dot2c_f32_bf16 v225, v26, v26
  v_dot2c_f32_bf16 v236, v229, v27
  v_dot2c_f32_bf16 v237, v27, v27
  ds_read_b64_tr_b16 v[192:193], v250 offset:4096
  ds_read_b64_tr_b16 v[194:195], v250 offset:4224
  v_dot2c_f32_bf16 v224, v229, v28
  v_dot2c_f32_bf16 v225, v28, v28
  v_dot2c_f32_bf16 v236, v229, v29
  v_dot2c_f32_bf16 v237, v29, v29
  v_dot2c_f32_bf16 v224, v229, v30
  v_dot2c_f32_bf16 v225, v30, v30
  v_dot2c_f32_bf16 v236, v229, v31
  v_dot2c_f32_bf16 v237, v31, v31
  ds_read_b64_tr_b16 v[196:197], v250 offset:4608
  ds_read_b64_tr_b16 v[198:199], v250 offset:4736
  v_dot2c_f32_bf16 v224, v229, v32
  v_dot2c_f32_bf16 v225, v32, v32
  v_dot2c_f32_bf16 v236, v229, v33
  v_dot2c_f32_bf16 v237, v33, v33
  v_dot2c_f32_bf16 v224, v229, v34
  v_dot2c_f32_bf16 v225, v34, v34
  v_dot2c_f32_bf16 v236, v229, v35
  v_dot2c_f32_bf16 v237, v35, v35
  ds_read_b64_tr_b16 v[200:201], v250 offset:5120
  ds_read_b64_tr_b16 v[202:203], v250 offset:5248
  v_dot2c_f32_bf16 v224, v229, v36
  v_dot2c_f32_bf16 v225, v36, v36
  v_dot2c_f32_bf16 v236, v229, v37
  v_dot2c_f32_bf16 v237, v37, v37
  v_dot2c_f32_bf16 v224, v229, v38
  v_dot2c_f32_bf16 v225, v38, v38
  v_dot2c_f32_bf16 v236, v229, v39
  v_dot2c_f32_bf16 v237, v39, v39
  ds_read_b64_tr_b16 v[204:205], v250 offset:5632
  ds_read_b64_tr_b16 v[206:207], v250 offset:5760
  v_dot2c_f32_bf16 v224, v229, v40
  v_dot2c_f32_bf16 v225, v40, v40
  v_dot2c_f32_bf16 v236, v229, v41
  v_dot2c_f32_bf16 v237, v41, v41
  v_dot2c_f32_bf16 v224, v229, v42
  v_dot2c_f32_bf16 v225, v42, v42
  v_dot2c_f32_bf16 v236, v229, v43
  v_dot2c_f32_bf16 v237, v43, v43
  ds_read_b64_tr_b16 v[208:209], v250 offset:6144
  ds_read_b64_tr_b16 v[210:211], v250 offset:6272
  v_dot2c_f32_bf16 v224, v229, v44
  v_dot2c_f32_bf16 v225, v44, v44
  v_dot2c_f32_bf16 v236, v229, v45
  v_dot2c_f32_bf16 v237, v45, v45
  v_dot2c_f32_bf16 v224, v229, v46
  v_dot2c_f32_bf16 v225, v46, v46
  v_dot2c_f32_bf16 v236, v229, v47
  v_dot2c_f32_bf16 v237, v47, v47
  ds_read_b64_tr_b16 v[212:213], v250 offset:6656
  ds_read_b64_tr_b16 v[214:215], v250 offset:6784
  v_dot2c_f32_bf16 v224, v229, v48
  v_dot2c_f32_bf16 v225, v48, v48
  v_dot2c_f32_bf16 v236, v229, v49
  v_dot2c_f32_bf16 v237, v49, v49
  v_dot2c_f32_bf16 v224, v229, v50
  v_dot2c_f32_bf16 v225, v50, v50
  v_dot2c_f32_bf16 v236, v229, v51
  v_dot2c_f32_bf16 v237, v51, v51
  ds_read_b64_tr_b16 v[216:217], v250 offset:7168
  ds_read_b64_tr_b16 v[218:219], v250 offset:7296
  v_dot2c_f32_bf16 v224, v229, v52
  v_dot2c_f32_bf16 v225, v52, v52
  v_dot2c_f32_bf16 v236, v229, v53
  v_dot2c_f32_bf16 v237, v53, v53
  v_dot2c_f32_bf16 v224, v229, v54
  v_dot2c_f32_bf16 v225, v54, v54
  v_dot2c_f32_bf16 v236, v229, v55
  v_dot2c_f32_bf16 v237, v55, v55
  ds_read_b64_tr_b16 v[220:221], v250 offset:7680
  ds_read_b64_tr_b16 v[222:223], v250 offset:7808
  v_dot2c_f32_bf16 v224, v229, v56
  v_dot2c_f32_bf16 v225, v56, v56
  v_dot2c_f32_bf16 v236, v229, v57
  v_dot2c_f32_bf16 v237, v57, v57
  v_dot2c_f32_bf16 v224, v229, v58
  v_dot2c_f32_bf16 v225, v58, v58
  v_dot2c_f32_bf16 v236, v229, v59
  v_dot2c_f32_bf16 v237, v59, v59
  v_dot2c_f32_bf16 v224, v229, v60
  v_dot2c_f32_bf16 v225, v60, v60
  v_dot2c_f32_bf16 v236, v229, v61
  v_dot2c_f32_bf16 v237, v61, v61
  v_dot2c_f32_bf16 v224, v229, v62
  v_dot2c_f32_bf16 v225, v62, v62
  v_dot2c_f32_bf16 v236, v229, v63
  v_dot2c_f32_bf16 v237, v63, v63
  v_dot2c_f32_bf16 v224, v229, v64
  v_dot2c_f32_bf16 v225, v64, v64
  v_dot2c_f32_bf16 v236, v229, v65
  v_dot2c_f32_bf16 v237, v65, v65
  v_dot2c_f32_bf16 v224, v229, v66
  v_dot2c_f32_bf16 v225, v66, v66
  v_dot2c_f32_bf16 v236, v229, v67
  v_dot2c_f32_bf16 v237, v67, v67
  v_dot2c_f32_bf16 v224, v229, v68
  v_dot2c_f32_bf16 v225, v68, v68
  v_dot2c_f32_bf16 v236, v229, v69
  v_dot2c_f32_bf16 v237, v69, v69
  v_dot2c_f32_bf16 v224, v229, v70
  v_dot2c_f32_bf16 v225, v70, v70
  v_dot2c_f32_bf16 v236, v229, v71
  v_dot2c_f32_bf16 v237, v71, v71
  v_dot2c_f32_bf16 v224, v229, v72
  v_dot2c_f32_bf16 v225, v72, v72
  v_dot2c_f32_bf16 v236, v229, v73
  v_dot2c_f32_bf16 v237, v73, v73
  v_dot2c_f32_bf16 v224, v229, v74
  v_dot2c_f32_bf16 v225, v74, v74
  v_dot2c_f32_bf16 v236, v229, v75
  v_dot2c_f32_bf16 v237, v75, v75
  v_dot2c_f32_bf16 v224, v229, v76
  v_dot2c_f32_bf16 v225, v76, v76
  v_dot2c_f32_bf16 v236, v229, v77
  v_dot2c_f32_bf16 v237, v77, v77
  v_dot2c_f32_bf16 v224, v229, v78
  v_dot2c_f32_bf16 v225, v78, v78
  v_dot2c_f32_bf16 v236, v229, v79
  v_dot2c_f32_bf16 v237, v79, v79
  s_waitcnt lgkmcnt(0)
  v_dot2c_f32_bf16 v226, v229, v160
  v_dot2c_f32_bf16 v238, v229, v161
  v_dot2c_f32_bf16 v226, v229, v162
  v_dot2c_f32_bf16 v238, v229, v163
  v_dot2c_f32_bf16 v226, v229, v164
  v_dot2c_f32_bf16 v238, v229, v165
  v_dot2c_f32_bf16 v226, v229, v166
  v_dot2c_f32_bf16 v238, v229, v167
  v_dot2c_f32_bf16 v226, v229, v168
  v_dot2c_f32_bf16 v238, v229, v169
  v_dot2c_f32_bf16 v226, v229, v170
  v_dot2c_f32_bf16 v238, v229, v171
  v_dot2c_f32_bf16 v226, v229, v172
  v_dot2c_f32_bf16 v238, v229, v173
  v_dot2c_f32_bf16 v226, v229, v174
  v_dot2c_f32_bf16 v238, v229, v175
  v_dot2c_f32_bf16 v226, v229, v176
  v_dot2c_f32_bf16 v238, v229, v177
  v_dot2c_f32_bf16 v226, v229, v178
  v_dot2c_f32_bf16 v238, v229, v179
  v_dot2c_f32_bf16 v226, v229, v180
  v_dot2c_f32_bf16 v238, v229, v181
  v_dot2c_f32_bf16 v226, v229, v182
  v_dot2c_f32_bf16 v238, v229, v183
  v_dot2c_f32_bf16 v226, v229, v184
  v_dot2c_f32_bf16 v238, v229, v185
  v_dot2c_f32_bf16 v226, v229, v186
  v_dot2c_f32_bf16 v238, v229, v187
  v_dot2c_f32_bf16 v226, v229, v188
  v_dot2c_f32_bf16 v238, v229, v189
  v_dot2c_f32_bf16 v226, v229, v190
  v_dot2c_f32_bf16 v238, v229, v191
  v_dot2c_f32_bf16 v226, v229, v192
  v_dot2c_f32_bf16 v238, v229, v193
  v_dot2c_f32_bf16 v226, v229, v194
  v_dot2c_f32_bf16 v238, v229, v195
  v_dot2c_f32_bf16 v226, v229, v196
  v_dot2c_f32_bf16 v238, v229, v197
  v_dot2c_f32_bf16 v226, v229, v198
  v_dot2c_f32_bf16 v238, v229, v199
  v_dot2c_f32_bf16 v226, v229, v200
  v_dot2c_f32_bf16 v238, v229, v201
  v_dot2c_f32_bf16 v226, v229, v202
  v_dot2c_f32_bf16 v238, v229, v203
  v_dot2c_f32_bf16 v226, v229, v204
  v_dot2c_f32_bf16 v238, v229, v205
  v_dot2c_f32_bf16 v226, v229, v206
  v_dot2c_f32_bf16 v238, v229, v207
  v_dot2c_f32_bf16 v226, v229, v208
  v_dot2c_f32_bf16 v238, v229, v209
  v_dot2c_f32_bf16 v226, v229, v210
  v_dot2c_f32_bf16 v238, v229, v211
  v_dot2c_f32_bf16 v226, v229, v212
  v_dot2c_f32_bf16 v238, v229, v213
  v_dot2c_f32_bf16 v226, v229, v214
  v_dot2c_f32_bf16 v238, v229, v215
  v_dot2c_f32_bf16 v226, v229, v216
  v_dot2c_f32_bf16 v238, v229, v217
  v_dot2c_f32_bf16 v226, v229, v218
  v_dot2c_f32_bf16 v238, v229, v219
  v_dot2c_f32_bf16 v226, v229, v220
  v_dot2c_f32_bf16 v238, v229, v221
  v_dot2c_f32_bf16 v226, v229, v222
  v_dot2c_f32_bf16 v238, v229, v223
  v_mfma_f32_32x32x16_bf16 v[144:159], v[160:163], v[16:19], 0
  v_mfma_f32_32x32x16_bf16 v[144:159], v[164:167], v[20:23], v[144:159]
  v_mfma_f32_32x32x16_bf16 v[144:159], v[168:171], v[24:27], v[144:159]
  v_mfma_f32_32x32x16_bf16 v[144:159], v[172:175], v[28:31], v[144:159]
  v_mfma_f32_32x32x16_bf16 v[144:159], v[176:179], v[32:35], v[144:159]
  v_mfma_f32_32x32x16_bf16 v[144:159], v[180:183], v[36:39], v[144:159]
  v_mfma_f32_32x32x16_bf16 v[144:159], v[184:187], v[40:43], v[144:159]
  v_mfma_f32_32x32x16_bf16 v[144:159], v[188:191], v[44:47], v[144:159]
  v_mfma_f32_32x32x16_bf16 v[144:159], v[192:195], v[48:51], v[144:159]
  v_mfma_f32_32x32x16_bf16 v[144:159], v[196:199], v[52:55], v[144:159]
  v_mfma_f32_32x32x16_bf16 v[144:159], v[200:203], v[56:59], v[144:159]
  v_mfma_f32_32x32x16_bf16 v[144:159], v[204:207], v[60:63], v[144:159]
  v_mfma_f32_32x32x16_bf16 v[144:159], v[208:211], v[64:67], v[144:159]
  v_mfma_f32_32x32x16_bf16 v[144:159], v[212:215], v[68:71], v[144:159]
  v_mfma_f32_32x32x16_bf16 v[144:159], v[216:219], v[72:75], v[144:159]
  v_mfma_f32_32x32x16_bf16 v[144:159], v[220:223], v[76:79], v[144:159]
  s_lshl_b32 s40, s20, 13
  s_add_u32 s40, s40, 131072
  v_add_f32 v224, v224, v236
  v_add_f32 v225, v225, v237
  s_nop 1
  v_permlane32_swap_b32 v224, v225
  v_add_f32 v224, v224, v225
  v_add_u32 v227, s40, v3
  ds_write_b32 v227, v224
  s_add_u32 s41, s40, 256
  v_add_f32 v226, v226, v238
  v_mov_b32 v228, v226
  s_nop 1
  v_permlane32_swap_b32 v226, v228
  v_add_f32 v226, v226, v228
  v_add_u32 v228, s41, v3
  s_mov_b32 exec_hi, 0
  ds_write_b32 v228, v226
  s_mov_b64 exec, -1
  s_cmp_eq_u32 s20, 0
  s_cbranch_scc1 FKW_16
  v_add_u32 v14, 139776, v2
  ds_write_b128 v14, v[144:147] offset:0
  ds_write_b128 v14, v[148:151] offset:1024
  ds_write_b128 v14, v[152:155] offset:2048
  ds_write_b128 v14, v[156:159] offset:3072
FKW_16:
  s_waitcnt lgkmcnt(0)
  s_barrier
  s_mov_b32 s40, 131072
  v_and_b32 v227, 31, v1
  v_lshlrev_b32 v227, 2, v227
  v_add_u32 v227, s40, v227
  ds_read_b32 v224, v227
  ds_read_b32 v225, v227 offset:128
  ds_read_b32 v226, v227 offset:8192
  ds_read_b32 v228, v227 offset:8320
  s_waitcnt lgkmcnt(0)
  v_add_f32 v224, v224, v226
  v_add_f32 v225, v225, v228
  v_mul_f32 v178, 0x3b000000, v224
  v_mul_f32 v225, 0x3b000000, v225
  v_fma_f32 v225, -v178, v178, v225
  v_add_f32 v225, 0x3727c5ac, v225
  v_rsq_f32 v179, v225
  s_cmp_lg_u32 s20, 0
  s_cbranch_scc1 FK1_17
  v_add_u32 v14, 139776, v2
  ds_read_b128 v[96:99], v14 offset:0
  ds_read_b128 v[100:103], v14 offset:1024
  ds_read_b128 v[104:107], v14 offset:2048
  ds_read_b128 v[108:111], v14 offset:3072
  v_and_b32 v216, 31, v1
  v_lshlrev_b32 v216, 5, v216
  v_lshrrev_b32 v217, 5, v1
  v_lshl_add_u32 v216, v217, 3, v216
  v_add_u32 v216, 132096, v216
  v_and_b32 v218, 15, v1
  v_bfe_u32 v219, v1, 4, 1
  v_lshlrev_b32 v219, 4, v219
  v_lshl_add_u32 v219, v217, 2, v219
  v_lshrrev_b32 v220, 2, v218
  v_add_u32 v219, v219, v220
  v_lshlrev_b32 v219, 5, v219
  v_and_b32 v220, 3, v218
  v_lshl_add_u32 v219, v220, 3, v219
  v_add_u32 v219, 132096, v219
  v_bfe_u32 v220, v1, 4, 1
  v_mul_u32_u24 v220, 544, v220
  v_mul_u32_u24 v222, 272, v217
  v_add_u32 v220, v220, v222
  v_lshl_add_u32 v220, v218, 4, v220
  s_lshl_b32 s40, s26, 10
  s_add_u32 s40, s40, s37
  s_mul_i32 s41, s26, 1088
  s_add_u32 s41, s41, s37
  s_add_u32 s41, s41, 0x10000
  v_mul_u32_u24 v222, 272, v1
  v_add_u32 v222, 256, v222
  v_mov_b32 v224, 0x3f803f80
  v_mov_b32 v225, 0x3f803f80
  v_mov_b32 v226, 0x3f803f80
  v_mov_b32 v227, 0x3f803f80
  s_mov_b64 exec, 0xf
  buffer_store_dwordx4 v[224:227], v222, s[4:7], s41 offen sc1
  s_mov_b64 exec, -1
  s_waitcnt lgkmcnt(0)
  v_lshrrev_b32 v228, 5, v1
  v_lshlrev_b32 v228, 4, v228
  v_add_u32 v228, 131328, v228
  ds_read_b128 v[196:199], v228 offset:0
  ds_read_b128 v[112:115], v228 offset:8192
  ds_read_b128 v[200:203], v228 offset:32
  ds_read_b128 v[116:119], v228 offset:8224
  ds_read_b128 v[204:207], v228 offset:64
  ds_read_b128 v[120:123], v228 offset:8256
  ds_read_b128 v[208:211], v228 offset:96
  ds_read_b128 v[124:127], v228 offset:8288
  s_waitcnt lgkmcnt(0)
  v_add_f32 v196, v196, v112
  v_add_f32 v197, v197, v113
  v_add_f32 v198, v198, v114
  v_add_f32 v199, v199, v115
  v_add_f32 v200, v200, v116
  v_add_f32 v201, v201, v117
  v_add_f32 v202, v202, v118
  v_add_f32 v203, v203, v119
  v_add_f32 v204, v204, v120
  v_add_f32 v205, v205, v121
  v_add_f32 v206, v206, v122
  v_add_f32 v207, v207, v123
  v_add_f32 v208, v208, v124
  v_add_f32 v209, v209, v125
  v_add_f32 v210, v210, v126
  v_add_f32 v211, v211, v127
  v_mul_f32 v214, v178, v179
  v_sub_f32 v214, 0, v214
  v_mov_b32 v212, v179
  v_pk_add_f32 v[144:145], v[144:145], v[96:97]
  v_pk_add_f32 v[146:147], v[146:147], v[98:99]
  v_pk_add_f32 v[148:149], v[148:149], v[100:101]
  v_pk_add_f32 v[150:151], v[150:151], v[102:103]
  v_pk_add_f32 v[152:153], v[152:153], v[104:105]
  v_pk_add_f32 v[154:155], v[154:155], v[106:107]
  v_pk_add_f32 v[156:157], v[156:157], v[108:109]
  v_pk_add_f32 v[158:159], v[158:159], v[110:111]
  v_pk_mul_f32 v[96:97], v[196:197], v[214:215] op_sel_hi:[1,0]
  v_pk_mul_f32 v[98:99], v[198:199], v[214:215] op_sel_hi:[1,0]
  v_pk_mul_f32 v[100:101], v[200:201], v[214:215] op_sel_hi:[1,0]
  v_pk_mul_f32 v[102:103], v[202:203], v[214:215] op_sel_hi:[1,0]
  v_pk_mul_f32 v[104:105], v[204:205], v[214:215] op_sel_hi:[1,0]
  v_pk_mul_f32 v[106:107], v[206:207], v[214:215] op_sel_hi:[1,0]
  v_pk_mul_f32 v[108:109], v[208:209], v[214:215] op_sel_hi:[1,0]
  v_pk_mul_f32 v[110:111], v[210:211], v[214:215] op_sel_hi:[1,0]
  v_pk_fma_f32 v[144:145], v[144:145], v[212:213], v[96:97] op_sel_hi:[1,0,1]
  v_pk_fma_f32 v[146:147], v[146:147], v[212:213], v[98:99] op_sel_hi:[1,0,1]
  v_pk_fma_f32 v[148:149], v[148:149], v[212:213], v[100:101] op_sel_hi:[1,0,1]
  v_pk_fma_f32 v[150:151], v[150:151], v[212:213], v[102:103] op_sel_hi:[1,0,1]
  v_pk_fma_f32 v[152:153], v[152:153], v[212:213], v[104:105] op_sel_hi:[1,0,1]
  v_pk_fma_f32 v[154:155], v[154:155], v[212:213], v[106:107] op_sel_hi:[1,0,1]
  v_pk_fma_f32 v[156:157], v[156:157], v[212:213], v[108:109] op_sel_hi:[1,0,1]
  v_pk_fma_f32 v[158:159], v[158:159], v[212:213], v[110:111] op_sel_hi:[1,0,1]
  v_cvt_pk_bf16_f32 v96, v144, v145
  v_cvt_pk_bf16_f32 v97, v146, v147
  v_cvt_pk_bf16_f32 v98, v148, v149
  v_cvt_pk_bf16_f32 v99, v150, v151
  v_cvt_pk_bf16_f32 v100, v152, v153
  v_cvt_pk_bf16_f32 v101, v154, v155
  v_cvt_pk_bf16_f32 v102, v156, v157
  v_cvt_pk_bf16_f32 v103, v158, v159
  ds_write_b64 v216, v[96:97]
  ds_write_b64 v216, v[98:99] offset:16
  buffer_store_dwordx4 v[100:103], v2, s[4:7], s40 offen sc1
  s_waitcnt lgkmcnt(0)
  ds_read_b64_tr_b16 v[104:105], v219
  ds_read_b64_tr_b16 v[106:107], v219 offset:256
  s_waitcnt lgkmcnt(0)
  buffer_store_dwordx4 v[104:107], v220, s[4:7], s41 offen sc1
FK1_17:
  s_barrier
  v_mov_b32 v232, 0x3f803f80
  v_mov_b32 v233, 0x3f803f80
  v_mov_b32 v234, 0x3f803f80
  v_mov_b32 v235, 0x3f803f80
  s_cmp_eq_u32 s19, 1
  s_cbranch_scc1 FQP1_18
  ds_read_b64_tr_b16 v[112:113], v248 offset:0
  ds_read_b64_tr_b16 v[114:115], v248 offset:512
  ds_read_b64_tr_b16 v[116:117], v249 offset:0
  ds_read_b64_tr_b16 v[118:119], v249 offset:512
  ds_read_b64_tr_b16 v[120:121], v248 offset:2048
  ds_read_b64_tr_b16 v[122:123], v248 offset:2560
  ds_read_b64_tr_b16 v[124:125], v249 offset:2048
  ds_read_b64_tr_b16 v[126:127], v249 offset:2560
  ds_read_b64_tr_b16 v[128:129], v248 offset:4096
  ds_read_b64_tr_b16 v[130:131], v248 offset:4608
  ds_read_b64_tr_b16 v[132:133], v249 offset:4096
  ds_read_b64_tr_b16 v[134:135], v249 offset:4608
  ds_read_b64_tr_b16 v[136:137], v248 offset:6144
  ds_read_b64_tr_b16 v[138:139], v248 offset:6656
  ds_read_b64_tr_b16 v[140:141], v249 offset:6144
  ds_read_b64_tr_b16 v[142:143], v249 offset:6656
  s_waitcnt lgkmcnt(12)
  v_mfma_f32_32x32x16_bf16 v[80:95], v[112:115], v[16:19], 0
  v_mfma_f32_32x32x16_bf16 v[96:111], v[116:119], v[16:19], 0
  v_mfma_f32_32x32x16_bf16 v[144:159], v[112:115], v[232:235], 0
  ds_read_b64_tr_b16 v[112:113], v248 offset:8192
  ds_read_b64_tr_b16 v[114:115], v248 offset:8704
  ds_read_b64_tr_b16 v[116:117], v249 offset:8192
  ds_read_b64_tr_b16 v[118:119], v249 offset:8704
  s_waitcnt lgkmcnt(12)
  v_mfma_f32_32x32x16_bf16 v[80:95], v[120:123], v[20:23], v[80:95]
  v_mfma_f32_32x32x16_bf16 v[96:111], v[124:127], v[20:23], v[96:111]
  v_mfma_f32_32x32x16_bf16 v[144:159], v[120:123], v[232:235], v[144:159]
  ds_read_b64_tr_b16 v[120:121], v248 offset:10240
  ds_read_b64_tr_b16 v[122:123], v248 offset:10752
  ds_read_b64_tr_b16 v[124:125], v249 offset:10240
  ds_read_b64_tr_b16 v[126:127], v249 offset:10752
  s_waitcnt lgkmcnt(12)
  v_mfma_f32_32x32x16_bf16 v[80:95], v[128:131], v[24:27], v[80:95]
  v_mfma_f32_32x32x16_bf16 v[96:111], v[132:135], v[24:27], v[96:111]
  v_mfma_f32_32x32x16_bf16 v[144:159], v[128:131], v[232:235], v[144:159]
  ds_read_b64_tr_b16 v[128:129], v248 offset:12288
  ds_read_b64_tr_b16 v[130:131], v248 offset:12800
  ds_read_b64_tr_b16 v[132:133], v249 offset:12288
  ds_read_b64_tr_b16 v[134:135], v249 offset:12800
  s_waitcnt lgkmcnt(12)
  v_mfma_f32_32x32x16_bf16 v[80:95], v[136:139], v[28:31], v[80:95]
  v_mfma_f32_32x32x16_bf16 v[96:111], v[140:143], v[28:31], v[96:111]
  v_mfma_f32_32x32x16_bf16 v[144:159], v[136:139], v[232:235], v[144:159]
  ds_read_b64_tr_b16 v[136:137], v248 offset:14336
  ds_read_b64_tr_b16 v[138:139], v248 offset:14848
  ds_read_b64_tr_b16 v[140:141], v249 offset:14336
  ds_read_b64_tr_b16 v[142:143], v249 offset:14848
  s_waitcnt lgkmcnt(12)
  v_mfma_f32_32x32x16_bf16 v[80:95], v[112:115], v[32:35], v[80:95]
  v_mfma_f32_32x32x16_bf16 v[96:111], v[116:119], v[32:35], v[96:111]
  v_mfma_f32_32x32x16_bf16 v[144:159], v[112:115], v[232:235], v[144:159]
  ds_read_b64_tr_b16 v[112:113], v248 offset:16384
  ds_read_b64_tr_b16 v[114:115], v248 offset:16896
  ds_read_b64_tr_b16 v[116:117], v249 offset:16384
  ds_read_b64_tr_b16 v[118:119], v249 offset:16896
  s_waitcnt lgkmcnt(12)
  v_mfma_f32_32x32x16_bf16 v[80:95], v[120:123], v[36:39], v[80:95]
  v_mfma_f32_32x32x16_bf16 v[96:111], v[124:127], v[36:39], v[96:111]
  v_mfma_f32_32x32x16_bf16 v[144:159], v[120:123], v[232:235], v[144:159]
  ds_read_b64_tr_b16 v[120:121], v248 offset:18432
  ds_read_b64_tr_b16 v[122:123], v248 offset:18944
  ds_read_b64_tr_b16 v[124:125], v249 offset:18432
  ds_read_b64_tr_b16 v[126:127], v249 offset:18944
  s_waitcnt lgkmcnt(12)
  v_mfma_f32_32x32x16_bf16 v[80:95], v[128:131], v[40:43], v[80:95]
  v_mfma_f32_32x32x16_bf16 v[96:111], v[132:135], v[40:43], v[96:111]
  v_mfma_f32_32x32x16_bf16 v[144:159], v[128:131], v[232:235], v[144:159]
  ds_read_b64_tr_b16 v[128:129], v248 offset:20480
  ds_read_b64_tr_b16 v[130:131], v248 offset:20992
  ds_read_b64_tr_b16 v[132:133], v249 offset:20480
  ds_read_b64_tr_b16 v[134:135], v249 offset:20992
  s_waitcnt lgkmcnt(12)
  v_mfma_f32_32x32x16_bf16 v[80:95], v[136:139], v[44:47], v[80:95]
  v_mfma_f32_32x32x16_bf16 v[96:111], v[140:143], v[44:47], v[96:111]
  v_mfma_f32_32x32x16_bf16 v[144:159], v[136:139], v[232:235], v[144:159]
  s_cmp_lg_u32 s20, 0
  s_cbranch_scc1 FKF_20
  s_lshl_b32 s44, s22, 11
  s_lshl_b32 s45, s26, 2
  s_add_u32 s44, s44, s45
  s_add_u32 s44, s44, 106496
  v_lshlrev_b32 v220, 8, v1
  v_mov_b32 v221, s21
  s_waitcnt vmcnt(0)
  s_mov_b64 exec, 0xff
  buffer_store_dword v221, v220, s[4:7], s44 offen sc1
  s_mov_b64 exec, -1
FKF_20:
  ds_read_b64_tr_b16 v[136:137], v248 offset:22528
  ds_read_b64_tr_b16 v[138:139], v248 offset:23040
  ds_read_b64_tr_b16 v[140:141], v249 offset:22528
  ds_read_b64_tr_b16 v[142:143], v249 offset:23040
  s_waitcnt lgkmcnt(12)
  v_mfma_f32_32x32x16_bf16 v[80:95], v[112:115], v[48:51], v[80:95]
  v_mfma_f32_32x32x16_bf16 v[96:111], v[116:119], v[48:51], v[96:111]
  v_mfma_f32_32x32x16_bf16 v[144:159], v[112:115], v[232:235], v[144:159]
  ds_read_b64_tr_b16 v[112:113], v248 offset:24576
  ds_read_b64_tr_b16 v[114:115], v248 offset:25088
  ds_read_b64_tr_b16 v[116:117], v249 offset:24576
  ds_read_b64_tr_b16 v[118:119], v249 offset:25088
  s_waitcnt lgkmcnt(12)
  v_mfma_f32_32x32x16_bf16 v[80:95], v[120:123], v[52:55], v[80:95]
  v_mfma_f32_32x32x16_bf16 v[96:111], v[124:127], v[52:55], v[96:111]
  v_mfma_f32_32x32x16_bf16 v[144:159], v[120:123], v[232:235], v[144:159]
  ds_read_b64_tr_b16 v[120:121], v248 offset:26624
  ds_read_b64_tr_b16 v[122:123], v248 offset:27136
  ds_read_b64_tr_b16 v[124:125], v249 offset:26624
  ds_read_b64_tr_b16 v[126:127], v249 offset:27136
  s_waitcnt lgkmcnt(12)
  v_mfma_f32_32x32x16_bf16 v[80:95], v[128:131], v[56:59], v[80:95]
  v_mfma_f32_32x32x16_bf16 v[96:111], v[132:135], v[56:59], v[96:111]
  v_mfma_f32_32x32x16_bf16 v[144:159], v[128:131], v[232:235], v[144:159]
  ds_read_b64_tr_b16 v[128:129], v248 offset:28672
  ds_read_b64_tr_b16 v[130:131], v248 offset:29184
  ds_read_b64_tr_b16 v[132:133], v249 offset:28672
  ds_read_b64_tr_b16 v[134:135], v249 offset:29184
  s_waitcnt lgkmcnt(12)
  v_mfma_f32_32x32x16_bf16 v[80:95], v[136:139], v[60:63], v[80:95]
  v_mfma_f32_32x32x16_bf16 v[96:111], v[140:143], v[60:63], v[96:111]
  v_mfma_f32_32x32x16_bf16 v[144:159], v[136:139], v[232:235], v[144:159]
  ds_read_b64_tr_b16 v[136:137], v248 offset:30720
  ds_read_b64_tr_b16 v[138:139], v248 offset:31232
  ds_read_b64_tr_b16 v[140:141], v249 offset:30720
  ds_read_b64_tr_b16 v[142:143], v249 offset:31232
  s_waitcnt lgkmcnt(12)
  v_mfma_f32_32x32x16_bf16 v[80:95], v[112:115], v[64:67], v[80:95]
  v_mfma_f32_32x32x16_bf16 v[96:111], v[116:119], v[64:67], v[96:111]
  v_mfma_f32_32x32x16_bf16 v[144:159], v[112:115], v[232:235], v[144:159]
  s_waitcnt lgkmcnt(8)
  v_mfma_f32_32x32x16_bf16 v[80:95], v[120:123], v[68:71], v[80:95]
  v_mfma_f32_32x32x16_bf16 v[96:111], v[124:127], v[68:71], v[96:111]
  v_mfma_f32_32x32x16_bf16 v[144:159], v[120:123], v[232:235], v[144:159]
  s_waitcnt lgkmcnt(4)
  v_mfma_f32_32x32x16_bf16 v[80:95], v[128:131], v[72:75], v[80:95]
  v_mfma_f32_32x32x16_bf16 v[96:111], v[132:135], v[72:75], v[96:111]
  v_mfma_f32_32x32x16_bf16 v[144:159], v[128:131], v[232:235], v[144:159]
  s_waitcnt lgkmcnt(0)
  v_mfma_f32_32x32x16_bf16 v[80:95], v[136:139], v[76:79], v[80:95]
  v_mfma_f32_32x32x16_bf16 v[96:111], v[140:143], v[76:79], v[96:111]
  v_mfma_f32_32x32x16_bf16 v[144:159], v[136:139], v[232:235], v[144:159]
  s_branch FQPD_19
FQP1_18:
  ds_read_b64_tr_b16 v[112:113], v248 offset:0
  ds_read_b64_tr_b16 v[114:115], v248 offset:512
  ds_read_b64_tr_b16 v[116:117], v249 offset:0
  ds_read_b64_tr_b16 v[118:119], v249 offset:512
  ds_read_b64_tr_b16 v[120:121], v248 offset:2048
  ds_read_b64_tr_b16 v[122:123], v248 offset:2560
  ds_read_b64_tr_b16 v[124:125], v249 offset:2048
  ds_read_b64_tr_b16 v[126:127], v249 offset:2560
  ds_read_b64_tr_b16 v[128:129], v248 offset:4096
  ds_read_b64_tr_b16 v[130:131], v248 offset:4608
  ds_read_b64_tr_b16 v[132:133], v249 offset:4096
  ds_read_b64_tr_b16 v[134:135], v249 offset:4608
  ds_read_b64_tr_b16 v[136:137], v248 offset:6144
  ds_read_b64_tr_b16 v[138:139], v248 offset:6656
  ds_read_b64_tr_b16 v[140:141], v249 offset:6144
  ds_read_b64_tr_b16 v[142:143], v249 offset:6656
  s_waitcnt lgkmcnt(12)
  v_mfma_f32_32x32x16_bf16 v[80:95], v[112:115], v[16:19], 0
  v_mfma_f32_32x32x16_bf16 v[96:111], v[116:119], v[16:19], 0
  v_mfma_f32_32x32x16_bf16 v[144:159], v[116:119], v[232:235], 0
  ds_read_b64_tr_b16 v[112:113], v248 offset:8192
  ds_read_b64_tr_b16 v[114:115], v248 offset:8704
  ds_read_b64_tr_b16 v[116:117], v249 offset:8192
  ds_read_b64_tr_b16 v[118:119], v249 offset:8704
  s_waitcnt lgkmcnt(12)
  v_mfma_f32_32x32x16_bf16 v[80:95], v[120:123], v[20:23], v[80:95]
  v_mfma_f32_32x32x16_bf16 v[96:111], v[124:127], v[20:23], v[96:111]
  v_mfma_f32_32x32x16_bf16 v[144:159], v[124:127], v[232:235], v[144:159]
  ds_read_b64_tr_b16 v[120:121], v248 offset:10240
  ds_read_b64_tr_b16 v[122:123], v248 offset:10752
  ds_read_b64_tr_b16 v[124:125], v249 offset:10240
  ds_read_b64_tr_b16 v[126:127], v249 offset:10752
  s_waitcnt lgkmcnt(12)
  v_mfma_f32_32x32x16_bf16 v[80:95], v[128:131], v[24:27], v[80:95]
  v_mfma_f32_32x32x16_bf16 v[96:111], v[132:135], v[24:27], v[96:111]
  v_mfma_f32_32x32x16_bf16 v[144:159], v[132:135], v[232:235], v[144:159]
  ds_read_b64_tr_b16 v[128:129], v248 offset:12288
  ds_read_b64_tr_b16 v[130:131], v248 offset:12800
  ds_read_b64_tr_b16 v[132:133], v249 offset:12288
  ds_read_b64_tr_b16 v[134:135], v249 offset:12800
  s_waitcnt lgkmcnt(12)
  v_mfma_f32_32x32x16_bf16 v[80:95], v[136:139], v[28:31], v[80:95]
  v_mfma_f32_32x32x16_bf16 v[96:111], v[140:143], v[28:31], v[96:111]
  v_mfma_f32_32x32x16_bf16 v[144:159], v[140:143], v[232:235], v[144:159]
  ds_read_b64_tr_b16 v[136:137], v248 offset:14336
  ds_read_b64_tr_b16 v[138:139], v248 offset:14848
  ds_read_b64_tr_b16 v[140:141], v249 offset:14336
  ds_read_b64_tr_b16 v[142:143], v249 offset:14848
  s_waitcnt lgkmcnt(12)
  v_mfma_f32_32x32x16_bf16 v[80:95], v[112:115], v[32:35], v[80:95]
  v_mfma_f32_32x32x16_bf16 v[96:111], v[116:119], v[32:35], v[96:111]
  v_mfma_f32_32x32x16_bf16 v[144:159], v[116:119], v[232:235], v[144:159]
  ds_read_b64_tr_b16 v[112:113], v248 offset:16384
  ds_read_b64_tr_b16 v[114:115], v248 offset:16896
  ds_read_b64_tr_b16 v[116:117], v249 offset:16384
  ds_read_b64_tr_b16 v[118:119], v249 offset:16896
  s_waitcnt lgkmcnt(12)
  v_mfma_f32_32x32x16_bf16 v[80:95], v[120:123], v[36:39], v[80:95]
  v_mfma_f32_32x32x16_bf16 v[96:111], v[124:127], v[36:39], v[96:111]
  v_mfma_f32_32x32x16_bf16 v[144:159], v[124:127], v[232:235], v[144:159]
  ds_read_b64_tr_b16 v[120:121], v248 offset:18432
  ds_read_b64_tr_b16 v[122:123], v248 offset:18944
  ds_read_b64_tr_b16 v[124:125], v249 offset:18432
  ds_read_b64_tr_b16 v[126:127], v249 offset:18944
  s_waitcnt lgkmcnt(12)
  v_mfma_f32_32x32x16_bf16 v[80:95], v[128:131], v[40:43], v[80:95]
  v_mfma_f32_32x32x16_bf16 v[96:111], v[132:135], v[40:43], v[96:111]
  v_mfma_f32_32x32x16_bf16 v[144:159], v[132:135], v[232:235], v[144:159]
  ds_read_b64_tr_b16 v[128:129], v248 offset:20480
  ds_read_b64_tr_b16 v[130:131], v248 offset:20992
  ds_read_b64_tr_b16 v[132:133], v249 offset:20480
  ds_read_b64_tr_b16 v[134:135], v249 offset:20992
  s_waitcnt lgkmcnt(12)
  v_mfma_f32_32x32x16_bf16 v[80:95], v[136:139], v[44:47], v[80:95]
  v_mfma_f32_32x32x16_bf16 v[96:111], v[140:143], v[44:47], v[96:111]
  v_mfma_f32_32x32x16_bf16 v[144:159], v[140:143], v[232:235], v[144:159]
  s_cmp_lg_u32 s20, 0
  s_cbranch_scc1 FKF_21
  s_lshl_b32 s44, s22, 11
  s_lshl_b32 s45, s26, 2
  s_add_u32 s44, s44, s45
  s_add_u32 s44, s44, 106496
  v_lshlrev_b32 v220, 8, v1
  v_mov_b32 v221, s21
  s_waitcnt vmcnt(0)
  s_mov_b64 exec, 0xff
  buffer_store_dword v221, v220, s[4:7], s44 offen sc1
  s_mov_b64 exec, -1
FKF_21:
  ds_read_b64_tr_b16 v[136:137], v248 offset:22528
  ds_read_b64_tr_b16 v[138:139], v248 offset:23040
  ds_read_b64_tr_b16 v[140:141], v249 offset:22528
  ds_read_b64_tr_b16 v[142:143], v249 offset:23040
  s_waitcnt lgkmcnt(12)
  v_mfma_f32_32x32x16_bf16 v[80:95], v[112:115], v[48:51], v[80:95]
  v_mfma_f32_32x32x16_bf16 v[96:111], v[116:119], v[48:51], v[96:111]
  v_mfma_f32_32x32x16_bf16 v[144:159], v[116:119], v[232:235], v[144:159]
  ds_read_b64_tr_b16 v[112:113], v248 offset:24576
  ds_read_b64_tr_b16 v[114:115], v248 offset:25088
  ds_read_b64_tr_b16 v[116:117], v249 offset:24576
  ds_read_b64_tr_b16 v[118:119], v249 offset:25088
  s_waitcnt lgkmcnt(12)
  v_mfma_f32_32x32x16_bf16 v[80:95], v[120:123], v[52:55], v[80:95]
  v_mfma_f32_32x32x16_bf16 v[96:111], v[124:127], v[52:55], v[96:111]
  v_mfma_f32_32x32x16_bf16 v[144:159], v[124:127], v[232:235], v[144:159]
  ds_read_b64_tr_b16 v[120:121], v248 offset:26624
  ds_read_b64_tr_b16 v[122:123], v248 offset:27136
  ds_read_b64_tr_b16 v[124:125], v249 offset:26624
  ds_read_b64_tr_b16 v[126:127], v249 offset:27136
  s_waitcnt lgkmcnt(12)
  v_mfma_f32_32x32x16_bf16 v[80:95], v[128:131], v[56:59], v[80:95]
  v_mfma_f32_32x32x16_bf16 v[96:111], v[132:135], v[56:59], v[96:111]
  v_mfma_f32_32x32x16_bf16 v[144:159], v[132:135], v[232:235], v[144:159]
  ds_read_b64_tr_b16 v[128:129], v248 offset:28672
  ds_read_b64_tr_b16 v[130:131], v248 offset:29184
  ds_read_b64_tr_b16 v[132:133], v249 offset:28672
  ds_read_b64_tr_b16 v[134:135], v249 offset:29184
  s_waitcnt lgkmcnt(12)
  v_mfma_f32_32x32x16_bf16 v[80:95], v[136:139], v[60:63], v[80:95]
  v_mfma_f32_32x32x16_bf16 v[96:111], v[140:143], v[60:63], v[96:111]
  v_mfma_f32_32x32x16_bf16 v[144:159], v[140:143], v[232:235], v[144:159]
  ds_read_b64_tr_b16 v[136:137], v248 offset:30720
  ds_read_b64_tr_b16 v[138:139], v248 offset:31232
  ds_read_b64_tr_b16 v[140:141], v249 offset:30720
  ds_read_b64_tr_b16 v[142:143], v249 offset:31232
  s_waitcnt lgkmcnt(12)
  v_mfma_f32_32x32x16_bf16 v[80:95], v[112:115], v[64:67], v[80:95]
  v_mfma_f32_32x32x16_bf16 v[96:111], v[116:119], v[64:67], v[96:111]
  v_mfma_f32_32x32x16_bf16 v[144:159], v[116:119], v[232:235], v[144:159]
  s_waitcnt lgkmcnt(8)
  v_mfma_f32_32x32x16_bf16 v[80:95], v[120:123], v[68:71], v[80:95]
  v_mfma_f32_32x32x16_bf16 v[96:111], v[124:127], v[68:71], v[96:111]
  v_mfma_f32_32x32x16_bf16 v[144:159], v[124:127], v[232:235], v[144:159]
  s_waitcnt lgkmcnt(4)
  v_mfma_f32_32x32x16_bf16 v[80:95], v[128:131], v[72:75], v[80:95]
  v_mfma_f32_32x32x16_bf16 v[96:111], v[132:135], v[72:75], v[96:111]
  v_mfma_f32_32x32x16_bf16 v[144:159], v[132:135], v[232:235], v[144:159]
  s_waitcnt lgkmcnt(0)
  v_mfma_f32_32x32x16_bf16 v[80:95], v[136:139], v[76:79], v[80:95]
  v_mfma_f32_32x32x16_bf16 v[96:111], v[140:143], v[76:79], v[96:111]
  v_mfma_f32_32x32x16_bf16 v[144:159], v[140:143], v[232:235], v[144:159]
FQPD_19:
  s_xor_b32 s41, s20, s19
  s_lshl_b32 s41, s41, 8
  s_lshl_b32 s42, s20, 7
  s_add_u32 s41, s41, s42
  s_add_u32 s41, s41, 145408
  v_lshrrev_b32 v228, 5, v1
  v_lshlrev_b32 v228, 4, v228
  v_add_u32 v228, s41, v228
  s_mov_b32 exec_lo, 1
  s_mov_b32 exec_hi, 1
  s_nop 1
  ds_write_b128 v228, v[144:147] offset:0
  ds_write_b128 v228, v[148:151] offset:32
  ds_write_b128 v228, v[152:155] offset:64
  ds_write_b128 v228, v[156:159] offset:96
  s_mov_b64 exec, -1
  s_waitcnt vmcnt(0)
  s_branch FRED_12
FNKW_9:
  s_cmp_ge_u32 s57, 97
  s_cbranch_scc1 FW0_22
  s_waitcnt vmcnt(36)
  s_lshl_b32 s40, s18, 13
  s_add_u32 s40, s40, 131072
  v_add_u32 v17, s40, v2
  ds_write_b128 v17, a[0:3] offset:0
  ds_write_b128 v17, a[4:7] offset:1024
  ds_write_b128 v17, a[8:11] offset:2048
  ds_write_b128 v17, a[12:15] offset:3072
  ds_write_b128 v17, a[16:19] offset:4096
  ds_write_b128 v17, a[20:23] offset:5120
  ds_write_b128 v17, a[24:27] offset:6144
  ds_write_b128 v17, a[28:31] offset:7168
  v_and_b32 v18, 15, v1
  v_lshrrev_b32 v19, 2, v18
  v_lshrrev_b32 v20, 5, v1
  v_lshl_add_u32 v19, v20, 2, v19
  v_lshlrev_b32 v19, 6, v19
  v_and_b32 v20, 3, v18
  v_lshl_add_u32 v19, v20, 3, v19
  v_bfe_u32 v20, v1, 4, 1
  v_lshl_add_u32 v19, v20, 5, v19
  v_add_u32 v19, s40, v19
  s_waitcnt lgkmcnt(0)
  ds_read_b64_tr_b16 v[32:33], v19 offset:0
  ds_read_b64_tr_b16 v[34:35], v19 offset:512
  ds_read_b64_tr_b16 v[36:37], v19 offset:1024
  ds_read_b64_tr_b16 v[38:39], v19 offset:1536
  ds_read_b64_tr_b16 v[40:41], v19 offset:2048
  ds_read_b64_tr_b16 v[42:43], v19 offset:2560
  ds_read_b64_tr_b16 v[44:45], v19 offset:3072
  ds_read_b64_tr_b16 v[46:47], v19 offset:3584
  ds_read_b64_tr_b16 v[48:49], v19 offset:4096
  ds_read_b64_tr_b16 v[50:51], v19 offset:4608
  ds_read_b64_tr_b16 v[52:53], v19 offset:5120
  ds_read_b64_tr_b16 v[54:55], v19 offset:5632
  ds_read_b64_tr_b16 v[56:57], v19 offset:6144
  ds_read_b64_tr_b16 v[58:59], v19 offset:6656
  ds_read_b64_tr_b16 v[60:61], v19 offset:7168
  ds_read_b64_tr_b16 v[62:63], v19 offset:7680
  s_lshl_b32 s42, s57, 15
  s_lshl_b32 s41, s18, 13
  s_add_u32 s42, s42, s41
  s_add_u32 s42, s42, 1048576
  s_add_u32 s41, s42, 4096
  v_mov_b32 v16, 0x3f803f80
  v_mov_b32 v17, 0
  s_waitcnt lgkmcnt(0)
  buffer_store_dwordx4 v[32:35], v2, s[4:7], s42 offen offset:0 sc1
  buffer_store_dwordx4 v[36:39], v2, s[4:7], s42 offen offset:1024 sc1
  buffer_store_dwordx4 v[40:43], v2, s[4:7], s42 offen offset:2048 sc1
  buffer_store_dwordx4 v[44:47], v2, s[4:7], s42 offen offset:3072 sc1
  buffer_store_dwordx4 v[48:51], v2, s[4:7], s41 offen offset:0 sc1
  buffer_store_dwordx4 v[52:55], v2, s[4:7], s41 offen offset:1024 sc1
  buffer_store_dwordx4 v[56:59], v2, s[4:7], s41 offen offset:2048 sc1
  buffer_store_dwordx4 v[60:63], v2, s[4:7], s41 offen offset:3072 sc1
  v_mov_b32 v21, 0
  v_mov_b32 v22, 0
  v_mov_b32 v23, 0
  v_dot2c_f32_bf16 v17, v16, v32
  v_dot2c_f32_bf16 v21, v16, v33
  v_dot2c_f32_bf16 v22, v16, v34
  v_dot2c_f32_bf16 v23, v16, v35
  v_dot2c_f32_bf16 v17, v16, v36
  v_dot2c_f32_bf16 v21, v16, v37
  v_dot2c_f32_bf16 v22, v16, v38
  v_dot2c_f32_bf16 v23, v16, v39
  v_dot2c_f32_bf16 v17, v16, v40
  v_dot2c_f32_bf16 v21, v16, v41
  v_dot2c_f32_bf16 v22, v16, v42
  v_dot2c_f32_bf16 v23, v16, v43
  v_dot2c_f32_bf16 v17, v16, v44
  v_dot2c_f32_bf16 v21, v16, v45
  v_dot2c_f32_bf16 v22, v16, v46
  v_dot2c_f32_bf16 v23, v16, v47
  v_dot2c_f32_bf16 v17, v16, v48
  v_dot2c_f32_bf16 v21, v16, v49
  v_dot2c_f32_bf16 v22, v16, v50
  v_dot2c_f32_bf16 v23, v16, v51
  v_dot2c_f32_bf16 v17, v16, v52
  v_dot2c_f32_bf16 v21, v16, v53
  v_dot2c_f32_bf16 v22, v16, v54
  v_dot2c_f32_bf16 v23, v16, v55
  v_dot2c_f32_bf16 v17, v16, v56
  v_dot2c_f32_bf16 v21, v16, v57
  v_dot2c_f32_bf16 v22, v16, v58
  v_dot2c_f32_bf16 v23, v16, v59
  v_dot2c_f32_bf16 v17, v16, v60
  v_dot2c_f32_bf16 v21, v16, v61
  v_dot2c_f32_bf16 v22, v16, v62
  v_dot2c_f32_bf16 v23, v16, v63
  s_nop 1
  v_add_f32 v21, v21, v22
  v_add_f32 v17, v17, v23
  v_add_f32 v17, v17, v21
  v_mov_b32 v18, v17
  s_nop 1
  v_permlane32_swap_b32 v17, v18
  v_add_f32 v17, v17, v18
  v_add_u32 v18, s40, v3
  ds_write_b32 v18, v17
  s_waitcnt lgkmcnt(0)
  s_barrier
  s_cmp_lg_u32 s18, 0
  s_cbranch_scc1 FPCS_24
  v_add_u32 v18, 131072, v3
  ds_read_b32 v20, v18
  ds_read_b32 v21, v18 offset:8192
  ds_read_b32 v22, v18 offset:16384
  ds_read_b32 v23, v18 offset:24576
  s_waitcnt lgkmcnt(0)
  v_add_f32 v20, v20, v21
  v_add_f32 v22, v22, v23
  v_add_f32 v20, v20, v22
  s_lshl_b32 s40, s57, 7
  s_add_u32 s40, s40, 4718592
  s_mov_b32 exec_hi, 0
  buffer_store_dword v20, v3, s[4:7], s40 offen sc1
  s_mov_b64 exec, -1
FPCS_24:
  s_cmp_eq_u32 s18, 0
  s_cbranch_scc1 FW2_25
  s_waitcnt vmcnt(8)
  s_branch FW1_23
FW2_25:
  s_waitcnt vmcnt(9)
  s_branch FW1_23
FW0_22:
  s_waitcnt vmcnt(0)
FW1_23:
  v_readfirstlane_b32 s21, v231
  s_nop 1
  s_mul_i32 s21, s21, 0x9E3779B1
  s_add_u32 s21, s21, 0x7F4A7C15
  s_cmp_lg_u32 s18, 0
  s_cbranch_scc1 XW_26
  s_add_u32 s40, s21, s3
  s_add_u32 s40, s40, 16
  v_mov_b32 v14, s40
  s_lshl_b32 s41, s16, 3
  s_add_u32 s41, s41, s17
  s_lshl_b32 s41, s41, 2
  s_add_u32 s41, s41, 114688
  v_mov_b32 v15, 0
  s_mov_b64 exec, 1
  buffer_store_dword v14, v15, s[4:7], s41 offen sc1
  s_mov_b64 exec, -1
XW_26:
  s_barrier
FQS_10:
  ds_read_b128 v[16:19], v240 offset:0
  ds_read_b128 v[20:23], v241 offset:0
  ds_read_b128 v[24:27], v242 offset:0
  ds_read_b128 v[28:31], v243 offset:0
  ds_read_b128 v[32:35], v244 offset:0
  ds_read_b128 v[36:39], v245 offset:0
  ds_read_b128 v[40:43], v246 offset:0
  ds_read_b128 v[44:47], v247 offset:0
  ds_read_b128 v[48:51], v240 offset:256
  ds_read_b128 v[52:55], v241 offset:256
  ds_read_b128 v[56:59], v242 offset:256
  ds_read_b128 v[60:63], v243 offset:256
  ds_read_b128 v[64:67], v244 offset:256
  ds_read_b128 v[68:71], v245 offset:256
  ds_read_b128 v[72:75], v246 offset:256
  ds_read_b128 v[76:79], v247 offset:256
  v_mov_b32 v229, 0x3f803f80
  v_mov_b32 v224, 0
  v_mov_b32 v225, 0
  v_mov_b32 v226, 0
  v_mov_b32 v236, 0
  v_mov_b32 v237, 0
  v_mov_b32 v238, 0
  s_waitcnt lgkmcnt(0)
  v_mov_b32 v232, 0x3f803f80
  v_mov_b32 v233, 0x3f803f80
  v_mov_b32 v234, 0x3f803f80
  v_mov_b32 v235, 0x3f803f80
  v_dot2c_f32_bf16 v224, v229, v16
  v_dot2c_f32_bf16 v225, v16, v16
  v_dot2c_f32_bf16 v236, v229, v17
  v_dot2c_f32_bf16 v237, v17, v17
  v_dot2c_f32_bf16 v224, v229, v18
  v_dot2c_f32_bf16 v225, v18, v18
  v_dot2c_f32_bf16 v236, v229, v19
  v_dot2c_f32_bf16 v237, v19, v19
  v_dot2c_f32_bf16 v224, v229, v20
  v_dot2c_f32_bf16 v225, v20, v20
  v_dot2c_f32_bf16 v236, v229, v21
  v_dot2c_f32_bf16 v237, v21, v21
  v_dot2c_f32_bf16 v224, v229, v22
  v_dot2c_f32_bf16 v225, v22, v22
  v_dot2c_f32_bf16 v236, v229, v23
  v_dot2c_f32_bf16 v237, v23, v23
  v_dot2c_f32_bf16 v224, v229, v24
  v_dot2c_f32_bf16 v225, v24, v24
  v_dot2c_f32_bf16 v236, v229, v25
  v_dot2c_f32_bf16 v237, v25, v25
  v_dot2c_f32_bf16 v224, v229, v26
  v_dot2c_f32_bf16 v225, v26, v26
  v_dot2c_f32_bf16 v236, v229, v27
  v_dot2c_f32_bf16 v237, v27, v27
  v_dot2c_f32_bf16 v224, v229, v28
  v_dot2c_f32_bf16 v225, v28, v28
  v_dot2c_f32_bf16 v236, v229, v29
  v_dot2c_f32_bf16 v237, v29, v29
  v_dot2c_f32_bf16 v224, v229, v30
  v_dot2c_f32_bf16 v225, v30, v30
  v_dot2c_f32_bf16 v236, v229, v31
  v_dot2c_f32_bf16 v237, v31, v31
  v_dot2c_f32_bf16 v224, v229, v32
  v_dot2c_f32_bf16 v225, v32, v32
  v_dot2c_f32_bf16 v236, v229, v33
  v_dot2c_f32_bf16 v237, v33, v33
  v_dot2c_f32_bf16 v224, v229, v34
  v_dot2c_f32_bf16 v225, v34, v34
  v_dot2c_f32_bf16 v236, v229, v35
  v_dot2c_f32_bf16 v237, v35, v35
  v_dot2c_f32_bf16 v224, v229, v36
  v_dot2c_f32_bf16 v225, v36, v36
  v_dot2c_f32_bf16 v236, v229, v37
  v_dot2c_f32_bf16 v237, v37, v37
  v_dot2c_f32_bf16 v224, v229, v38
  v_dot2c_f32_bf16 v225, v38, v38
  v_dot2c_f32_bf16 v236, v229, v39
  v_dot2c_f32_bf16 v237, v39, v39
  v_dot2c_f32_bf16 v224, v229, v40
  v_dot2c_f32_bf16 v225, v40, v40
  v_dot2c_f32_bf16 v236, v229, v41
  v_dot2c_f32_bf16 v237, v41, v41
  v_dot2c_f32_bf16 v224, v229, v42
  v_dot2c_f32_bf16 v225, v42, v42
  v_dot2c_f32_bf16 v236, v229, v43
  v_dot2c_f32_bf16 v237, v43, v43
  v_dot2c_f32_bf16 v224, v229, v44
  v_dot2c_f32_bf16 v225, v44, v44
  v_dot2c_f32_bf16 v236, v229, v45
  v_dot2c_f32_bf16 v237, v45, v45
  v_dot2c_f32_bf16 v224, v229, v46
  v_dot2c_f32_bf16 v225, v46, v46
  v_dot2c_f32_bf16 v236, v229, v47
  v_dot2c_f32_bf16 v237, v47, v47
  v_dot2c_f32_bf16 v224, v229, v48
  v_dot2c_f32_bf16 v225, v48, v48
  v_dot2c_f32_bf16 v236, v229, v49
  v_dot2c_f32_bf16 v237, v49, v49
  v_dot2c_f32_bf16 v224, v229, v50
  v_dot2c_f32_bf16 v225, v50, v50
  v_dot2c_f32_bf16 v236, v229, v51
  v_dot2c_f32_bf16 v237, v51, v51
  v_dot2c_f32_bf16 v224, v229, v52
  v_dot2c_f32_bf16 v225, v52, v52
  v_dot2c_f32_bf16 v236, v229, v53
  v_dot2c_f32_bf16 v237, v53, v53
  v_dot2c_f32_bf16 v224, v229, v54
  v_dot2c_f32_bf16 v225, v54, v54
  v_dot2c_f32_bf16 v236, v229, v55
  v_dot2c_f32_bf16 v237, v55, v55
  v_dot2c_f32_bf16 v224, v229, v56
  v_dot2c_f32_bf16 v225, v56, v56
  v_dot2c_f32_bf16 v236, v229, v57
  v_dot2c_f32_bf16 v237, v57, v57
  v_dot2c_f32_bf16 v224, v229, v58
  v_dot2c_f32_bf16 v225, v58, v58
  v_dot2c_f32_bf16 v236, v229, v59
  v_dot2c_f32_bf16 v237, v59, v59
  v_dot2c_f32_bf16 v224, v229, v60
  v_dot2c_f32_bf16 v225, v60, v60
  v_dot2c_f32_bf16 v236, v229, v61
  v_dot2c_f32_bf16 v237, v61, v61
  v_dot2c_f32_bf16 v224, v229, v62
  v_dot2c_f32_bf16 v225, v62, v62
  v_dot2c_f32_bf16 v236, v229, v63
  v_dot2c_f32_bf16 v237, v63, v63
  v_dot2c_f32_bf16 v224, v229, v64
  v_dot2c_f32_bf16 v225, v64, v64
  v_dot2c_f32_bf16 v236, v229, v65
  v_dot2c_f32_bf16 v237, v65, v65
  v_dot2c_f32_bf16 v224, v229, v66
  v_dot2c_f32_bf16 v225, v66, v66
  v_dot2c_f32_bf16 v236, v229, v67
  v_dot2c_f32_bf16 v237, v67, v67
  v_dot2c_f32_bf16 v224, v229, v68
  v_dot2c_f32_bf16 v225, v68, v68
  v_dot2c_f32_bf16 v236, v229, v69
  v_dot2c_f32_bf16 v237, v69, v69
  v_dot2c_f32_bf16 v224, v229, v70
  v_dot2c_f32_bf16 v225, v70, v70
  v_dot2c_f32_bf16 v236, v229, v71
  v_dot2c_f32_bf16 v237, v71, v71
  v_dot2c_f32_bf16 v224, v229, v72
  v_dot2c_f32_bf16 v225, v72, v72
  v_dot2c_f32_bf16 v236, v229, v73
  v_dot2c_f32_bf16 v237, v73, v73
  v_dot2c_f32_bf16 v224, v229, v74
  v_dot2c_f32_bf16 v225, v74, v74
  v_dot2c_f32_bf16 v236, v229, v75
  v_dot2c_f32_bf16 v237, v75, v75
  v_dot2c_f32_bf16 v224, v229, v76
  v_dot2c_f32_bf16 v225, v76, v76
  v_dot2c_f32_bf16 v236, v229, v77
  v_dot2c_f32_bf16 v237, v77, v77
  v_dot2c_f32_bf16 v224, v229, v78
  v_dot2c_f32_bf16 v225, v78, v78
  v_dot2c_f32_bf16 v236, v229, v79
  v_dot2c_f32_bf16 v237, v79, v79
  s_cmp_eq_u32 s19, 1
  s_cbranch_scc1 FQP1_27
  ds_read_b64_tr_b16 v[112:113], v248 offset:0
  ds_read_b64_tr_b16 v[114:115], v248 offset:512
  ds_read_b64_tr_b16 v[116:117], v249 offset:0
  ds_read_b64_tr_b16 v[118:119], v249 offset:512
  ds_read_b64_tr_b16 v[120:121], v248 offset:2048
  ds_read_b64_tr_b16 v[122:123], v248 offset:2560
  ds_read_b64_tr_b16 v[124:125], v249 offset:2048
  ds_read_b64_tr_b16 v[126:127], v249 offset:2560
  ds_read_b64_tr_b16 v[128:129], v248 offset:4096
  ds_read_b64_tr_b16 v[130:131], v248 offset:4608
  ds_read_b64_tr_b16 v[132:133], v249 offset:4096
  ds_read_b64_tr_b16 v[134:135], v249 offset:4608
  ds_read_b64_tr_b16 v[136:137], v248 offset:6144
  ds_read_b64_tr_b16 v[138:139], v248 offset:6656
  ds_read_b64_tr_b16 v[140:141], v249 offset:6144
  ds_read_b64_tr_b16 v[142:143], v249 offset:6656
  s_waitcnt lgkmcnt(12)
  v_mfma_f32_32x32x16_bf16 v[80:95], v[112:115], v[16:19], 0
  v_mfma_f32_32x32x16_bf16 v[96:111], v[116:119], v[16:19], 0
  v_mfma_f32_32x32x16_bf16 v[144:159], v[112:115], v[232:235], 0
  ds_read_b64_tr_b16 v[112:113], v248 offset:8192
  ds_read_b64_tr_b16 v[114:115], v248 offset:8704
  ds_read_b64_tr_b16 v[116:117], v249 offset:8192
  ds_read_b64_tr_b16 v[118:119], v249 offset:8704
  s_waitcnt lgkmcnt(12)
  v_mfma_f32_32x32x16_bf16 v[80:95], v[120:123], v[20:23], v[80:95]
  v_mfma_f32_32x32x16_bf16 v[96:111], v[124:127], v[20:23], v[96:111]
  v_mfma_f32_32x32x16_bf16 v[144:159], v[120:123], v[232:235], v[144:159]
  ds_read_b64_tr_b16 v[120:121], v248 offset:10240
  ds_read_b64_tr_b16 v[122:123], v248 offset:10752
  ds_read_b64_tr_b16 v[124:125], v249 offset:10240
  ds_read_b64_tr_b16 v[126:127], v249 offset:10752
  s_waitcnt lgkmcnt(12)
  v_mfma_f32_32x32x16_bf16 v[80:95], v[128:131], v[24:27], v[80:95]
  v_mfma_f32_32x32x16_bf16 v[96:111], v[132:135], v[24:27], v[96:111]
  v_mfma_f32_32x32x16_bf16 v[144:159], v[128:131], v[232:235], v[144:159]
  ds_read_b64_tr_b16 v[128:129], v248 offset:12288
  ds_read_b64_tr_b16 v[130:131], v248 offset:12800
  ds_read_b64_tr_b16 v[132:133], v249 offset:12288
  ds_read_b64_tr_b16 v[134:135], v249 offset:12800
  s_waitcnt lgkmcnt(12)
  v_mfma_f32_32x32x16_bf16 v[80:95], v[136:139], v[28:31], v[80:95]
  v_mfma_f32_32x32x16_bf16 v[96:111], v[140:143], v[28:31], v[96:111]
  v_mfma_f32_32x32x16_bf16 v[144:159], v[136:139], v[232:235], v[144:159]
  ds_read_b64_tr_b16 v[136:137], v248 offset:14336
  ds_read_b64_tr_b16 v[138:139], v248 offset:14848
  ds_read_b64_tr_b16 v[140:141], v249 offset:14336
  ds_read_b64_tr_b16 v[142:143], v249 offset:14848
  s_waitcnt lgkmcnt(12)
  v_mfma_f32_32x32x16_bf16 v[80:95], v[112:115], v[32:35], v[80:95]
  v_mfma_f32_32x32x16_bf16 v[96:111], v[116:119], v[32:35], v[96:111]
  v_mfma_f32_32x32x16_bf16 v[144:159], v[112:115], v[232:235], v[144:159]
  ds_read_b64_tr_b16 v[112:113], v248 offset:16384
  ds_read_b64_tr_b16 v[114:115], v248 offset:16896
  ds_read_b64_tr_b16 v[116:117], v249 offset:16384
  ds_read_b64_tr_b16 v[118:119], v249 offset:16896
  s_waitcnt lgkmcnt(12)
  v_mfma_f32_32x32x16_bf16 v[80:95], v[120:123], v[36:39], v[80:95]
  v_mfma_f32_32x32x16_bf16 v[96:111], v[124:127], v[36:39], v[96:111]
  v_mfma_f32_32x32x16_bf16 v[144:159], v[120:123], v[232:235], v[144:159]
  ds_read_b64_tr_b16 v[120:121], v248 offset:18432
  ds_read_b64_tr_b16 v[122:123], v248 offset:18944
  ds_read_b64_tr_b16 v[124:125], v249 offset:18432
  ds_read_b64_tr_b16 v[126:127], v249 offset:18944
  s_waitcnt lgkmcnt(12)
  v_mfma_f32_32x32x16_bf16 v[80:95], v[128:131], v[40:43], v[80:95]
  v_mfma_f32_32x32x16_bf16 v[96:111], v[132:135], v[40:43], v[96:111]
  v_mfma_f32_32x32x16_bf16 v[144:159], v[128:131], v[232:235], v[144:159]
  ds_read_b64_tr_b16 v[128:129], v248 offset:20480
  ds_read_b64_tr_b16 v[130:131], v248 offset:20992
  ds_read_b64_tr_b16 v[132:133], v249 offset:20480
  ds_read_b64_tr_b16 v[134:135], v249 offset:20992
  s_waitcnt lgkmcnt(12)
  v_mfma_f32_32x32x16_bf16 v[80:95], v[136:139], v[44:47], v[80:95]
  v_mfma_f32_32x32x16_bf16 v[96:111], v[140:143], v[44:47], v[96:111]
  v_mfma_f32_32x32x16_bf16 v[144:159], v[136:139], v[232:235], v[144:159]
  ds_read_b64_tr_b16 v[136:137], v248 offset:22528
  ds_read_b64_tr_b16 v[138:139], v248 offset:23040
  ds_read_b64_tr_b16 v[140:141], v249 offset:22528
  ds_read_b64_tr_b16 v[142:143], v249 offset:23040
  s_waitcnt lgkmcnt(12)
  v_mfma_f32_32x32x16_bf16 v[80:95], v[112:115], v[48:51], v[80:95]
  v_mfma_f32_32x32x16_bf16 v[96:111], v[116:119], v[48:51], v[96:111]
  v_mfma_f32_32x32x16_bf16 v[144:159], v[112:115], v[232:235], v[144:159]
  ds_read_b64_tr_b16 v[112:113], v248 offset:24576
  ds_read_b64_tr_b16 v[114:115], v248 offset:25088
  ds_read_b64_tr_b16 v[116:117], v249 offset:24576
  ds_read_b64_tr_b16 v[118:119], v249 offset:25088
  s_waitcnt lgkmcnt(12)
  v_mfma_f32_32x32x16_bf16 v[80:95], v[120:123], v[52:55], v[80:95]
  v_mfma_f32_32x32x16_bf16 v[96:111], v[124:127], v[52:55], v[96:111]
  v_mfma_f32_32x32x16_bf16 v[144:159], v[120:123], v[232:235], v[144:159]
  ds_read_b64_tr_b16 v[120:121], v248 offset:26624
  ds_read_b64_tr_b16 v[122:123], v248 offset:27136
  ds_read_b64_tr_b16 v[124:125], v249 offset:26624
  ds_read_b64_tr_b16 v[126:127], v249 offset:27136
  s_waitcnt lgkmcnt(12)
  v_mfma_f32_32x32x16_bf16 v[80:95], v[128:131], v[56:59], v[80:95]
  v_mfma_f32_32x32x16_bf16 v[96:111], v[132:135], v[56:59], v[96:111]
  v_mfma_f32_32x32x16_bf16 v[144:159], v[128:131], v[232:235], v[144:159]
  ds_read_b64_tr_b16 v[128:129], v248 offset:28672
  ds_read_b64_tr_b16 v[130:131], v248 offset:29184
  ds_read_b64_tr_b16 v[132:133], v249 offset:28672
  ds_read_b64_tr_b16 v[134:135], v249 offset:29184
  s_waitcnt lgkmcnt(12)
  v_mfma_f32_32x32x16_bf16 v[80:95], v[136:139], v[60:63], v[80:95]
  v_mfma_f32_32x32x16_bf16 v[96:111], v[140:143], v[60:63], v[96:111]
  v_mfma_f32_32x32x16_bf16 v[144:159], v[136:139], v[232:235], v[144:159]
  ds_read_b64_tr_b16 v[136:137], v248 offset:30720
  ds_read_b64_tr_b16 v[138:139], v248 offset:31232
  ds_read_b64_tr_b16 v[140:141], v249 offset:30720
  ds_read_b64_tr_b16 v[142:143], v249 offset:31232
  s_waitcnt lgkmcnt(12)
  v_mfma_f32_32x32x16_bf16 v[80:95], v[112:115], v[64:67], v[80:95]
  v_mfma_f32_32x32x16_bf16 v[96:111], v[116:119], v[64:67], v[96:111]
  v_mfma_f32_32x32x16_bf16 v[144:159], v[112:115], v[232:235], v[144:159]
  s_waitcnt lgkmcnt(8)
  v_mfma_f32_32x32x16_bf16 v[80:95], v[120:123], v[68:71], v[80:95]
  v_mfma_f32_32x32x16_bf16 v[96:111], v[124:127], v[68:71], v[96:111]
  v_mfma_f32_32x32x16_bf16 v[144:159], v[120:123], v[232:235], v[144:159]
  s_waitcnt lgkmcnt(4)
  v_mfma_f32_32x32x16_bf16 v[80:95], v[128:131], v[72:75], v[80:95]
  v_mfma_f32_32x32x16_bf16 v[96:111], v[132:135], v[72:75], v[96:111]
  v_mfma_f32_32x32x16_bf16 v[144:159], v[128:131], v[232:235], v[144:159]
  s_waitcnt lgkmcnt(0)
  v_mfma_f32_32x32x16_bf16 v[80:95], v[136:139], v[76:79], v[80:95]
  v_mfma_f32_32x32x16_bf16 v[96:111], v[140:143], v[76:79], v[96:111]
  v_mfma_f32_32x32x16_bf16 v[144:159], v[136:139], v[232:235], v[144:159]
  s_branch FQPD_28
FQP1_27:
  ds_read_b64_tr_b16 v[112:113], v248 offset:0
  ds_read_b64_tr_b16 v[114:115], v248 offset:512
  ds_read_b64_tr_b16 v[116:117], v249 offset:0
  ds_read_b64_tr_b16 v[118:119], v249 offset:512
  ds_read_b64_tr_b16 v[120:121], v248 offset:2048
  ds_read_b64_tr_b16 v[122:123], v248 offset:2560
  ds_read_b64_tr_b16 v[124:125], v249 offset:2048
  ds_read_b64_tr_b16 v[126:127], v249 offset:2560
  ds_read_b64_tr_b16 v[128:129], v248 offset:4096
  ds_read_b64_tr_b16 v[130:131], v248 offset:4608
  ds_read_b64_tr_b16 v[132:133], v249 offset:4096
  ds_read_b64_tr_b16 v[134:135], v249 offset:4608
  ds_read_b64_tr_b16 v[136:137], v248 offset:6144
  ds_read_b64_tr_b16 v[138:139], v248 offset:6656
  ds_read_b64_tr_b16 v[140:141], v249 offset:6144
  ds_read_b64_tr_b16 v[142:143], v249 offset:6656
  s_waitcnt lgkmcnt(12)
  v_mfma_f32_32x32x16_bf16 v[80:95], v[112:115], v[16:19], 0
  v_mfma_f32_32x32x16_bf16 v[96:111], v[116:119], v[16:19], 0
  v_mfma_f32_32x32x16_bf16 v[144:159], v[116:119], v[232:235], 0
  ds_read_b64_tr_b16 v[112:113], v248 offset:8192
  ds_read_b64_tr_b16 v[114:115], v248 offset:8704
  ds_read_b64_tr_b16 v[116:117], v249 offset:8192
  ds_read_b64_tr_b16 v[118:119], v249 offset:8704
  s_waitcnt lgkmcnt(12)
  v_mfma_f32_32x32x16_bf16 v[80:95], v[120:123], v[20:23], v[80:95]
  v_mfma_f32_32x32x16_bf16 v[96:111], v[124:127], v[20:23], v[96:111]
  v_mfma_f32_32x32x16_bf16 v[144:159], v[124:127], v[232:235], v[144:159]
  ds_read_b64_tr_b16 v[120:121], v248 offset:10240
  ds_read_b64_tr_b16 v[122:123], v248 offset:10752
  ds_read_b64_tr_b16 v[124:125], v249 offset:10240
  ds_read_b64_tr_b16 v[126:127], v249 offset:10752
  s_waitcnt lgkmcnt(12)
  v_mfma_f32_32x32x16_bf16 v[80:95], v[128:131], v[24:27], v[80:95]
  v_mfma_f32_32x32x16_bf16 v[96:111], v[132:135], v[24:27], v[96:111]
  v_mfma_f32_32x32x16_bf16 v[144:159], v[132:135], v[232:235], v[144:159]
  ds_read_b64_tr_b16 v[128:129], v248 offset:12288
  ds_read_b64_tr_b16 v[130:131], v248 offset:12800
  ds_read_b64_tr_b16 v[132:133], v249 offset:12288
  ds_read_b64_tr_b16 v[134:135], v249 offset:12800
  s_waitcnt lgkmcnt(12)
  v_mfma_f32_32x32x16_bf16 v[80:95], v[136:139], v[28:31], v[80:95]
  v_mfma_f32_32x32x16_bf16 v[96:111], v[140:143], v[28:31], v[96:111]
  v_mfma_f32_32x32x16_bf16 v[144:159], v[140:143], v[232:235], v[144:159]
  ds_read_b64_tr_b16 v[136:137], v248 offset:14336
  ds_read_b64_tr_b16 v[138:139], v248 offset:14848
  ds_read_b64_tr_b16 v[140:141], v249 offset:14336
  ds_read_b64_tr_b16 v[142:143], v249 offset:14848
  s_waitcnt lgkmcnt(12)
  v_mfma_f32_32x32x16_bf16 v[80:95], v[112:115], v[32:35], v[80:95]
  v_mfma_f32_32x32x16_bf16 v[96:111], v[116:119], v[32:35], v[96:111]
  v_mfma_f32_32x32x16_bf16 v[144:159], v[116:119], v[232:235], v[144:159]
  ds_read_b64_tr_b16 v[112:113], v248 offset:16384
  ds_read_b64_tr_b16 v[114:115], v248 offset:16896
  ds_read_b64_tr_b16 v[116:117], v249 offset:16384
  ds_read_b64_tr_b16 v[118:119], v249 offset:16896
  s_waitcnt lgkmcnt(12)
  v_mfma_f32_32x32x16_bf16 v[80:95], v[120:123], v[36:39], v[80:95]
  v_mfma_f32_32x32x16_bf16 v[96:111], v[124:127], v[36:39], v[96:111]
  v_mfma_f32_32x32x16_bf16 v[144:159], v[124:127], v[232:235], v[144:159]
  ds_read_b64_tr_b16 v[120:121], v248 offset:18432
  ds_read_b64_tr_b16 v[122:123], v248 offset:18944
  ds_read_b64_tr_b16 v[124:125], v249 offset:18432
  ds_read_b64_tr_b16 v[126:127], v249 offset:18944
  s_waitcnt lgkmcnt(12)
  v_mfma_f32_32x32x16_bf16 v[80:95], v[128:131], v[40:43], v[80:95]
  v_mfma_f32_32x32x16_bf16 v[96:111], v[132:135], v[40:43], v[96:111]
  v_mfma_f32_32x32x16_bf16 v[144:159], v[132:135], v[232:235], v[144:159]
  ds_read_b64_tr_b16 v[128:129], v248 offset:20480
  ds_read_b64_tr_b16 v[130:131], v248 offset:20992
  ds_read_b64_tr_b16 v[132:133], v249 offset:20480
  ds_read_b64_tr_b16 v[134:135], v249 offset:20992
  s_waitcnt lgkmcnt(12)
  v_mfma_f32_32x32x16_bf16 v[80:95], v[136:139], v[44:47], v[80:95]
  v_mfma_f32_32x32x16_bf16 v[96:111], v[140:143], v[44:47], v[96:111]
  v_mfma_f32_32x32x16_bf16 v[144:159], v[140:143], v[232:235], v[144:159]
  ds_read_b64_tr_b16 v[136:137], v248 offset:22528
  ds_read_b64_tr_b16 v[138:139], v248 offset:23040
  ds_read_b64_tr_b16 v[140:141], v249 offset:22528
  ds_read_b64_tr_b16 v[142:143], v249 offset:23040
  s_waitcnt lgkmcnt(12)
  v_mfma_f32_32x32x16_bf16 v[80:95], v[112:115], v[48:51], v[80:95]
  v_mfma_f32_32x32x16_bf16 v[96:111], v[116:119], v[48:51], v[96:111]
  v_mfma_f32_32x32x16_bf16 v[144:159], v[116:119], v[232:235], v[144:159]
  ds_read_b64_tr_b16 v[112:113], v248 offset:24576
  ds_read_b64_tr_b16 v[114:115], v248 offset:25088
  ds_read_b64_tr_b16 v[116:117], v249 offset:24576
  ds_read_b64_tr_b16 v[118:119], v249 offset:25088
  s_waitcnt lgkmcnt(12)
  v_mfma_f32_32x32x16_bf16 v[80:95], v[120:123], v[52:55], v[80:95]
  v_mfma_f32_32x32x16_bf16 v[96:111], v[124:127], v[52:55], v[96:111]
  v_mfma_f32_32x32x16_bf16 v[144:159], v[124:127], v[232:235], v[144:159]
  ds_read_b64_tr_b16 v[120:121], v248 offset:26624
  ds_read_b64_tr_b16 v[122:123], v248 offset:27136
  ds_read_b64_tr_b16 v[124:125], v249 offset:26624
  ds_read_b64_tr_b16 v[126:127], v249 offset:27136
  s_waitcnt lgkmcnt(12)
  v_mfma_f32_32x32x16_bf16 v[80:95], v[128:131], v[56:59], v[80:95]
  v_mfma_f32_32x32x16_bf16 v[96:111], v[132:135], v[56:59], v[96:111]
  v_mfma_f32_32x32x16_bf16 v[144:159], v[132:135], v[232:235], v[144:159]
  ds_read_b64_tr_b16 v[128:129], v248 offset:28672
  ds_read_b64_tr_b16 v[130:131], v248 offset:29184
  ds_read_b64_tr_b16 v[132:133], v249 offset:28672
  ds_read_b64_tr_b16 v[134:135], v249 offset:29184
  s_waitcnt lgkmcnt(12)
  v_mfma_f32_32x32x16_bf16 v[80:95], v[136:139], v[60:63], v[80:95]
  v_mfma_f32_32x32x16_bf16 v[96:111], v[140:143], v[60:63], v[96:111]
  v_mfma_f32_32x32x16_bf16 v[144:159], v[140:143], v[232:235], v[144:159]
  ds_read_b64_tr_b16 v[136:137], v248 offset:30720
  ds_read_b64_tr_b16 v[138:139], v248 offset:31232
  ds_read_b64_tr_b16 v[140:141], v249 offset:30720
  ds_read_b64_tr_b16 v[142:143], v249 offset:31232
  s_waitcnt lgkmcnt(12)
  v_mfma_f32_32x32x16_bf16 v[80:95], v[112:115], v[64:67], v[80:95]
  v_mfma_f32_32x32x16_bf16 v[96:111], v[116:119], v[64:67], v[96:111]
  v_mfma_f32_32x32x16_bf16 v[144:159], v[116:119], v[232:235], v[144:159]
  s_waitcnt lgkmcnt(8)
  v_mfma_f32_32x32x16_bf16 v[80:95], v[120:123], v[68:71], v[80:95]
  v_mfma_f32_32x32x16_bf16 v[96:111], v[124:127], v[68:71], v[96:111]
  v_mfma_f32_32x32x16_bf16 v[144:159], v[124:127], v[232:235], v[144:159]
  s_waitcnt lgkmcnt(4)
  v_mfma_f32_32x32x16_bf16 v[80:95], v[128:131], v[72:75], v[80:95]
  v_mfma_f32_32x32x16_bf16 v[96:111], v[132:135], v[72:75], v[96:111]
  v_mfma_f32_32x32x16_bf16 v[144:159], v[132:135], v[232:235], v[144:159]
  s_waitcnt lgkmcnt(0)
  v_mfma_f32_32x32x16_bf16 v[80:95], v[136:139], v[76:79], v[80:95]
  v_mfma_f32_32x32x16_bf16 v[96:111], v[140:143], v[76:79], v[96:111]
  v_mfma_f32_32x32x16_bf16 v[144:159], v[140:143], v[232:235], v[144:159]
FQPD_28:
  s_xor_b32 s41, s20, s19
  s_lshl_b32 s41, s41, 8
  s_lshl_b32 s42, s20, 7
  s_add_u32 s41, s41, s42
  s_add_u32 s41, s41, 145408
  v_lshrrev_b32 v228, 5, v1
  v_lshlrev_b32 v228, 4, v228
  v_add_u32 v228, s41, v228
  s_mov_b32 exec_lo, 1
  s_mov_b32 exec_hi, 1
  s_nop 1
  ds_write_b128 v228, v[144:147] offset:0
  ds_write_b128 v228, v[148:151] offset:32
  ds_write_b128 v228, v[152:155] offset:64
  ds_write_b128 v228, v[156:159] offset:96
  s_mov_b64 exec, -1
  s_lshl_b32 s40, s18, 8
  s_add_u32 s40, s40, 144384
  v_add_f32 v224, v224, v236
  v_add_f32 v225, v225, v237
  s_nop 1
  v_permlane32_swap_b32 v224, v225
  v_add_f32 v224, v224, v225
  v_add_u32 v227, s40, v3
  ds_write_b32 v227, v224
FRED_12:
  s_lshl_b32 s40, s18, 12
  s_add_u32 s40, s40, 147456
  v_add_u32 v14, s40, v2
  s_xor_b32 s40, s40, 8192
  v_add_u32 v15, s40, v2
  ds_write_b128 v14, v[96:99] offset:0
  ds_write_b128 v14, v[100:103] offset:1024
  ds_write_b128 v14, v[104:107] offset:2048
  ds_write_b128 v14, v[108:111] offset:3072
  s_waitcnt lgkmcnt(0)
  s_barrier
  ds_read_b128 v[96:99], v15 offset:0
  ds_read_b128 v[100:103], v15 offset:1024
  ds_read_b128 v[104:107], v15 offset:2048
  ds_read_b128 v[108:111], v15 offset:3072
  s_waitcnt lgkmcnt(3)
  v_pk_add_f32 v[80:81], v[80:81], v[96:97]
  v_pk_add_f32 v[82:83], v[82:83], v[98:99]
  s_waitcnt lgkmcnt(2)
  v_pk_add_f32 v[84:85], v[84:85], v[100:101]
  v_pk_add_f32 v[86:87], v[86:87], v[102:103]
  s_waitcnt lgkmcnt(1)
  v_pk_add_f32 v[88:89], v[88:89], v[104:105]
  v_pk_add_f32 v[90:91], v[90:91], v[106:107]
  s_waitcnt lgkmcnt(0)
  v_pk_add_f32 v[92:93], v[92:93], v[108:109]
  v_pk_add_f32 v[94:95], v[94:95], v[110:111]
  s_lshl_b32 s41, s20, 8
  s_add_u32 s41, s41, 145408
  v_lshrrev_b32 v228, 5, v1
  v_lshlrev_b32 v228, 4, v228
  v_add_u32 v228, s41, v228
  ds_read_b128 v[196:199], v228 offset:0
  ds_read_b128 v[112:115], v228 offset:128
  ds_read_b128 v[200:203], v228 offset:32
  ds_read_b128 v[116:119], v228 offset:160
  ds_read_b128 v[204:207], v228 offset:64
  ds_read_b128 v[120:123], v228 offset:192
  ds_read_b128 v[208:211], v228 offset:96
  ds_read_b128 v[124:127], v228 offset:224
  s_cmp_eq_u32 s19, s17
  s_cbranch_scc1 FST_29
  s_lshl_b32 s40, s19, 8
  s_add_u32 s40, s40, 144384
  v_and_b32 v227, 31, v1
  v_lshlrev_b32 v227, 2, v227
  v_add_u32 v227, s40, v227
  ds_read_b32 v224, v227
  ds_read_b32 v225, v227 offset:128
  ds_read_b32 v226, v227 offset:512
  ds_read_b32 v228, v227 offset:640
  s_waitcnt lgkmcnt(0)
  v_add_f32 v224, v224, v226
  v_add_f32 v225, v225, v228
  v_mul_f32 v178, 0x3b000000, v224
  v_mul_f32 v225, 0x3b000000, v225
  v_fma_f32 v225, -v178, v178, v225
  v_add_f32 v225, 0x3727c5ac, v225
  v_rsq_f32 v179, v225
FST_29:
  s_waitcnt lgkmcnt(0)
  v_pk_add_f32 v[196:197], v[196:197], v[112:113]
  v_pk_add_f32 v[198:199], v[198:199], v[114:115]
  v_pk_add_f32 v[200:201], v[200:201], v[116:117]
  v_pk_add_f32 v[202:203], v[202:203], v[118:119]
  v_pk_add_f32 v[204:205], v[204:205], v[120:121]
  v_pk_add_f32 v[206:207], v[206:207], v[122:123]
  v_pk_add_f32 v[208:209], v[208:209], v[124:125]
  v_pk_add_f32 v[210:211], v[210:211], v[126:127]
  v_mul_f32 v214, 0x3eb8aa3b, v179
  v_mul_f32 v216, v178, v214
  v_sub_f32 v216, 0, v216
  s_lshl_b32 s40, s20, 2
  s_add_u32 s40, s40, s19
  s_lshl_b32 s40, s40, 10
  v_add_u32 v14, s40, v2
  v_pk_mul_f32 v[96:97], v[196:197], v[216:217] op_sel_hi:[1,0]
  v_pk_mul_f32 v[98:99], v[198:199], v[216:217] op_sel_hi:[1,0]
  v_pk_mul_f32 v[100:101], v[200:201], v[216:217] op_sel_hi:[1,0]
  v_pk_mul_f32 v[102:103], v[202:203], v[216:217] op_sel_hi:[1,0]
  v_pk_mul_f32 v[104:105], v[204:205], v[216:217] op_sel_hi:[1,0]
  v_pk_mul_f32 v[106:107], v[206:207], v[216:217] op_sel_hi:[1,0]
  v_pk_mul_f32 v[108:109], v[208:209], v[216:217] op_sel_hi:[1,0]
  v_pk_mul_f32 v[110:111], v[210:211], v[216:217] op_sel_hi:[1,0]
  v_pk_fma_f32 v[80:81], v[80:81], v[214:215], v[96:97] op_sel_hi:[1,0,1]
  v_pk_fma_f32 v[82:83], v[82:83], v[214:215], v[98:99] op_sel_hi:[1,0,1]
  v_pk_fma_f32 v[84:85], v[84:85], v[214:215], v[100:101] op_sel_hi:[1,0,1]
  v_pk_fma_f32 v[86:87], v[86:87], v[214:215], v[102:103] op_sel_hi:[1,0,1]
  v_pk_fma_f32 v[88:89], v[88:89], v[214:215], v[104:105] op_sel_hi:[1,0,1]
  v_pk_fma_f32 v[90:91], v[90:91], v[214:215], v[106:107] op_sel_hi:[1,0,1]
  v_pk_fma_f32 v[92:93], v[92:93], v[214:215], v[108:109] op_sel_hi:[1,0,1]
  v_pk_fma_f32 v[94:95], v[94:95], v[214:215], v[110:111] op_sel_hi:[1,0,1]
  v_cvt_pk_bf16_f32 v96, v80, v81
  v_cvt_pk_bf16_f32 v97, v82, v83
  v_cvt_pk_bf16_f32 v98, v84, v85
  v_cvt_pk_bf16_f32 v99, v86, v87
  v_cvt_pk_bf16_f32 v100, v88, v89
  v_cvt_pk_bf16_f32 v101, v90, v91
  v_cvt_pk_bf16_f32 v102, v92, v93
  v_cvt_pk_bf16_f32 v103, v94, v95
  ds_write_b128 v14, v[96:99] offset:0
  ds_write_b128 v14, v[100:103] offset:2048
  s_mov_b32 s100, s57
  s_lshl_b32 s41, s17, 2
  v_mov_b32 v244, s41
  v_mov_b32 v245, s21
  v_and_b32 v246, 7, v1
  v_lshlrev_b32 v246, 2, v246
  v_lshrrev_b32 v248, 5, v1
  v_lshlrev_b32 v248, 4, v248
  v_and_b32 v249, 31, v1
  v_lshlrev_b32 v249, 2, v249
L_ATT:
  s_lshl_b32 s40, s17, 1
  s_mov_b32 s57, 33
  s_mov_b32 s58, 34
  s_cmp_eq_u32 s18, 1
  s_cselect_b32 s57, 49, s57
  s_cselect_b32 s58, 50, s58
  s_cmp_eq_u32 s18, 2
  s_cselect_b32 s57, 50, s57
  s_cselect_b32 s58, 65, s58
  s_cmp_eq_u32 s18, 3
  s_cselect_b32 s57, 66, s57
  s_cselect_b32 s58, 65, s58
  s_add_u32 s57, s57, s40
  s_add_u32 s58, s58, s40
  s_lshl_b32 s59, s57, 15
  s_add_u32 s59, s59, 1048576
  s_lshl_b32 s60, s58, 15
  s_add_u32 s60, s60, 1048576
  v_mov_b32 v27, 0
  ds_write_b32 v27, v27 offset:63488
  s_mov_b32 s101, 0
  v_mov_b32 v72, 0
  v_mov_b32 v73, 0
  v_mov_b32 v74, 0
  v_mov_b32 v75, 0
  v_mov_b32 v76, 0
  v_mov_b32 v77, 0
  v_mov_b32 v78, 0
  v_mov_b32 v79, 0
  v_mov_b32 v62, 0
  v_mov_b32 v63, 0
  s_mul_i32 s40, s18, 13824
  s_add_u32 s40, s40, 8192
  v_add_u32 v24, s40, v2
  s_add_u32 s40, s40, 2048
  v_add_u32 v25, s40, v3
  s_lshl_b32 s40, s18, 14
  s_add_u32 s62, s40, 65536
  s_lshl_b32 s63, s17, 16
  s_add_u32 s63, s63, s40
  s_add_u32 s63, s63, 1605632
  v_and_b32 v27, 31, v1
  v_min_u32 v26, 16, v27
  v_lshlrev_b32 v26, 4, v26
  v_lshrrev_b32 v29, 5, v1
  v_mul_u32_u24 v29, 272, v29
  v_add_u32 v26, v26, v29
  v_and_b32 v29, 27, v27
  v_cmp_eq_u32 vcc, 16, v29
  v_cmp_gt_u32 s[48:49], 16, v27
  s_nop 1
  s_or_b64 vcc, vcc, s[48:49]
  v_mov_b32 v29, 268435456
  v_cndmask_b32 v26, v29, v26, vcc
  s_mov_b32 s56, 0
  s_lshl_b32 s42, s18, 1
  s_add_u32 s42, s42, 2
  s_and_b32 s42, s42, 7
  s_lshl_b32 s42, s42, 10
  v_add_u32 v28, s42, v2
  s_waitcnt lgkmcnt(0)
  s_cmp_lg_u32 s18, 0
  s_cbranch_scc1 GK_31
  s_cmp_lg_u32 s22, 0
  s_cbranch_scc1 NOMODE_32
  s_lshl_b32 s40, s16, 5
  s_add_u32 s40, s40, 114688
  v_and_b32 v16, 7, v1
  v_lshlrev_b32 v16, 2, v16
  s_mov_b32 s52, 0
XPOLL_33:
  buffer_load_dword v17, v16, s[4:7], s40 offen sc1
  s_waitcnt vmcnt(0)
  v_subrev_u32 v17, s21, v17
  v_subrev_u32 v17, 16, v17
  v_cmp_le_u32 vcc, 16, v17
  s_nop 4
  s_cbranch_vccz XOK_34
  s_add_u32 s52, s52, 1
  s_cmp_lt_u32 s52, 400000
  s_cbranch_scc1 XPOLL_33
  s_branch L_END
XOK_34:
  v_cmp_ne_u32 vcc, s3, v17
  s_nop 4
  s_cmp_eq_u64 vcc, 0
  s_cselect_b32 s41, 1, 0
  v_mov_b32 v16, 163832
  v_mov_b32 v17, s41
  ds_write_b32 v16, v17
  s_waitcnt lgkmcnt(0)
NOMODE_32:
  s_lshl_b32 s40, s22, 11
  s_and_b32 s41, s2, 7
  s_lshl_b32 s41, s41, 8
  s_add_u32 s40, s40, s41
  s_add_u32 s40, s40, 106496
  s_mov_b32 s52, 0
POLL_35:
  buffer_load_dword v17, v3, s[4:7], s40 offen sc1
  s_waitcnt vmcnt(0)
  v_cmp_ne_u32 vcc, s21, v17
  s_nop 4
  s_cbranch_vccz POLLOK_36
  s_add_u32 s52, s52, 1
  s_cmp_lt_u32 s52, 400000
  s_cbranch_scc1 POLL_35
  s_branch L_END
POLLOK_36:
  s_cmp_lg_u32 s2, 0
  s_cbranch_scc1 EPOCH_37
  s_cmp_eq_u32 s22, 0
  s_cbranch_scc1 EPOCH_37
  v_mov_b32 v16, 0
  v_mov_b32 v17, s21
  s_mov_b64 exec, 1
  buffer_store_dword v17, v16, s[4:7], 0 offen sc0 sc1
  s_mov_b64 exec, -1
  s_waitcnt vmcnt(0)
EPOCH_37:
GK_31:
  s_waitcnt vmcnt(0)
  s_barrier
  s_cmp_lg_u32 s22, 0
  s_cbranch_scc1 NOMODE2_38
  v_mov_b32 v16, 163832
  ds_read_b32 v17, v16
  s_waitcnt lgkmcnt(0)
  v_readfirstlane_b32 s39, v17
  s_nop 1
  s_cmp_eq_u32 s39, 0
  s_cbranch_scc1 ALIAS_40
  s_mov_b32 s34, 13631488
  s_mov_b32 s35, 13631488
  s_mov_b32 s28, 7340032
  s_mov_b32 s29, 7340032
  s_mov_b32 s30, 7340032
  s_mov_b32 s31, 24379392
  s_mov_b32 s32, 24379392
  s_mov_b32 s33, 24379392
ALIAS_40:
  s_cmp_ge_u32 s100, 97
  s_cbranch_scc1 NOPF_39
  s_cmp_lg_u32 s18, 0
  s_cbranch_scc1 NOPF_39
  v_lshlrev_b32 v16, 9, v1
  s_lshl_b32 s40, s100, 2
  s_add_u32 s40, s40, 98304
  v_mov_b32 v17, s21
  s_mov_b64 exec, 0xff
  buffer_store_dword v17, v16, s[4:7], s40 offen sc1
  s_mov_b64 exec, -1
NOPF_39:
NOMODE2_38:
  ds_read_b128 v[16:19], v28 offset:0
  s_lshl_b32 s88, s18, 14
  s_add_u32 s88, s88, s37
  s_mul_i32 s89, s18, 17408
  s_add_u32 s89, s89, s37
  s_add_u32 s89, s89, 0x10000
  buffer_load_dwordx4 a[0:3], v2, s[4:7], s88 offen offset:0 sc1
  buffer_load_dwordx4 a[64:67], v26, s[4:7], s89 offen offset:0 sc1
  buffer_load_dwordx4 a[68:71], v26, s[4:7], s89 offen offset:544 sc1
  buffer_load_dwordx4 a[4:7], v2, s[4:7], s88 offen offset:1024 sc1
  buffer_load_dwordx4 a[72:75], v26, s[4:7], s89 offen offset:1088 sc1
  buffer_load_dwordx4 a[76:79], v26, s[4:7], s89 offen offset:1632 sc1
  s_add_u32 s89, s89, 2176
  buffer_load_dwordx4 a[8:11], v2, s[4:7], s88 offen offset:2048 sc1
  buffer_load_dwordx4 a[80:83], v26, s[4:7], s89 offen offset:0 sc1
  buffer_load_dwordx4 a[84:87], v26, s[4:7], s89 offen offset:544 sc1
  buffer_load_dwordx4 a[12:15], v2, s[4:7], s88 offen offset:3072 sc1
  buffer_load_dwordx4 a[88:91], v26, s[4:7], s89 offen offset:1088 sc1
  buffer_load_dwordx4 a[92:95], v26, s[4:7], s89 offen offset:1632 sc1
  s_waitcnt vmcnt(11) lgkmcnt(0)
  v_mfma_f32_32x32x16_bf16 v[32:47], a[0:3], v[16:19], 0
  s_nop 7
  s_nop 7
  s_waitcnt vmcnt(8)
  v_exp_f32 v32, v32
  v_cvt_pk_bf16_f32 v79, v62, v63
  v_exp_f32 v33, v33
  v_mfma_f32_32x32x16_bf16 v[48:63], a[4:7], v[16:19], 0
  v_exp_f32 v34, v34
  v_exp_f32 v35, v35
  v_cvt_pk_bf16_f32 v64, v32, v33
  s_add_u32 s88, s88, 4096
  s_add_u32 s89, s89, 2176
  buffer_load_dwordx4 a[16:19], v2, s[4:7], s88 offen offset:0 sc1
  buffer_load_dwordx4 a[96:99], v26, s[4:7], s89 offen offset:0 sc1
  buffer_load_dwordx4 a[100:103], v26, s[4:7], s89 offen offset:544 sc1
  v_exp_f32 v36, v36
  v_exp_f32 v37, v37
  v_cvt_pk_bf16_f32 v65, v34, v35
  v_exp_f32 v38, v38
  v_mfma_f32_32x32x16_bf16 v[96:111], a[188:191], v[76:79], v[96:111]
  v_exp_f32 v39, v39
  v_cvt_pk_bf16_f32 v66, v36, v37
  v_exp_f32 v40, v40
  v_exp_f32 v41, v41
  v_cvt_pk_bf16_f32 v67, v38, v39
  v_add_u32 v28, 0x400, v28
  v_and_b32 v28, 0x1fff, v28
  v_exp_f32 v42, v42
  v_exp_f32 v43, v43
  v_cvt_pk_bf16_f32 v68, v40, v41
  v_mfma_f32_32x32x16_bf16 v[80:95], a[64:67], v[64:67], 0
  v_exp_f32 v44, v44
  v_exp_f32 v45, v45
  v_cvt_pk_bf16_f32 v69, v42, v43
  v_exp_f32 v46, v46
  v_exp_f32 v47, v47
  v_cvt_pk_bf16_f32 v70, v44, v45
  s_waitcnt vmcnt(8)
  v_exp_f32 v48, v48
  v_cvt_pk_bf16_f32 v71, v46, v47
  v_exp_f32 v49, v49
  v_mfma_f32_32x32x16_bf16 v[32:47], a[8:11], v[16:19], 0
  v_exp_f32 v50, v50
  v_exp_f32 v51, v51
  v_cvt_pk_bf16_f32 v72, v48, v49
  buffer_load_dwordx4 a[20:23], v2, s[4:7], s88 offen offset:1024 sc1
  buffer_load_dwordx4 a[104:107], v26, s[4:7], s89 offen offset:1088 sc1
  buffer_load_dwordx4 a[108:111], v26, s[4:7], s89 offen offset:1632 sc1
  v_exp_f32 v52, v52
  v_exp_f32 v53, v53
  v_cvt_pk_bf16_f32 v73, v50, v51
  v_exp_f32 v54, v54
  v_mfma_f32_32x32x16_bf16 v[80:95], a[68:71], v[68:71], v[80:95]
  v_exp_f32 v55, v55
  v_cvt_pk_bf16_f32 v74, v52, v53
  v_exp_f32 v56, v56
  v_exp_f32 v57, v57
  v_cvt_pk_bf16_f32 v75, v54, v55
  v_exp_f32 v58, v58
  v_exp_f32 v59, v59
  v_cvt_pk_bf16_f32 v76, v56, v57
  v_mfma_f32_32x32x16_bf16 v[80:95], a[72:75], v[72:75], v[80:95]
  v_exp_f32 v60, v60
  v_exp_f32 v61, v61
  v_cvt_pk_bf16_f32 v77, v58, v59
  v_exp_f32 v62, v62
  v_exp_f32 v63, v63
  v_cvt_pk_bf16_f32 v78, v60, v61
  s_waitcnt vmcnt(8)
  v_exp_f32 v32, v32
  v_cvt_pk_bf16_f32 v79, v62, v63
  v_exp_f32 v33, v33
  v_mfma_f32_32x32x16_bf16 v[48:63], a[12:15], v[16:19], 0
  v_exp_f32 v34, v34
  v_exp_f32 v35, v35
  v_cvt_pk_bf16_f32 v64, v32, v33
  s_add_u32 s89, s89, 2176
  buffer_load_dwordx4 a[24:27], v2, s[4:7], s88 offen offset:2048 sc1
  buffer_load_dwordx4 a[112:115], v26, s[4:7], s89 offen offset:0 sc1
  buffer_load_dwordx4 a[116:119], v26, s[4:7], s89 offen offset:544 sc1
  v_exp_f32 v36, v36
  v_exp_f32 v37, v37
  v_cvt_pk_bf16_f32 v65, v34, v35
  v_exp_f32 v38, v38
  v_mfma_f32_32x32x16_bf16 v[80:95], a[76:79], v[76:79], v[80:95]
  v_exp_f32 v39, v39
  v_cvt_pk_bf16_f32 v66, v36, v37
  v_exp_f32 v40, v40
  v_exp_f32 v41, v41
  v_cvt_pk_bf16_f32 v67, v38, v39
  v_exp_f32 v42, v42
  v_exp_f32 v43, v43
  v_cvt_pk_bf16_f32 v68, v40, v41
  v_mfma_f32_32x32x16_bf16 v[80:95], a[80:83], v[64:67], v[80:95]
  v_exp_f32 v44, v44
  v_exp_f32 v45, v45
  v_cvt_pk_bf16_f32 v69, v42, v43
  v_exp_f32 v46, v46
  v_exp_f32 v47, v47
  v_cvt_pk_bf16_f32 v70, v44, v45
  s_waitcnt vmcnt(8)
  v_exp_f32 v48, v48
  v_cvt_pk_bf16_f32 v71, v46, v47
  v_exp_f32 v49, v49
  v_mfma_f32_32x32x16_bf16 v[32:47], a[16:19], v[16:19], 0
  v_exp_f32 v50, v50
  v_exp_f32 v51, v51
  v_cvt_pk_bf16_f32 v72, v48, v49
  buffer_load_dwordx4 a[28:31], v2, s[4:7], s88 offen offset:3072 sc1
  buffer_load_dwordx4 a[120:123], v26, s[4:7], s89 offen offset:1088 sc1
  buffer_load_dwordx4 a[124:127], v26, s[4:7], s89 offen offset:1632 sc1
  v_exp_f32 v52, v52
  v_exp_f32 v53, v53
  v_cvt_pk_bf16_f32 v73, v50, v51
  v_exp_f32 v54, v54
  v_mfma_f32_32x32x16_bf16 v[80:95], a[84:87], v[68:71], v[80:95]
  v_exp_f32 v55, v55
  v_cvt_pk_bf16_f32 v74, v52, v53
  v_exp_f32 v56, v56
  v_exp_f32 v57, v57
  v_cvt_pk_bf16_f32 v75, v54, v55
  v_exp_f32 v58, v58
  v_exp_f32 v59, v59
  v_cvt_pk_bf16_f32 v76, v56, v57
  v_mfma_f32_32x32x16_bf16 v[80:95], a[88:91], v[72:75], v[80:95]
  v_exp_f32 v60, v60
  v_exp_f32 v61, v61
  v_cvt_pk_bf16_f32 v77, v58, v59
  v_exp_f32 v62, v62
  v_exp_f32 v63, v63
  v_cvt_pk_bf16_f32 v78, v60, v61
  s_waitcnt vmcnt(8)
  v_exp_f32 v32, v32
  v_cvt_pk_bf16_f32 v79, v62, v63
  v_exp_f32 v33, v33
  v_mfma_f32_32x32x16_bf16 v[48:63], a[20:23], v[16:19], 0
  v_exp_f32 v34, v34
  v_exp_f32 v35, v35
  v_cvt_pk_bf16_f32 v64, v32, v33
  s_add_u32 s88, s88, 4096
  s_add_u32 s89, s89, 2176
  buffer_load_dwordx4 a[32:35], v2, s[4:7], s88 offen offset:0 sc1
  buffer_load_dwordx4 a[128:131], v26, s[4:7], s89 offen offset:0 sc1
  buffer_load_dwordx4 a[132:135], v26, s[4:7], s89 offen offset:544 sc1
  v_exp_f32 v36, v36
  v_exp_f32 v37, v37
  v_cvt_pk_bf16_f32 v65, v34, v35
  ds_read_b128 v[20:23], v28 offset:0
  v_exp_f32 v38, v38
  v_mfma_f32_32x32x16_bf16 v[80:95], a[92:95], v[76:79], v[80:95]
  v_exp_f32 v39, v39
  v_cvt_pk_bf16_f32 v66, v36, v37
  v_exp_f32 v40, v40
  v_exp_f32 v41, v41
  v_cvt_pk_bf16_f32 v67, v38, v39
  v_exp_f32 v42, v42
  v_exp_f32 v43, v43
  v_cvt_pk_bf16_f32 v68, v40, v41
  v_mfma_f32_32x32x16_bf16 v[80:95], a[96:99], v[64:67], v[80:95]
  v_exp_f32 v44, v44
  v_exp_f32 v45, v45
  v_cvt_pk_bf16_f32 v69, v42, v43
  v_exp_f32 v46, v46
  v_exp_f32 v47, v47
  v_cvt_pk_bf16_f32 v70, v44, v45
  s_waitcnt vmcnt(8)
  v_exp_f32 v48, v48
  v_cvt_pk_bf16_f32 v71, v46, v47
  v_exp_f32 v49, v49
  v_mfma_f32_32x32x16_bf16 v[32:47], a[24:27], v[16:19], 0
  v_exp_f32 v50, v50
  v_exp_f32 v51, v51
  v_cvt_pk_bf16_f32 v72, v48, v49
  buffer_load_dwordx4 a[36:39], v2, s[4:7], s88 offen offset:1024 sc1
  buffer_load_dwordx4 a[136:139], v26, s[4:7], s89 offen offset:1088 sc1
  buffer_load_dwordx4 a[140:143], v26, s[4:7], s89 offen offset:1632 sc1
  v_exp_f32 v52, v52
  v_exp_f32 v53, v53
  v_cvt_pk_bf16_f32 v73, v50, v51
  v_exp_f32 v54, v54
  v_mfma_f32_32x32x16_bf16 v[80:95], a[100:103], v[68:71], v[80:95]
  v_exp_f32 v55, v55
  v_cvt_pk_bf16_f32 v74, v52, v53
  v_exp_f32 v56, v56
  v_exp_f32 v57, v57
  v_cvt_pk_bf16_f32 v75, v54, v55
  v_exp_f32 v58, v58
  v_exp_f32 v59, v59
  v_cvt_pk_bf16_f32 v76, v56, v57
  v_mfma_f32_32x32x16_bf16 v[80:95], a[104:107], v[72:75], v[80:95]
  v_exp_f32 v60, v60
  v_exp_f32 v61, v61
  v_cvt_pk_bf16_f32 v77, v58, v59
  v_exp_f32 v62, v62
  v_exp_f32 v63, v63
  v_cvt_pk_bf16_f32 v78, v60, v61
  s_waitcnt vmcnt(8)
  v_exp_f32 v32, v32
  v_cvt_pk_bf16_f32 v79, v62, v63
  v_exp_f32 v33, v33
  v_mfma_f32_32x32x16_bf16 v[48:63], a[28:31], v[16:19], 0
  v_exp_f32 v34, v34
  v_exp_f32 v35, v35
  v_cvt_pk_bf16_f32 v64, v32, v33
  s_add_u32 s89, s89, 2176
  buffer_load_dwordx4 a[40:43], v2, s[4:7], s88 offen offset:2048 sc1
  buffer_load_dwordx4 a[144:147], v26, s[4:7], s89 offen offset:0 sc1
  buffer_load_dwordx4 a[148:151], v26, s[4:7], s89 offen offset:544 sc1
  v_exp_f32 v36, v36
  v_exp_f32 v37, v37
  v_cvt_pk_bf16_f32 v65, v34, v35
  v_exp_f32 v38, v38
  v_mfma_f32_32x32x16_bf16 v[80:95], a[108:111], v[76:79], v[80:95]
  v_exp_f32 v39, v39
  v_cvt_pk_bf16_f32 v66, v36, v37
  v_exp_f32 v40, v40
  v_exp_f32 v41, v41
  v_cvt_pk_bf16_f32 v67, v38, v39
  v_exp_f32 v42, v42
  v_exp_f32 v43, v43
  v_cvt_pk_bf16_f32 v68, v40, v41
  v_mfma_f32_32x32x16_bf16 v[80:95], a[112:115], v[64:67], v[80:95]
  v_exp_f32 v44, v44
  v_exp_f32 v45, v45
  v_cvt_pk_bf16_f32 v69, v42, v43
  v_exp_f32 v46, v46
  v_exp_f32 v47, v47
  v_cvt_pk_bf16_f32 v70, v44, v45
  s_waitcnt vmcnt(8)
  v_exp_f32 v48, v48
  v_cvt_pk_bf16_f32 v71, v46, v47
  v_exp_f32 v49, v49
  v_mfma_f32_32x32x16_bf16 v[32:47], a[32:35], v[16:19], 0
  v_exp_f32 v50, v50
  v_exp_f32 v51, v51
  v_cvt_pk_bf16_f32 v72, v48, v49
  buffer_load_dwordx4 a[44:47], v2, s[4:7], s88 offen offset:3072 sc1
  buffer_load_dwordx4 a[152:155], v26, s[4:7], s89 offen offset:1088 sc1
  buffer_load_dwordx4 a[156:159], v26, s[4:7], s89 offen offset:1632 sc1
  v_exp_f32 v52, v52
  v_exp_f32 v53, v53
  v_cvt_pk_bf16_f32 v73, v50, v51
  v_exp_f32 v54, v54
  v_mfma_f32_32x32x16_bf16 v[80:95], a[116:119], v[68:71], v[80:95]
  v_exp_f32 v55, v55
  v_cvt_pk_bf16_f32 v74, v52, v53
  v_exp_f32 v56, v56
  v_exp_f32 v57, v57
  v_cvt_pk_bf16_f32 v75, v54, v55
  v_exp_f32 v58, v58
  v_exp_f32 v59, v59
  v_cvt_pk_bf16_f32 v76, v56, v57
  v_mfma_f32_32x32x16_bf16 v[80:95], a[120:123], v[72:75], v[80:95]
  v_exp_f32 v60, v60
  v_exp_f32 v61, v61
  v_cvt_pk_bf16_f32 v77, v58, v59
  v_exp_f32 v62, v62
  v_exp_f32 v63, v63
  v_cvt_pk_bf16_f32 v78, v60, v61
  s_waitcnt vmcnt(8)
  v_exp_f32 v32, v32
  v_cvt_pk_bf16_f32 v79, v62, v63
  v_exp_f32 v33, v33
  v_mfma_f32_32x32x16_bf16 v[48:63], a[36:39], v[16:19], 0
  v_exp_f32 v34, v34
  v_exp_f32 v35, v35
  v_cvt_pk_bf16_f32 v64, v32, v33
  s_add_u32 s88, s88, 4096
  s_add_u32 s89, s89, 2176
  buffer_load_dwordx4 a[48:51], v2, s[4:7], s88 offen offset:0 sc1
  buffer_load_dwordx4 a[160:163], v26, s[4:7], s89 offen offset:0 sc1
  buffer_load_dwordx4 a[164:167], v26, s[4:7], s89 offen offset:544 sc1
  v_exp_f32 v36, v36
  v_exp_f32 v37, v37
  v_cvt_pk_bf16_f32 v65, v34, v35
  v_exp_f32 v38, v38
  v_mfma_f32_32x32x16_bf16 v[80:95], a[124:127], v[76:79], v[80:95]
  v_exp_f32 v39, v39
  v_cvt_pk_bf16_f32 v66, v36, v37
  v_exp_f32 v40, v40
  v_exp_f32 v41, v41
  v_cvt_pk_bf16_f32 v67, v38, v39
  v_exp_f32 v42, v42
  v_exp_f32 v43, v43
  v_cvt_pk_bf16_f32 v68, v40, v41
  v_mfma_f32_32x32x16_bf16 v[80:95], a[128:131], v[64:67], v[80:95]
  v_exp_f32 v44, v44
  v_exp_f32 v45, v45
  v_cvt_pk_bf16_f32 v69, v42, v43
  v_exp_f32 v46, v46
  v_exp_f32 v47, v47
  v_cvt_pk_bf16_f32 v70, v44, v45
  s_waitcnt vmcnt(8)
  v_exp_f32 v48, v48
  v_cvt_pk_bf16_f32 v71, v46, v47
  v_exp_f32 v49, v49
  v_mfma_f32_32x32x16_bf16 v[32:47], a[40:43], v[16:19], 0
  v_exp_f32 v50, v50
  v_exp_f32 v51, v51
  v_cvt_pk_bf16_f32 v72, v48, v49
  buffer_load_dwordx4 a[52:55], v2, s[4:7], s88 offen offset:1024 sc1
  buffer_load_dwordx4 a[168:171], v26, s[4:7], s89 offen offset:1088 sc1
  buffer_load_dwordx4 a[172:175], v26, s[4:7], s89 offen offset:1632 sc1
  v_exp_f32 v52, v52
  v_exp_f32 v53, v53
  v_cvt_pk_bf16_f32 v73, v50, v51
  v_exp_f32 v54, v54
  v_mfma_f32_32x32x16_bf16 v[80:95], a[132:135], v[68:71], v[80:95]
  v_exp_f32 v55, v55
  v_cvt_pk_bf16_f32 v74, v52, v53
  v_exp_f32 v56, v56
  v_exp_f32 v57, v57
  v_cvt_pk_bf16_f32 v75, v54, v55
  v_exp_f32 v58, v58
  v_exp_f32 v59, v59
  v_cvt_pk_bf16_f32 v76, v56, v57
  v_mfma_f32_32x32x16_bf16 v[80:95], a[136:139], v[72:75], v[80:95]
  v_exp_f32 v60, v60
  v_exp_f32 v61, v61
  v_cvt_pk_bf16_f32 v77, v58, v59
  v_exp_f32 v62, v62
  v_exp_f32 v63, v63
  v_cvt_pk_bf16_f32 v78, v60, v61
  s_waitcnt vmcnt(8)
  v_exp_f32 v32, v32
  v_cvt_pk_bf16_f32 v79, v62, v63
  v_exp_f32 v33, v33
  v_mfma_f32_32x32x16_bf16 v[48:63], a[44:47], v[16:19], 0
  v_exp_f32 v34, v34
  v_exp_f32 v35, v35
  v_cvt_pk_bf16_f32 v64, v32, v33
  s_add_u32 s89, s89, 2176
  buffer_load_dwordx4 a[56:59], v2, s[4:7], s88 offen offset:2048 sc1
  buffer_load_dwordx4 a[176:179], v26, s[4:7], s89 offen offset:0 sc1
  buffer_load_dwordx4 a[180:183], v26, s[4:7], s89 offen offset:544 sc1
  v_exp_f32 v36, v36
  v_exp_f32 v37, v37
  v_cvt_pk_bf16_f32 v65, v34, v35
  v_exp_f32 v38, v38
  v_mfma_f32_32x32x16_bf16 v[80:95], a[140:143], v[76:79], v[80:95]
  v_exp_f32 v39, v39
  v_cvt_pk_bf16_f32 v66, v36, v37
  v_exp_f32 v40, v40
  v_exp_f32 v41, v41
  v_cvt_pk_bf16_f32 v67, v38, v39
  v_exp_f32 v42, v42
  v_exp_f32 v43, v43
  v_cvt_pk_bf16_f32 v68, v40, v41
  v_mfma_f32_32x32x16_bf16 v[80:95], a[144:147], v[64:67], v[80:95]
  v_exp_f32 v44, v44
  v_exp_f32 v45, v45
  v_cvt_pk_bf16_f32 v69, v42, v43
  v_exp_f32 v46, v46
  v_exp_f32 v47, v47
  v_cvt_pk_bf16_f32 v70, v44, v45
  s_waitcnt vmcnt(8)
  v_exp_f32 v48, v48
  v_cvt_pk_bf16_f32 v71, v46, v47
  v_exp_f32 v49, v49
  v_mfma_f32_32x32x16_bf16 v[32:47], a[48:51], v[16:19], 0
  v_exp_f32 v50, v50
  v_exp_f32 v51, v51
  v_cvt_pk_bf16_f32 v72, v48, v49
  buffer_load_dwordx4 a[60:63], v2, s[4:7], s88 offen offset:3072 sc1
  buffer_load_dwordx4 a[184:187], v26, s[4:7], s89 offen offset:1088 sc1
  buffer_load_dwordx4 a[188:191], v26, s[4:7], s89 offen offset:1632 sc1
  v_exp_f32 v52, v52
  v_exp_f32 v53, v53
  v_cvt_pk_bf16_f32 v73, v50, v51
  v_exp_f32 v54, v54
  v_mfma_f32_32x32x16_bf16 v[80:95], a[148:151], v[68:71], v[80:95]
  v_exp_f32 v55, v55
  v_cvt_pk_bf16_f32 v74, v52, v53
  v_exp_f32 v56, v56
  v_exp_f32 v57, v57
  v_cvt_pk_bf16_f32 v75, v54, v55
  v_exp_f32 v58, v58
  v_exp_f32 v59, v59
  v_cvt_pk_bf16_f32 v76, v56, v57
  v_mfma_f32_32x32x16_bf16 v[80:95], a[152:155], v[72:75], v[80:95]
  v_exp_f32 v60, v60
  v_exp_f32 v61, v61
  v_cvt_pk_bf16_f32 v77, v58, v59
  v_exp_f32 v62, v62
  v_exp_f32 v63, v63
  v_cvt_pk_bf16_f32 v78, v60, v61
  s_waitcnt vmcnt(8)
  v_exp_f32 v32, v32
  v_cvt_pk_bf16_f32 v79, v62, v63
  v_exp_f32 v33, v33
  v_mfma_f32_32x32x16_bf16 v[48:63], a[52:55], v[16:19], 0
  v_exp_f32 v34, v34
  v_exp_f32 v35, v35
  v_cvt_pk_bf16_f32 v64, v32, v33
  v_exp_f32 v36, v36
  v_exp_f32 v37, v37
  v_cvt_pk_bf16_f32 v65, v34, v35
  s_and_b32 s40, s2, 7
  s_lshl_b32 s40, s40, 9
  s_add_u32 s40, s40, 98304
  v_lshlrev_b32 v29, 3, v1
  buffer_load_dwordx2 v[30:31], v29, s[4:7], s40 offen sc1
  v_exp_f32 v38, v38
  v_mfma_f32_32x32x16_bf16 v[80:95], a[156:159], v[76:79], v[80:95]
  v_exp_f32 v39, v39
  v_cvt_pk_bf16_f32 v66, v36, v37
  v_exp_f32 v40, v40
  v_exp_f32 v41, v41
  v_cvt_pk_bf16_f32 v67, v38, v39
  v_exp_f32 v42, v42
  v_exp_f32 v43, v43
  v_cvt_pk_bf16_f32 v68, v40, v41
  v_mfma_f32_32x32x16_bf16 v[80:95], a[160:163], v[64:67], v[80:95]
  v_exp_f32 v44, v44
  v_exp_f32 v45, v45
  v_cvt_pk_bf16_f32 v69, v42, v43
  v_exp_f32 v46, v46
  v_exp_f32 v47, v47
  v_cvt_pk_bf16_f32 v70, v44, v45
  s_waitcnt vmcnt(6)
  v_exp_f32 v48, v48
  v_cvt_pk_bf16_f32 v71, v46, v47
  v_exp_f32 v49, v49
  v_mfma_f32_32x32x16_bf16 v[32:47], a[56:59], v[16:19], 0
  v_exp_f32 v50, v50
  v_exp_f32 v51, v51
  v_cvt_pk_bf16_f32 v72, v48, v49
  v_exp_f32 v52, v52
  v_exp_f32 v53, v53
  v_cvt_pk_bf16_f32 v73, v50, v51
  v_exp_f32 v54, v54
  v_mfma_f32_32x32x16_bf16 v[80:95], a[164:167], v[68:71], v[80:95]
  v_exp_f32 v55, v55
  v_cvt_pk_bf16_f32 v74, v52, v53
  v_exp_f32 v56, v56
  v_exp_f32 v57, v57
  v_cvt_pk_bf16_f32 v75, v54, v55
  v_exp_f32 v58, v58
  v_exp_f32 v59, v59
  v_cvt_pk_bf16_f32 v76, v56, v57
  v_mfma_f32_32x32x16_bf16 v[80:95], a[168:171], v[72:75], v[80:95]
  v_exp_f32 v60, v60
  v_exp_f32 v61, v61
  v_cvt_pk_bf16_f32 v77, v58, v59
  v_exp_f32 v62, v62
  v_exp_f32 v63, v63
  v_cvt_pk_bf16_f32 v78, v60, v61
  s_waitcnt vmcnt(3)
  v_exp_f32 v32, v32
  v_cvt_pk_bf16_f32 v79, v62, v63
  v_exp_f32 v33, v33
  v_mfma_f32_32x32x16_bf16 v[48:63], a[60:63], v[16:19], 0
  v_exp_f32 v34, v34
  v_exp_f32 v35, v35
  v_cvt_pk_bf16_f32 v64, v32, v33
  v_exp_f32 v36, v36
  s_waitcnt lgkmcnt(0)
  v_exp_f32 v37, v37
  v_cvt_pk_bf16_f32 v65, v34, v35
  v_exp_f32 v38, v38
  v_mfma_f32_32x32x16_bf16 v[80:95], a[172:175], v[76:79], v[80:95]
  v_exp_f32 v39, v39
  v_cvt_pk_bf16_f32 v66, v36, v37
  v_exp_f32 v40, v40
  v_exp_f32 v41, v41
  v_cvt_pk_bf16_f32 v67, v38, v39
  v_exp_f32 v42, v42
  v_exp_f32 v43, v43
  v_cvt_pk_bf16_f32 v68, v40, v41
  v_mfma_f32_32x32x16_bf16 v[80:95], a[176:179], v[64:67], v[80:95]
  v_exp_f32 v44, v44
  v_exp_f32 v45, v45
  v_cvt_pk_bf16_f32 v69, v42, v43
  v_exp_f32 v46, v46
  v_exp_f32 v47, v47
  v_cvt_pk_bf16_f32 v70, v44, v45
  s_waitcnt vmcnt(0)
  v_exp_f32 v48, v48
  v_cvt_pk_bf16_f32 v71, v46, v47
  v_exp_f32 v49, v49
  v_mfma_f32_32x32x16_bf16 v[32:47], a[0:3], v[20:23], 0
  v_exp_f32 v50, v50
  v_exp_f32 v51, v51
  v_cvt_pk_bf16_f32 v72, v48, v49
  v_exp_f32 v52, v52
  v_exp_f32 v53, v53
  v_cvt_pk_bf16_f32 v73, v50, v51
  v_exp_f32 v54, v54
  v_xor_b32 v30, s21, v30
  v_xor_b32 v31, s21, v31
  v_cmp_lt_u32 vcc, 48, v1
  s_nop 1
  v_cndmask_b32 v30, v30, 0, vcc
  v_cmp_le_u32 vcc, 48, v1
  s_nop 1
  v_cndmask_b32 v31, v31, 0, vcc
  v_or_b32 v30, v30, v31
  v_cmp_ne_u32 vcc, 0, v30
  s_nop 4
  s_cbranch_vccz G0OK_43
  s_mov_b32 s52, 0
G0P_44:
  buffer_load_dwordx2 v[30:31], v29, s[4:7], s40 offen sc1
  s_waitcnt vmcnt(0)
  v_xor_b32 v30, s21, v30
  v_xor_b32 v31, s21, v31
  v_cmp_lt_u32 vcc, 48, v1
  s_nop 1
  v_cndmask_b32 v30, v30, 0, vcc
  v_cmp_le_u32 vcc, 48, v1
  s_nop 1
  v_cndmask_b32 v31, v31, 0, vcc
  v_or_b32 v30, v30, v31
  v_cmp_ne_u32 vcc, 0, v30
  s_nop 4
  s_cbranch_vccz G0OK_43
  s_add_u32 s52, s52, 1
  s_cmp_lt_u32 s52, 400000
  s_cbranch_scc1 G0P_44
  s_branch L_END
G0OK_43:
  v_mfma_f32_32x32x16_bf16 v[80:95], a[180:183], v[68:71], v[80:95]
  v_exp_f32 v55, v55
  v_cvt_pk_bf16_f32 v74, v52, v53
  v_exp_f32 v56, v56
  v_exp_f32 v57, v57
  v_cvt_pk_bf16_f32 v75, v54, v55
  v_exp_f32 v58, v58
  s_cmp_lg_u32 s22, 0
  s_cbranch_scc1 PTH1_41
  s_add_u32 s40, s29, s24
  buffer_load_dwordx4 v[128:131], v2, s[4:7], s40 offen
  buffer_load_dwordx4 v[132:135], v2, s[4:7], s40 offen offset:1024
  s_add_u32 s40, s32, s25
  buffer_load_dword v136, v12, s[4:7], s40 offen
  s_lshl_b32 s40, s17, 2
  s_add_u32 s40, s40, s18
  s_lshl_b32 s40, s40, 10
  s_lshl_b32 s41, s16, 16
  s_add_u32 s40, s40, s41
  s_add_u32 s40, s40, s34
  s_add_u32 s41, s40, 32768
  buffer_load_dwordx4 v[140:143], v2, s[4:7], s40 offen
  buffer_load_dwordx4 v[144:147], v2, s[4:7], s41 offen
  s_branch PTD_42
PTH1_41:
  v_and_b32 v139, 31, v1
  v_lshlrev_b32 v139, 11, v139
  v_lshrrev_b32 v148, 5, v1
  v_lshl_add_u32 v139, v148, 4, v139
  s_lshl_b32 s40, s16, 6
  s_add_u32 s40, s40, s19
  s_lshl_b32 s40, s40, 10
  s_lshl_b32 s41, s27, 6
  s_add_u32 s40, s40, s41
  buffer_load_dwordx4 v[128:131], v139, s[12:15], s40 offen
PTD_42:
  v_exp_f32 v59, v59
  v_cvt_pk_bf16_f32 v76, v56, v57
  v_mfma_f32_32x32x16_bf16 v[80:95], a[184:187], v[72:75], v[80:95]
  v_exp_f32 v60, v60
  v_exp_f32 v61, v61
  v_cvt_pk_bf16_f32 v77, v58, v59
  v_exp_f32 v62, v62
  s_add_u32 s56, s56, 1
  v_exp_f32 v63, v63
  v_cvt_pk_bf16_f32 v78, v60, v61
.p2align 3
ATTLOOP_45:
  v_exp_f32 v32, v32
  v_cvt_pk_bf16_f32 v79, v62, v63
  v_exp_f32 v33, v33
  v_mfma_f32_32x32x16_bf16 v[48:63], a[4:7], v[20:23], 0
  v_exp_f32 v34, v34
  v_exp_f32 v35, v35
  v_cvt_pk_bf16_f32 v64, v32, v33
  v_exp_f32 v36, v36
  v_exp_f32 v37, v37
  v_cvt_pk_bf16_f32 v65, v34, v35
  v_exp_f32 v38, v38
  v_mfma_f32_32x32x16_bf16 v[80:95], a[188:191], v[76:79], v[80:95]
  v_exp_f32 v39, v39
  v_cvt_pk_bf16_f32 v66, v36, v37
  v_exp_f32 v40, v40
  v_exp_f32 v41, v41
  v_cvt_pk_bf16_f32 v67, v38, v39
  v_add_u32 v28, 0x400, v28
  v_and_b32 v28, 0x1fff, v28
  v_exp_f32 v42, v42
  v_exp_f32 v43, v43
  v_cvt_pk_bf16_f32 v68, v40, v41
  v_mfma_f32_32x32x16_bf16 v[96:111], a[64:67], v[64:67], 0
  v_exp_f32 v44, v44
  v_exp_f32 v45, v45
  v_cvt_pk_bf16_f32 v69, v42, v43
  v_exp_f32 v46, v46
  v_exp_f32 v47, v47
  v_cvt_pk_bf16_f32 v70, v44, v45
  v_exp_f32 v48, v48
  v_cvt_pk_bf16_f32 v71, v46, v47
  v_exp_f32 v49, v49
  v_mfma_f32_32x32x16_bf16 v[32:47], a[8:11], v[20:23], 0
  v_exp_f32 v50, v50
  v_exp_f32 v51, v51
  v_cvt_pk_bf16_f32 v72, v48, v49
  v_exp_f32 v52, v52
  v_exp_f32 v53, v53
  v_cvt_pk_bf16_f32 v73, v50, v51
  v_exp_f32 v54, v54
  ds_write_b128 v24, v[80:83]
  ds_write_b128 v24, v[84:87] offset:1024
  ds_write_b32 v25, v88
  v_add_u32 v24, 2304, v24
  v_add_u32 v25, 2304, v25
  v_mfma_f32_32x32x16_bf16 v[96:111], a[68:71], v[68:71], v[96:111]
  v_exp_f32 v55, v55
  v_cvt_pk_bf16_f32 v74, v52, v53
  v_exp_f32 v56, v56
  v_exp_f32 v57, v57
  v_cvt_pk_bf16_f32 v75, v54, v55
  v_exp_f32 v58, v58
  v_exp_f32 v59, v59
  v_cvt_pk_bf16_f32 v76, v56, v57
  v_mfma_f32_32x32x16_bf16 v[96:111], a[72:75], v[72:75], v[96:111]
  v_exp_f32 v60, v60
  v_exp_f32 v61, v61
  v_cvt_pk_bf16_f32 v77, v58, v59
  v_exp_f32 v62, v62
  v_exp_f32 v63, v63
  v_cvt_pk_bf16_f32 v78, v60, v61
  v_exp_f32 v32, v32
  v_cvt_pk_bf16_f32 v79, v62, v63
  v_exp_f32 v33, v33
  v_mfma_f32_32x32x16_bf16 v[48:63], a[12:15], v[20:23], 0
  v_exp_f32 v34, v34
  v_exp_f32 v35, v35
  v_cvt_pk_bf16_f32 v64, v32, v33
  v_exp_f32 v36, v36
  v_exp_f32 v37, v37
  v_cvt_pk_bf16_f32 v65, v34, v35
  s_mov_b32 m0, s62
  s_add_u32 s62, s62, 4096
  buffer_load_dwordx4 v2, s[4:7], s63 offen offset:0 sc1 lds
  v_exp_f32 v38, v38
  v_mfma_f32_32x32x16_bf16 v[96:111], a[76:79], v[76:79], v[96:111]
  v_exp_f32 v39, v39
  v_cvt_pk_bf16_f32 v66, v36, v37
  buffer_load_dwordx4 v2, s[4:7], s63 offen offset:1024 sc1 lds
  v_exp_f32 v40, v40
  v_exp_f32 v41, v41
  v_cvt_pk_bf16_f32 v67, v38, v39
  buffer_load_dwordx4 v2, s[4:7], s63 offen offset:2048 sc1 lds
  v_exp_f32 v42, v42
  v_exp_f32 v43, v43
  v_cvt_pk_bf16_f32 v68, v40, v41
  buffer_load_dwordx4 v2, s[4:7], s63 offen offset:3072 sc1 lds
  s_add_u32 s63, s63, 4096
  v_mfma_f32_32x32x16_bf16 v[96:111], a[80:83], v[64:67], v[96:111]
  v_exp_f32 v44, v44
  v_exp_f32 v45, v45
  v_cvt_pk_bf16_f32 v69, v42, v43
  v_exp_f32 v46, v46
  v_exp_f32 v47, v47
  v_cvt_pk_bf16_f32 v70, v44, v45
  v_exp_f32 v48, v48
  v_cvt_pk_bf16_f32 v71, v46, v47
  v_exp_f32 v49, v49
  v_mfma_f32_32x32x16_bf16 v[32:47], a[16:19], v[20:23], 0
  v_exp_f32 v50, v50
  v_exp_f32 v51, v51
  v_cvt_pk_bf16_f32 v72, v48, v49
  v_exp_f32 v52, v52
  v_exp_f32 v53, v53
  v_cvt_pk_bf16_f32 v73, v50, v51
  v_exp_f32 v54, v54
  v_mfma_f32_32x32x16_bf16 v[96:111], a[84:87], v[68:71], v[96:111]
  v_exp_f32 v55, v55
  v_cvt_pk_bf16_f32 v74, v52, v53
  v_exp_f32 v56, v56
  v_exp_f32 v57, v57
  v_cvt_pk_bf16_f32 v75, v54, v55
  v_exp_f32 v58, v58
  v_exp_f32 v59, v59
  v_cvt_pk_bf16_f32 v76, v56, v57
  v_mfma_f32_32x32x16_bf16 v[96:111], a[88:91], v[72:75], v[96:111]
  v_exp_f32 v60, v60
  v_exp_f32 v61, v61
  v_cvt_pk_bf16_f32 v77, v58, v59
  v_exp_f32 v62, v62
  v_exp_f32 v63, v63
  v_cvt_pk_bf16_f32 v78, v60, v61
  v_exp_f32 v32, v32
  v_cvt_pk_bf16_f32 v79, v62, v63
  v_exp_f32 v33, v33
  v_mfma_f32_32x32x16_bf16 v[48:63], a[20:23], v[20:23], 0
  v_exp_f32 v34, v34
  v_exp_f32 v35, v35
  v_cvt_pk_bf16_f32 v64, v32, v33
  v_exp_f32 v36, v36
  v_exp_f32 v37, v37
  v_cvt_pk_bf16_f32 v65, v34, v35
  ds_read_b128 v[16:19], v28 offset:0
  v_exp_f32 v38, v38
  v_mfma_f32_32x32x16_bf16 v[96:111], a[92:95], v[76:79], v[96:111]
  v_exp_f32 v39, v39
  v_cvt_pk_bf16_f32 v66, v36, v37
  v_exp_f32 v40, v40
  v_exp_f32 v41, v41
  v_cvt_pk_bf16_f32 v67, v38, v39
  v_exp_f32 v42, v42
  v_exp_f32 v43, v43
  v_cvt_pk_bf16_f32 v68, v40, v41
  v_mfma_f32_32x32x16_bf16 v[96:111], a[96:99], v[64:67], v[96:111]
  v_exp_f32 v44, v44
  v_exp_f32 v45, v45
  v_cvt_pk_bf16_f32 v69, v42, v43
  v_exp_f32 v46, v46
  v_exp_f32 v47, v47
  v_cvt_pk_bf16_f32 v70, v44, v45
  v_exp_f32 v48, v48
  v_cvt_pk_bf16_f32 v71, v46, v47
  v_exp_f32 v49, v49
  v_mfma_f32_32x32x16_bf16 v[32:47], a[24:27], v[20:23], 0
  v_exp_f32 v50, v50
  v_exp_f32 v51, v51
  v_cvt_pk_bf16_f32 v72, v48, v49
  v_exp_f32 v52, v52
  v_exp_f32 v53, v53
  v_cvt_pk_bf16_f32 v73, v50, v51
  v_exp_f32 v54, v54
  v_mfma_f32_32x32x16_bf16 v[96:111], a[100:103], v[68:71], v[96:111]
  v_exp_f32 v55, v55
  v_cvt_pk_bf16_f32 v74, v52, v53
  v_exp_f32 v56, v56
  v_exp_f32 v57, v57
  v_cvt_pk_bf16_f32 v75, v54, v55
  v_exp_f32 v58, v58
  v_exp_f32 v59, v59
  v_cvt_pk_bf16_f32 v76, v56, v57
  v_mfma_f32_32x32x16_bf16 v[96:111], a[104:107], v[72:75], v[96:111]
  v_exp_f32 v60, v60
  v_exp_f32 v61, v61
  v_cvt_pk_bf16_f32 v77, v58, v59
  v_exp_f32 v62, v62
  v_exp_f32 v63, v63
  v_cvt_pk_bf16_f32 v78, v60, v61
  v_exp_f32 v32, v32
  v_cvt_pk_bf16_f32 v79, v62, v63
  v_exp_f32 v33, v33
  v_mfma_f32_32x32x16_bf16 v[48:63], a[28:31], v[20:23], 0
  v_exp_f32 v34, v34
  v_exp_f32 v35, v35
  v_cvt_pk_bf16_f32 v64, v32, v33
  v_exp_f32 v36, v36
  v_exp_f32 v37, v37
  v_cvt_pk_bf16_f32 v65, v34, v35
  v_exp_f32 v38, v38
  v_mfma_f32_32x32x16_bf16 v[96:111], a[108:111], v[76:79], v[96:111]
  v_exp_f32 v39, v39
  v_cvt_pk_bf16_f32 v66, v36, v37
  v_exp_f32 v40, v40
  v_exp_f32 v41, v41
  v_cvt_pk_bf16_f32 v67, v38, v39
  v_exp_f32 v42, v42
  v_exp_f32 v43, v43
  v_cvt_pk_bf16_f32 v68, v40, v41
  v_mfma_f32_32x32x16_bf16 v[96:111], a[112:115], v[64:67], v[96:111]
  v_exp_f32 v44, v44
  v_exp_f32 v45, v45
  v_cvt_pk_bf16_f32 v69, v42, v43
  v_exp_f32 v46, v46
  v_exp_f32 v47, v47
  v_cvt_pk_bf16_f32 v70, v44, v45
  v_exp_f32 v48, v48
  v_cvt_pk_bf16_f32 v71, v46, v47
  v_exp_f32 v49, v49
  v_mfma_f32_32x32x16_bf16 v[32:47], a[32:35], v[20:23], 0
  v_exp_f32 v50, v50
  v_exp_f32 v51, v51
  v_cvt_pk_bf16_f32 v72, v48, v49
  v_exp_f32 v52, v52
  v_exp_f32 v53, v53
  v_cvt_pk_bf16_f32 v73, v50, v51
  v_exp_f32 v54, v54
  v_mfma_f32_32x32x16_bf16 v[96:111], a[116:119], v[68:71], v[96:111]
  v_exp_f32 v55, v55
  v_cvt_pk_bf16_f32 v74, v52, v53
  v_exp_f32 v56, v56
  v_exp_f32 v57, v57
  v_cvt_pk_bf16_f32 v75, v54, v55
  v_exp_f32 v58, v58
  v_exp_f32 v59, v59
  v_cvt_pk_bf16_f32 v76, v56, v57
  v_mfma_f32_32x32x16_bf16 v[96:111], a[120:123], v[72:75], v[96:111]
  v_exp_f32 v60, v60
  v_exp_f32 v61, v61
  v_cvt_pk_bf16_f32 v77, v58, v59
  v_exp_f32 v62, v62
  v_exp_f32 v63, v63
  v_cvt_pk_bf16_f32 v78, v60, v61
  v_exp_f32 v32, v32
  v_cvt_pk_bf16_f32 v79, v62, v63
  v_exp_f32 v33, v33
  v_mfma_f32_32x32x16_bf16 v[48:63], a[36:39], v[20:23], 0
  v_exp_f32 v34, v34
  v_exp_f32 v35, v35
  v_cvt_pk_bf16_f32 v64, v32, v33
  v_exp_f32 v36, v36
  v_exp_f32 v37, v37
  v_cvt_pk_bf16_f32 v65, v34, v35
  v_exp_f32 v38, v38
  v_mfma_f32_32x32x16_bf16 v[96:111], a[124:127], v[76:79], v[96:111]
  v_exp_f32 v39, v39
  v_cvt_pk_bf16_f32 v66, v36, v37
  v_exp_f32 v40, v40
  v_exp_f32 v41, v41
  v_cvt_pk_bf16_f32 v67, v38, v39
  v_exp_f32 v42, v42
  v_exp_f32 v43, v43
  v_cvt_pk_bf16_f32 v68, v40, v41
  v_mfma_f32_32x32x16_bf16 v[96:111], a[128:131], v[64:67], v[96:111]
  v_exp_f32 v44, v44
  v_exp_f32 v45, v45
  v_cvt_pk_bf16_f32 v69, v42, v43
  v_exp_f32 v46, v46
  v_exp_f32 v47, v47
  v_cvt_pk_bf16_f32 v70, v44, v45
  v_exp_f32 v48, v48
  v_cvt_pk_bf16_f32 v71, v46, v47
  v_exp_f32 v49, v49
  v_mfma_f32_32x32x16_bf16 v[32:47], a[40:43], v[20:23], 0
  v_exp_f32 v50, v50
  v_exp_f32 v51, v51
  v_cvt_pk_bf16_f32 v72, v48, v49
  v_exp_f32 v52, v52
  v_exp_f32 v53, v53
  v_cvt_pk_bf16_f32 v73, v50, v51
  v_exp_f32 v54, v54
  v_mfma_f32_32x32x16_bf16 v[96:111], a[132:135], v[68:71], v[96:111]
  v_exp_f32 v55, v55
  v_cvt_pk_bf16_f32 v74, v52, v53
  v_exp_f32 v56, v56
  v_exp_f32 v57, v57
  v_cvt_pk_bf16_f32 v75, v54, v55
  v_exp_f32 v58, v58
  v_exp_f32 v59, v59
  v_cvt_pk_bf16_f32 v76, v56, v57
  v_mfma_f32_32x32x16_bf16 v[96:111], a[136:139], v[72:75], v[96:111]
  v_exp_f32 v60, v60
  v_exp_f32 v61, v61
  v_cvt_pk_bf16_f32 v77, v58, v59
  v_exp_f32 v62, v62
  v_exp_f32 v63, v63
  v_cvt_pk_bf16_f32 v78, v60, v61
  v_exp_f32 v32, v32
  v_cvt_pk_bf16_f32 v79, v62, v63
  v_exp_f32 v33, v33
  v_mfma_f32_32x32x16_bf16 v[48:63], a[44:47], v[20:23], 0
  v_exp_f32 v34, v34
  v_exp_f32 v35, v35
  v_cvt_pk_bf16_f32 v64, v32, v33
  v_exp_f32 v36, v36
  v_exp_f32 v37, v37
  v_cvt_pk_bf16_f32 v65, v34, v35
  v_exp_f32 v38, v38
  v_mfma_f32_32x32x16_bf16 v[96:111], a[140:143], v[76:79], v[96:111]
  v_exp_f32 v39, v39
  v_cvt_pk_bf16_f32 v66, v36, v37
  v_exp_f32 v40, v40
  v_exp_f32 v41, v41
  v_cvt_pk_bf16_f32 v67, v38, v39
  v_exp_f32 v42, v42
  v_exp_f32 v43, v43
  v_cvt_pk_bf16_f32 v68, v40, v41
  v_mfma_f32_32x32x16_bf16 v[96:111], a[144:147], v[64:67], v[96:111]
  v_exp_f32 v44, v44
  v_exp_f32 v45, v45
  v_cvt_pk_bf16_f32 v69, v42, v43
  v_exp_f32 v46, v46
  v_exp_f32 v47, v47
  v_cvt_pk_bf16_f32 v70, v44, v45
  v_exp_f32 v48, v48
  v_cvt_pk_bf16_f32 v71, v46, v47
  v_exp_f32 v49, v49
  v_mfma_f32_32x32x16_bf16 v[32:47], a[48:51], v[20:23], 0
  v_exp_f32 v50, v50
  v_exp_f32 v51, v51
  v_cvt_pk_bf16_f32 v72, v48, v49
  v_exp_f32 v52, v52
  v_exp_f32 v53, v53
  v_cvt_pk_bf16_f32 v73, v50, v51
  v_exp_f32 v54, v54
  v_mfma_f32_32x32x16_bf16 v[96:111], a[148:151], v[68:71], v[96:111]
  v_exp_f32 v55, v55
  v_cvt_pk_bf16_f32 v74, v52, v53
  v_exp_f32 v56, v56
  v_exp_f32 v57, v57
  v_cvt_pk_bf16_f32 v75, v54, v55
  v_exp_f32 v58, v58
  v_exp_f32 v59, v59
  v_cvt_pk_bf16_f32 v76, v56, v57
  v_mfma_f32_32x32x16_bf16 v[96:111], a[152:155], v[72:75], v[96:111]
  v_exp_f32 v60, v60
  v_exp_f32 v61, v61
  v_cvt_pk_bf16_f32 v77, v58, v59
  v_exp_f32 v62, v62
  v_exp_f32 v63, v63
  v_cvt_pk_bf16_f32 v78, v60, v61
  v_exp_f32 v32, v32
  v_cvt_pk_bf16_f32 v79, v62, v63
  v_exp_f32 v33, v33
  v_mfma_f32_32x32x16_bf16 v[48:63], a[52:55], v[20:23], 0
  v_exp_f32 v34, v34
  v_exp_f32 v35, v35
  v_cvt_pk_bf16_f32 v64, v32, v33
  v_exp_f32 v36, v36
  v_exp_f32 v37, v37
  v_cvt_pk_bf16_f32 v65, v34, v35
  v_exp_f32 v38, v38
  v_mfma_f32_32x32x16_bf16 v[96:111], a[156:159], v[76:79], v[96:111]
  v_exp_f32 v39, v39
  v_cvt_pk_bf16_f32 v66, v36, v37
  v_exp_f32 v40, v40
  v_exp_f32 v41, v41
  v_cvt_pk_bf16_f32 v67, v38, v39
  v_exp_f32 v42, v42
  v_exp_f32 v43, v43
  v_cvt_pk_bf16_f32 v68, v40, v41
  v_mfma_f32_32x32x16_bf16 v[96:111], a[160:163], v[64:67], v[96:111]
  v_exp_f32 v44, v44
  v_exp_f32 v45, v45
  v_cvt_pk_bf16_f32 v69, v42, v43
  v_exp_f32 v46, v46
  v_exp_f32 v47, v47
  v_cvt_pk_bf16_f32 v70, v44, v45
  v_exp_f32 v48, v48
  v_cvt_pk_bf16_f32 v71, v46, v47
  v_exp_f32 v49, v49
  v_mfma_f32_32x32x16_bf16 v[32:47], a[56:59], v[20:23], 0
  v_exp_f32 v50, v50
  v_exp_f32 v51, v51
  v_cvt_pk_bf16_f32 v72, v48, v49
  v_exp_f32 v52, v52
  v_exp_f32 v53, v53
  v_cvt_pk_bf16_f32 v73, v50, v51
  v_exp_f32 v54, v54
  v_mfma_f32_32x32x16_bf16 v[96:111], a[164:167], v[68:71], v[96:111]
  v_exp_f32 v55, v55
  v_cvt_pk_bf16_f32 v74, v52, v53
  v_exp_f32 v56, v56
  v_exp_f32 v57, v57
  v_cvt_pk_bf16_f32 v75, v54, v55
  v_exp_f32 v58, v58
  v_exp_f32 v59, v59
  v_cvt_pk_bf16_f32 v76, v56, v57
  v_mfma_f32_32x32x16_bf16 v[96:111], a[168:171], v[72:75], v[96:111]
  v_exp_f32 v60, v60
  v_exp_f32 v61, v61
  v_cvt_pk_bf16_f32 v77, v58, v59
  v_exp_f32 v62, v62
  v_exp_f32 v63, v63
  v_cvt_pk_bf16_f32 v78, v60, v61
  v_exp_f32 v32, v32
  v_cvt_pk_bf16_f32 v79, v62, v63
  v_exp_f32 v33, v33
  v_mfma_f32_32x32x16_bf16 v[48:63], a[60:63], v[20:23], 0
  v_exp_f32 v34, v34
  v_exp_f32 v35, v35
  v_cvt_pk_bf16_f32 v64, v32, v33
  v_exp_f32 v36, v36
  s_waitcnt lgkmcnt(0)
  v_exp_f32 v37, v37
  v_cvt_pk_bf16_f32 v65, v34, v35
  v_exp_f32 v38, v38
  v_mfma_f32_32x32x16_bf16 v[96:111], a[172:175], v[76:79], v[96:111]
  v_exp_f32 v39, v39
  v_cvt_pk_bf16_f32 v66, v36, v37
  v_exp_f32 v40, v40
  v_exp_f32 v41, v41
  v_cvt_pk_bf16_f32 v67, v38, v39
  v_exp_f32 v42, v42
  v_exp_f32 v43, v43
  v_cvt_pk_bf16_f32 v68, v40, v41
  v_mfma_f32_32x32x16_bf16 v[96:111], a[176:179], v[64:67], v[96:111]
  v_exp_f32 v44, v44
  v_exp_f32 v45, v45
  v_cvt_pk_bf16_f32 v69, v42, v43
  v_exp_f32 v46, v46
  v_exp_f32 v47, v47
  v_cvt_pk_bf16_f32 v70, v44, v45
  v_exp_f32 v48, v48
  v_cvt_pk_bf16_f32 v71, v46, v47
  v_exp_f32 v49, v49
  v_mfma_f32_32x32x16_bf16 v[32:47], a[0:3], v[16:19], 0
  v_exp_f32 v50, v50
  v_exp_f32 v51, v51
  v_cvt_pk_bf16_f32 v72, v48, v49
  v_exp_f32 v52, v52
  v_exp_f32 v53, v53
  v_cvt_pk_bf16_f32 v73, v50, v51
  v_exp_f32 v54, v54
  v_mfma_f32_32x32x16_bf16 v[96:111], a[180:183], v[68:71], v[96:111]
  v_exp_f32 v55, v55
  v_cvt_pk_bf16_f32 v74, v52, v53
  v_exp_f32 v56, v56
  v_exp_f32 v57, v57
  v_cvt_pk_bf16_f32 v75, v54, v55
  v_exp_f32 v58, v58
  v_exp_f32 v59, v59
  v_cvt_pk_bf16_f32 v76, v56, v57
  v_mfma_f32_32x32x16_bf16 v[96:111], a[184:187], v[72:75], v[96:111]
  v_exp_f32 v60, v60
  v_exp_f32 v61, v61
  v_cvt_pk_bf16_f32 v77, v58, v59
  v_exp_f32 v62, v62
  s_add_u32 s56, s56, 1
  v_exp_f32 v63, v63
  v_cvt_pk_bf16_f32 v78, v60, v61
  v_exp_f32 v32, v32
  v_cvt_pk_bf16_f32 v79, v62, v63
  v_exp_f32 v33, v33
  v_mfma_f32_32x32x16_bf16 v[48:63], a[4:7], v[16:19], 0
  v_exp_f32 v34, v34
  v_exp_f32 v35, v35
  v_cvt_pk_bf16_f32 v64, v32, v33
  v_exp_f32 v36, v36
  v_exp_f32 v37, v37
  v_cvt_pk_bf16_f32 v65, v34, v35
  v_exp_f32 v38, v38
  v_mfma_f32_32x32x16_bf16 v[96:111], a[188:191], v[76:79], v[96:111]
  v_exp_f32 v39, v39
  v_cvt_pk_bf16_f32 v66, v36, v37
  v_exp_f32 v40, v40
  v_exp_f32 v41, v41
  v_cvt_pk_bf16_f32 v67, v38, v39
  v_add_u32 v28, 0x400, v28
  v_and_b32 v28, 0x1fff, v28
  v_exp_f32 v42, v42
  v_exp_f32 v43, v43
  v_cvt_pk_bf16_f32 v68, v40, v41
  v_mfma_f32_32x32x16_bf16 v[80:95], a[64:67], v[64:67], 0
  v_exp_f32 v44, v44
  v_exp_f32 v45, v45
  v_cvt_pk_bf16_f32 v69, v42, v43
  v_exp_f32 v46, v46
  v_exp_f32 v47, v47
  v_cvt_pk_bf16_f32 v70, v44, v45
  v_exp_f32 v48, v48
  v_cvt_pk_bf16_f32 v71, v46, v47
  v_exp_f32 v49, v49
  v_mfma_f32_32x32x16_bf16 v[32:47], a[8:11], v[16:19], 0
  v_exp_f32 v50, v50
  v_exp_f32 v51, v51
  v_cvt_pk_bf16_f32 v72, v48, v49
  v_exp_f32 v52, v52
  v_exp_f32 v53, v53
  v_cvt_pk_bf16_f32 v73, v50, v51
  v_exp_f32 v54, v54
  ds_write_b128 v24, v[96:99]
  ds_write_b128 v24, v[100:103] offset:1024
  ds_write_b32 v25, v104
  v_add_u32 v24, 2304, v24
  v_add_u32 v25, 2304, v25
  v_mfma_f32_32x32x16_bf16 v[80:95], a[68:71], v[68:71], v[80:95]
  v_exp_f32 v55, v55
  v_cvt_pk_bf16_f32 v74, v52, v53
  v_exp_f32 v56, v56
  v_exp_f32 v57, v57
  v_cvt_pk_bf16_f32 v75, v54, v55
  v_exp_f32 v58, v58
  v_exp_f32 v59, v59
  v_cvt_pk_bf16_f32 v76, v56, v57
  v_mfma_f32_32x32x16_bf16 v[80:95], a[72:75], v[72:75], v[80:95]
  v_exp_f32 v60, v60
  v_exp_f32 v61, v61
  v_cvt_pk_bf16_f32 v77, v58, v59
  v_exp_f32 v62, v62
  v_exp_f32 v63, v63
  v_cvt_pk_bf16_f32 v78, v60, v61
  v_exp_f32 v32, v32
  v_cvt_pk_bf16_f32 v79, v62, v63
  v_exp_f32 v33, v33
  v_mfma_f32_32x32x16_bf16 v[48:63], a[12:15], v[16:19], 0
  v_exp_f32 v34, v34
  v_exp_f32 v35, v35
  v_cvt_pk_bf16_f32 v64, v32, v33
  v_exp_f32 v36, v36
  v_exp_f32 v37, v37
  v_cvt_pk_bf16_f32 v65, v34, v35
  v_exp_f32 v38, v38
  v_mfma_f32_32x32x16_bf16 v[80:95], a[76:79], v[76:79], v[80:95]
  v_exp_f32 v39, v39
  v_cvt_pk_bf16_f32 v66, v36, v37
  v_exp_f32 v40, v40
  v_exp_f32 v41, v41
  v_cvt_pk_bf16_f32 v67, v38, v39
  v_exp_f32 v42, v42
  v_exp_f32 v43, v43
  v_cvt_pk_bf16_f32 v68, v40, v41
  v_mfma_f32_32x32x16_bf16 v[80:95], a[80:83], v[64:67], v[80:95]
  v_exp_f32 v44, v44
  v_exp_f32 v45, v45
  v_cvt_pk_bf16_f32 v69, v42, v43
  v_exp_f32 v46, v46
  v_exp_f32 v47, v47
  v_cvt_pk_bf16_f32 v70, v44, v45
  v_exp_f32 v48, v48
  v_cvt_pk_bf16_f32 v71, v46, v47
  v_exp_f32 v49, v49
  v_mfma_f32_32x32x16_bf16 v[32:47], a[16:19], v[16:19], 0
  v_exp_f32 v50, v50
  v_exp_f32 v51, v51
  v_cvt_pk_bf16_f32 v72, v48, v49
  v_exp_f32 v52, v52
  v_exp_f32 v53, v53
  v_cvt_pk_bf16_f32 v73, v50, v51
  v_exp_f32 v54, v54
  v_mfma_f32_32x32x16_bf16 v[80:95], a[84:87], v[68:71], v[80:95]
  v_exp_f32 v55, v55
  v_cvt_pk_bf16_f32 v74, v52, v53
  v_exp_f32 v56, v56
  v_exp_f32 v57, v57
  v_cvt_pk_bf16_f32 v75, v54, v55
  v_exp_f32 v58, v58
  v_exp_f32 v59, v59
  v_cvt_pk_bf16_f32 v76, v56, v57
  v_mfma_f32_32x32x16_bf16 v[80:95], a[88:91], v[72:75], v[80:95]
  v_exp_f32 v60, v60
  v_exp_f32 v61, v61
  v_cvt_pk_bf16_f32 v77, v58, v59
  v_exp_f32 v62, v62
  v_exp_f32 v63, v63
  v_cvt_pk_bf16_f32 v78, v60, v61
  v_exp_f32 v32, v32
  v_cvt_pk_bf16_f32 v79, v62, v63
  v_exp_f32 v33, v33
  v_mfma_f32_32x32x16_bf16 v[48:63], a[20:23], v[16:19], 0
  v_exp_f32 v34, v34
  v_exp_f32 v35, v35
  v_cvt_pk_bf16_f32 v64, v32, v33
  v_exp_f32 v36, v36
  v_exp_f32 v37, v37
  v_cvt_pk_bf16_f32 v65, v34, v35
  ds_read_b128 v[20:23], v28 offset:0
  v_exp_f32 v38, v38
  v_mfma_f32_32x32x16_bf16 v[80:95], a[92:95], v[76:79], v[80:95]
  v_exp_f32 v39, v39
  v_cvt_pk_bf16_f32 v66, v36, v37
  v_exp_f32 v40, v40
  v_exp_f32 v41, v41
  v_cvt_pk_bf16_f32 v67, v38, v39
  v_exp_f32 v42, v42
  v_exp_f32 v43, v43
  v_cvt_pk_bf16_f32 v68, v40, v41
  v_mfma_f32_32x32x16_bf16 v[80:95], a[96:99], v[64:67], v[80:95]
  v_exp_f32 v44, v44
  v_exp_f32 v45, v45
  v_cvt_pk_bf16_f32 v69, v42, v43
  v_exp_f32 v46, v46
  v_exp_f32 v47, v47
  v_cvt_pk_bf16_f32 v70, v44, v45
  v_exp_f32 v48, v48
  v_cvt_pk_bf16_f32 v71, v46, v47
  v_exp_f32 v49, v49
  v_mfma_f32_32x32x16_bf16 v[32:47], a[24:27], v[16:19], 0
  v_exp_f32 v50, v50
  v_exp_f32 v51, v51
  v_cvt_pk_bf16_f32 v72, v48, v49
  v_exp_f32 v52, v52
  v_exp_f32 v53, v53
  v_cvt_pk_bf16_f32 v73, v50, v51
  v_exp_f32 v54, v54
  v_mfma_f32_32x32x16_bf16 v[80:95], a[100:103], v[68:71], v[80:95]
  v_exp_f32 v55, v55
  v_cvt_pk_bf16_f32 v74, v52, v53
  v_exp_f32 v56, v56
  v_exp_f32 v57, v57
  v_cvt_pk_bf16_f32 v75, v54, v55
  v_exp_f32 v58, v58
  v_exp_f32 v59, v59
  v_cvt_pk_bf16_f32 v76, v56, v57
  v_mfma_f32_32x32x16_bf16 v[80:95], a[104:107], v[72:75], v[80:95]
  v_exp_f32 v60, v60
  v_exp_f32 v61, v61
  v_cvt_pk_bf16_f32 v77, v58, v59
  v_exp_f32 v62, v62
  v_exp_f32 v63, v63
  v_cvt_pk_bf16_f32 v78, v60, v61
  v_exp_f32 v32, v32
  v_cvt_pk_bf16_f32 v79, v62, v63
  v_exp_f32 v33, v33
  v_mfma_f32_32x32x16_bf16 v[48:63], a[28:31], v[16:19], 0
  v_exp_f32 v34, v34
  v_exp_f32 v35, v35
  v_cvt_pk_bf16_f32 v64, v32, v33
  v_exp_f32 v36, v36
  v_exp_f32 v37, v37
  v_cvt_pk_bf16_f32 v65, v34, v35
  v_exp_f32 v38, v38
  v_mfma_f32_32x32x16_bf16 v[80:95], a[108:111], v[76:79], v[80:95]
  v_exp_f32 v39, v39
  v_cvt_pk_bf16_f32 v66, v36, v37
  v_exp_f32 v40, v40
  v_exp_f32 v41, v41
  v_cvt_pk_bf16_f32 v67, v38, v39
  v_exp_f32 v42, v42
  v_exp_f32 v43, v43
  v_cvt_pk_bf16_f32 v68, v40, v41
  v_mfma_f32_32x32x16_bf16 v[80:95], a[112:115], v[64:67], v[80:95]
  v_exp_f32 v44, v44
  v_exp_f32 v45, v45
  v_cvt_pk_bf16_f32 v69, v42, v43
  v_exp_f32 v46, v46
  v_exp_f32 v47, v47
  v_cvt_pk_bf16_f32 v70, v44, v45
  v_exp_f32 v48, v48
  v_cvt_pk_bf16_f32 v71, v46, v47
  v_exp_f32 v49, v49
  v_mfma_f32_32x32x16_bf16 v[32:47], a[32:35], v[16:19], 0
  v_exp_f32 v50, v50
  v_exp_f32 v51, v51
  v_cvt_pk_bf16_f32 v72, v48, v49
  v_exp_f32 v52, v52
  v_exp_f32 v53, v53
  v_cvt_pk_bf16_f32 v73, v50, v51
  v_exp_f32 v54, v54
  v_mfma_f32_32x32x16_bf16 v[80:95], a[116:119], v[68:71], v[80:95]
  v_exp_f32 v55, v55
  v_cvt_pk_bf16_f32 v74, v52, v53
  v_exp_f32 v56, v56
  v_exp_f32 v57, v57
  v_cvt_pk_bf16_f32 v75, v54, v55
  v_exp_f32 v58, v58
  v_exp_f32 v59, v59
  v_cvt_pk_bf16_f32 v76, v56, v57
  v_mfma_f32_32x32x16_bf16 v[80:95], a[120:123], v[72:75], v[80:95]
  v_exp_f32 v60, v60
  v_exp_f32 v61, v61
  v_cvt_pk_bf16_f32 v77, v58, v59
  v_exp_f32 v62, v62
  v_exp_f32 v63, v63
  v_cvt_pk_bf16_f32 v78, v60, v61
  v_exp_f32 v32, v32
  v_cvt_pk_bf16_f32 v79, v62, v63
  v_exp_f32 v33, v33
  v_mfma_f32_32x32x16_bf16 v[48:63], a[36:39], v[16:19], 0
  v_exp_f32 v34, v34
  v_exp_f32 v35, v35
  v_cvt_pk_bf16_f32 v64, v32, v33
  v_exp_f32 v36, v36
  v_exp_f32 v37, v37
  v_cvt_pk_bf16_f32 v65, v34, v35
  v_exp_f32 v38, v38
  v_mfma_f32_32x32x16_bf16 v[80:95], a[124:127], v[76:79], v[80:95]
  v_exp_f32 v39, v39
  v_cvt_pk_bf16_f32 v66, v36, v37
  v_exp_f32 v40, v40
  v_exp_f32 v41, v41
  v_cvt_pk_bf16_f32 v67, v38, v39
  v_exp_f32 v42, v42
  v_exp_f32 v43, v43
  v_cvt_pk_bf16_f32 v68, v40, v41
  v_mfma_f32_32x32x16_bf16 v[80:95], a[128:131], v[64:67], v[80:95]
  v_exp_f32 v44, v44
  v_exp_f32 v45, v45
  v_cvt_pk_bf16_f32 v69, v42, v43
  v_exp_f32 v46, v46
  v_exp_f32 v47, v47
  v_cvt_pk_bf16_f32 v70, v44, v45
  v_exp_f32 v48, v48
  v_cvt_pk_bf16_f32 v71, v46, v47
  v_exp_f32 v49, v49
  v_mfma_f32_32x32x16_bf16 v[32:47], a[40:43], v[16:19], 0
  v_exp_f32 v50, v50
  v_exp_f32 v51, v51
  v_cvt_pk_bf16_f32 v72, v48, v49
  v_exp_f32 v52, v52
  v_exp_f32 v53, v53
  v_cvt_pk_bf16_f32 v73, v50, v51
  v_exp_f32 v54, v54
  v_mfma_f32_32x32x16_bf16 v[80:95], a[132:135], v[68:71], v[80:95]
  v_exp_f32 v55, v55
  v_cvt_pk_bf16_f32 v74, v52, v53
  v_exp_f32 v56, v56
  v_exp_f32 v57, v57
  v_cvt_pk_bf16_f32 v75, v54, v55
  v_exp_f32 v58, v58
  v_exp_f32 v59, v59
  v_cvt_pk_bf16_f32 v76, v56, v57
  v_mfma_f32_32x32x16_bf16 v[80:95], a[136:139], v[72:75], v[80:95]
  v_exp_f32 v60, v60
  v_exp_f32 v61, v61
  v_cvt_pk_bf16_f32 v77, v58, v59
  v_exp_f32 v62, v62
  v_exp_f32 v63, v63
  v_cvt_pk_bf16_f32 v78, v60, v61
  v_exp_f32 v32, v32
  v_cvt_pk_bf16_f32 v79, v62, v63
  v_exp_f32 v33, v33
  v_mfma_f32_32x32x16_bf16 v[48:63], a[44:47], v[16:19], 0
  v_exp_f32 v34, v34
  v_exp_f32 v35, v35
  v_cvt_pk_bf16_f32 v64, v32, v33
  v_exp_f32 v36, v36
  v_exp_f32 v37, v37
  v_cvt_pk_bf16_f32 v65, v34, v35
  v_exp_f32 v38, v38
  v_mfma_f32_32x32x16_bf16 v[80:95], a[140:143], v[76:79], v[80:95]
  v_exp_f32 v39, v39
  v_cvt_pk_bf16_f32 v66, v36, v37
  v_exp_f32 v40, v40
  v_exp_f32 v41, v41
  v_cvt_pk_bf16_f32 v67, v38, v39
  v_exp_f32 v42, v42
  v_exp_f32 v43, v43
  v_cvt_pk_bf16_f32 v68, v40, v41
  v_mfma_f32_32x32x16_bf16 v[80:95], a[144:147], v[64:67], v[80:95]
  v_exp_f32 v44, v44
  v_exp_f32 v45, v45
  v_cvt_pk_bf16_f32 v69, v42, v43
  v_exp_f32 v46, v46
  v_exp_f32 v47, v47
  v_cvt_pk_bf16_f32 v70, v44, v45
  v_exp_f32 v48, v48
  v_cvt_pk_bf16_f32 v71, v46, v47
  v_exp_f32 v49, v49
  v_mfma_f32_32x32x16_bf16 v[32:47], a[48:51], v[16:19], 0
  v_exp_f32 v50, v50
  v_exp_f32 v51, v51
  v_cvt_pk_bf16_f32 v72, v48, v49
  v_exp_f32 v52, v52
  v_exp_f32 v53, v53
  v_cvt_pk_bf16_f32 v73, v50, v51
  v_exp_f32 v54, v54
  v_mfma_f32_32x32x16_bf16 v[80:95], a[148:151], v[68:71], v[80:95]
  v_exp_f32 v55, v55
  v_cvt_pk_bf16_f32 v74, v52, v53
  v_exp_f32 v56, v56
  v_exp_f32 v57, v57
  v_cvt_pk_bf16_f32 v75, v54, v55
  v_exp_f32 v58, v58
  v_exp_f32 v59, v59
  v_cvt_pk_bf16_f32 v76, v56, v57
  v_mfma_f32_32x32x16_bf16 v[80:95], a[152:155], v[72:75], v[80:95]
  v_exp_f32 v60, v60
  v_exp_f32 v61, v61
  v_cvt_pk_bf16_f32 v77, v58, v59
  v_exp_f32 v62, v62
  v_exp_f32 v63, v63
  v_cvt_pk_bf16_f32 v78, v60, v61
  v_exp_f32 v32, v32
  v_cvt_pk_bf16_f32 v79, v62, v63
  v_exp_f32 v33, v33
  v_mfma_f32_32x32x16_bf16 v[48:63], a[52:55], v[16:19], 0
  v_exp_f32 v34, v34
  v_exp_f32 v35, v35
  v_cvt_pk_bf16_f32 v64, v32, v33
  v_exp_f32 v36, v36
  v_exp_f32 v37, v37
  v_cvt_pk_bf16_f32 v65, v34, v35
  v_exp_f32 v38, v38
  v_mfma_f32_32x32x16_bf16 v[80:95], a[156:159], v[76:79], v[80:95]
  v_exp_f32 v39, v39
  v_cvt_pk_bf16_f32 v66, v36, v37
  v_exp_f32 v40, v40
  v_exp_f32 v41, v41
  v_cvt_pk_bf16_f32 v67, v38, v39
  v_exp_f32 v42, v42
  v_exp_f32 v43, v43
  v_cvt_pk_bf16_f32 v68, v40, v41
  v_mfma_f32_32x32x16_bf16 v[80:95], a[160:163], v[64:67], v[80:95]
  v_exp_f32 v44, v44
  v_exp_f32 v45, v45
  v_cvt_pk_bf16_f32 v69, v42, v43
  v_exp_f32 v46, v46
  v_exp_f32 v47, v47
  v_cvt_pk_bf16_f32 v70, v44, v45
  v_exp_f32 v48, v48
  v_cvt_pk_bf16_f32 v71, v46, v47
  v_exp_f32 v49, v49
  v_mfma_f32_32x32x16_bf16 v[32:47], a[56:59], v[16:19], 0
  v_exp_f32 v50, v50
  v_exp_f32 v51, v51
  v_cvt_pk_bf16_f32 v72, v48, v49
  v_exp_f32 v52, v52
  v_exp_f32 v53, v53
  v_cvt_pk_bf16_f32 v73, v50, v51
  v_exp_f32 v54, v54
  v_mfma_f32_32x32x16_bf16 v[80:95], a[164:167], v[68:71], v[80:95]
  v_exp_f32 v55, v55
  v_cvt_pk_bf16_f32 v74, v52, v53
  v_exp_f32 v56, v56
  v_exp_f32 v57, v57
  v_cvt_pk_bf16_f32 v75, v54, v55
  v_exp_f32 v58, v58
  v_exp_f32 v59, v59
  v_cvt_pk_bf16_f32 v76, v56, v57
  v_mfma_f32_32x32x16_bf16 v[80:95], a[168:171], v[72:75], v[80:95]
  v_exp_f32 v60, v60
  v_exp_f32 v61, v61
  v_cvt_pk_bf16_f32 v77, v58, v59
  v_exp_f32 v62, v62
  v_exp_f32 v63, v63
  v_cvt_pk_bf16_f32 v78, v60, v61
  v_exp_f32 v32, v32
  v_cvt_pk_bf16_f32 v79, v62, v63
  v_exp_f32 v33, v33
  v_mfma_f32_32x32x16_bf16 v[48:63], a[60:63], v[16:19], 0
  v_exp_f32 v34, v34
  v_exp_f32 v35, v35
  v_cvt_pk_bf16_f32 v64, v32, v33
  v_exp_f32 v36, v36
  s_waitcnt lgkmcnt(0)
  v_exp_f32 v37, v37
  v_cvt_pk_bf16_f32 v65, v34, v35
  v_exp_f32 v38, v38
  v_mfma_f32_32x32x16_bf16 v[80:95], a[172:175], v[76:79], v[80:95]
  v_exp_f32 v39, v39
  v_cvt_pk_bf16_f32 v66, v36, v37
  v_exp_f32 v40, v40
  v_exp_f32 v41, v41
  v_cvt_pk_bf16_f32 v67, v38, v39
  v_exp_f32 v42, v42
  v_exp_f32 v43, v43
  v_cvt_pk_bf16_f32 v68, v40, v41
  v_mfma_f32_32x32x16_bf16 v[80:95], a[176:179], v[64:67], v[80:95]
  v_exp_f32 v44, v44
  v_exp_f32 v45, v45
  v_cvt_pk_bf16_f32 v69, v42, v43
  v_exp_f32 v46, v46
  v_exp_f32 v47, v47
  v_cvt_pk_bf16_f32 v70, v44, v45
  v_exp_f32 v48, v48
  v_cvt_pk_bf16_f32 v71, v46, v47
  v_exp_f32 v49, v49
  v_mfma_f32_32x32x16_bf16 v[32:47], a[0:3], v[20:23], 0
  v_exp_f32 v50, v50
  v_exp_f32 v51, v51
  v_cvt_pk_bf16_f32 v72, v48, v49
  v_exp_f32 v52, v52
  v_exp_f32 v53, v53
  v_cvt_pk_bf16_f32 v73, v50, v51
  v_exp_f32 v54, v54
  v_mfma_f32_32x32x16_bf16 v[80:95], a[180:183], v[68:71], v[80:95]
  v_exp_f32 v55, v55
  v_cvt_pk_bf16_f32 v74, v52, v53
  v_exp_f32 v56, v56
  v_exp_f32 v57, v57
  v_cvt_pk_bf16_f32 v75, v54, v55
  v_exp_f32 v58, v58
  v_exp_f32 v59, v59
  v_cvt_pk_bf16_f32 v76, v56, v57
  v_mfma_f32_32x32x16_bf16 v[80:95], a[184:187], v[72:75], v[80:95]
  v_exp_f32 v60, v60
  v_exp_f32 v61, v61
  v_cvt_pk_bf16_f32 v77, v58, v59
  v_exp_f32 v62, v62
  s_add_u32 s56, s56, 1
  v_exp_f32 v63, v63
  v_cvt_pk_bf16_f32 v78, v60, v61
  s_cmp_lt_u32 s56, 7
  s_cbranch_scc1 ATTLOOP_45
  v_exp_f32 v32, v32
  v_cvt_pk_bf16_f32 v79, v62, v63
  v_exp_f32 v33, v33
  s_lshr_b32 s44, s2, 3
  s_lshl_b32 s44, s44, 2
  s_add_u32 s44, s44, s18
  s_lshl_b32 s44, s44, 10
  s_add_u32 s45, s44, 1024
  s_cmp_gt_u32 s45, L_CODE_END-L_PFBASE
  s_cbranch_scc1 PF2_46
  s_add_u32 s44, s44, s86
  s_addc_u32 s45, s87, 0
  global_load_dwordx4 v[128:131], v2, s[44:45]
PF2_46:
  v_mfma_f32_32x32x16_bf16 v[48:63], a[4:7], v[20:23], 0
  v_exp_f32 v34, v34
  v_exp_f32 v35, v35
  v_cvt_pk_bf16_f32 v64, v32, v33
  v_exp_f32 v36, v36
  s_add_u32 s47, s59, 0
  buffer_load_dwordx4 a[0:3], v2, s[4:7], s47 offen offset:0 sc1
  v_exp_f32 v37, v37
  v_cvt_pk_bf16_f32 v65, v34, v35
  v_exp_f32 v38, v38
  v_mfma_f32_32x32x16_bf16 v[80:95], a[188:191], v[76:79], v[80:95]
  v_exp_f32 v39, v39
  v_cvt_pk_bf16_f32 v66, v36, v37
  v_exp_f32 v40, v40
  s_mov_b32 m0, s62
  s_add_u32 s62, s62, 4096
  buffer_load_dwordx4 v2, s[4:7], s63 offen offset:0 sc1 lds
  v_exp_f32 v41, v41
  v_cvt_pk_bf16_f32 v67, v38, v39
  v_exp_f32 v42, v42
  v_exp_f32 v43, v43
  v_cvt_pk_bf16_f32 v68, v40, v41
  v_mfma_f32_32x32x16_bf16 v[96:111], a[64:67], v[64:67], 0
  v_exp_f32 v44, v44
  v_exp_f32 v45, v45
  v_cvt_pk_bf16_f32 v69, v42, v43
  v_exp_f32 v46, v46
  v_exp_f32 v47, v47
  v_cvt_pk_bf16_f32 v70, v44, v45
  v_exp_f32 v48, v48
  v_cvt_pk_bf16_f32 v71, v46, v47
  v_exp_f32 v49, v49
  v_mfma_f32_32x32x16_bf16 v[32:47], a[8:11], v[20:23], 0
  v_exp_f32 v50, v50
  v_exp_f32 v51, v51
  v_cvt_pk_bf16_f32 v72, v48, v49
  v_exp_f32 v52, v52
  buffer_load_dwordx4 a[4:7], v2, s[4:7], s47 offen offset:1024 sc1
  v_exp_f32 v53, v53
  v_cvt_pk_bf16_f32 v73, v50, v51
  v_exp_f32 v54, v54
  v_mfma_f32_32x32x16_bf16 v[96:111], a[68:71], v[68:71], v[96:111]
  v_exp_f32 v55, v55
  v_cvt_pk_bf16_f32 v74, v52, v53
  v_exp_f32 v56, v56
  buffer_load_dwordx4 v2, s[4:7], s63 offen offset:1024 sc1 lds
  v_exp_f32 v57, v57
  v_cvt_pk_bf16_f32 v75, v54, v55
  v_exp_f32 v58, v58
  v_exp_f32 v59, v59
  v_cvt_pk_bf16_f32 v76, v56, v57
  v_mfma_f32_32x32x16_bf16 v[96:111], a[72:75], v[72:75], v[96:111]
  v_exp_f32 v60, v60
  v_exp_f32 v61, v61
  v_cvt_pk_bf16_f32 v77, v58, v59
  v_exp_f32 v62, v62
  v_exp_f32 v63, v63
  v_cvt_pk_bf16_f32 v78, v60, v61
  v_exp_f32 v32, v32
  v_cvt_pk_bf16_f32 v79, v62, v63
  v_exp_f32 v33, v33
  v_mfma_f32_32x32x16_bf16 v[48:63], a[12:15], v[20:23], 0
  v_exp_f32 v34, v34
  v_exp_f32 v35, v35
  v_cvt_pk_bf16_f32 v64, v32, v33
  v_exp_f32 v36, v36
  buffer_load_dwordx4 a[8:11], v2, s[4:7], s47 offen offset:2048 sc1
  v_exp_f32 v37, v37
  v_cvt_pk_bf16_f32 v65, v34, v35
  v_exp_f32 v38, v38
  v_mfma_f32_32x32x16_bf16 v[96:111], a[76:79], v[76:79], v[96:111]
  v_exp_f32 v39, v39
  v_cvt_pk_bf16_f32 v66, v36, v37
  v_exp_f32 v40, v40
  buffer_load_dwordx4 v2, s[4:7], s63 offen offset:2048 sc1 lds
  v_exp_f32 v41, v41
  v_cvt_pk_bf16_f32 v67, v38, v39
  v_exp_f32 v42, v42
  s_add_u32 s46, s59, 16384
  buffer_load_dwordx4 a[64:67], v2, s[4:7], s46 offen offset:0 sc1
  v_exp_f32 v43, v43
  v_cvt_pk_bf16_f32 v68, v40, v41
  v_mfma_f32_32x32x16_bf16 v[96:111], a[80:83], v[64:67], v[96:111]
  v_exp_f32 v44, v44
  v_exp_f32 v45, v45
  v_cvt_pk_bf16_f32 v69, v42, v43
  v_exp_f32 v46, v46
  v_exp_f32 v47, v47
  v_cvt_pk_bf16_f32 v70, v44, v45
  v_exp_f32 v48, v48
  v_cvt_pk_bf16_f32 v71, v46, v47
  v_exp_f32 v49, v49
  v_mfma_f32_32x32x16_bf16 v[32:47], a[16:19], v[20:23], 0
  v_exp_f32 v50, v50
  v_exp_f32 v51, v51
  v_cvt_pk_bf16_f32 v72, v48, v49
  v_exp_f32 v52, v52
  buffer_load_dwordx4 a[12:15], v2, s[4:7], s47 offen offset:3072 sc1
  v_exp_f32 v53, v53
  v_cvt_pk_bf16_f32 v73, v50, v51
  v_exp_f32 v54, v54
  v_mfma_f32_32x32x16_bf16 v[96:111], a[84:87], v[68:71], v[96:111]
  v_exp_f32 v55, v55
  v_cvt_pk_bf16_f32 v74, v52, v53
  v_exp_f32 v56, v56
  buffer_load_dwordx4 v2, s[4:7], s63 offen offset:3072 sc1 lds
  s_add_u32 s63, s63, 4096
  v_exp_f32 v57, v57
  v_cvt_pk_bf16_f32 v75, v54, v55
  v_exp_f32 v58, v58
  buffer_load_dwordx4 a[68:71], v2, s[4:7], s46 offen offset:1024 sc1
  v_exp_f32 v59, v59
  v_cvt_pk_bf16_f32 v76, v56, v57
  v_mfma_f32_32x32x16_bf16 v[96:111], a[88:91], v[72:75], v[96:111]
  v_exp_f32 v60, v60
  v_exp_f32 v61, v61
  v_cvt_pk_bf16_f32 v77, v58, v59
  v_exp_f32 v62, v62
  v_exp_f32 v63, v63
  v_cvt_pk_bf16_f32 v78, v60, v61
  v_exp_f32 v32, v32
  v_cvt_pk_bf16_f32 v79, v62, v63
  v_exp_f32 v33, v33
  v_mfma_f32_32x32x16_bf16 v[48:63], a[20:23], v[20:23], 0
  v_exp_f32 v34, v34
  v_exp_f32 v35, v35
  v_cvt_pk_bf16_f32 v64, v32, v33
  v_exp_f32 v36, v36
  s_add_u32 s47, s59, 4096
  buffer_load_dwordx4 a[16:19], v2, s[4:7], s47 offen offset:0 sc1
  v_exp_f32 v37, v37
  v_cvt_pk_bf16_f32 v65, v34, v35
  v_exp_f32 v38, v38
  v_mfma_f32_32x32x16_bf16 v[96:111], a[92:95], v[76:79], v[96:111]
  v_exp_f32 v39, v39
  v_cvt_pk_bf16_f32 v66, v36, v37
  v_exp_f32 v40, v40
  v_exp_f32 v41, v41
  v_cvt_pk_bf16_f32 v67, v38, v39
  v_exp_f32 v42, v42
  buffer_load_dwordx4 a[72:75], v2, s[4:7], s46 offen offset:2048 sc1
  v_exp_f32 v43, v43
  v_cvt_pk_bf16_f32 v68, v40, v41
  v_mfma_f32_32x32x16_bf16 v[96:111], a[96:99], v[64:67], v[96:111]
  v_exp_f32 v44, v44
  v_exp_f32 v45, v45
  v_cvt_pk_bf16_f32 v69, v42, v43
  v_exp_f32 v46, v46
  v_exp_f32 v47, v47
  v_cvt_pk_bf16_f32 v70, v44, v45
  v_exp_f32 v48, v48
  v_cvt_pk_bf16_f32 v71, v46, v47
  v_exp_f32 v49, v49
  v_mfma_f32_32x32x16_bf16 v[32:47], a[24:27], v[20:23], 0
  v_exp_f32 v50, v50
  v_exp_f32 v51, v51
  v_cvt_pk_bf16_f32 v72, v48, v49
  v_exp_f32 v52, v52
  buffer_load_dwordx4 a[20:23], v2, s[4:7], s47 offen offset:1024 sc1
  v_exp_f32 v53, v53
  v_cvt_pk_bf16_f32 v73, v50, v51
  v_exp_f32 v54, v54
  v_mfma_f32_32x32x16_bf16 v[96:111], a[100:103], v[68:71], v[96:111]
  v_exp_f32 v55, v55
  v_cvt_pk_bf16_f32 v74, v52, v53
  v_exp_f32 v56, v56
  v_exp_f32 v57, v57
  v_cvt_pk_bf16_f32 v75, v54, v55
  v_exp_f32 v58, v58
  buffer_load_dwordx4 a[76:79], v2, s[4:7], s46 offen offset:3072 sc1
  v_exp_f32 v59, v59
  v_cvt_pk_bf16_f32 v76, v56, v57
  v_mfma_f32_32x32x16_bf16 v[96:111], a[104:107], v[72:75], v[96:111]
  v_exp_f32 v60, v60
  v_exp_f32 v61, v61
  v_cvt_pk_bf16_f32 v77, v58, v59
  v_exp_f32 v62, v62
  v_exp_f32 v63, v63
  v_cvt_pk_bf16_f32 v78, v60, v61
  v_exp_f32 v32, v32
  v_cvt_pk_bf16_f32 v79, v62, v63
  v_exp_f32 v33, v33
  v_mfma_f32_32x32x16_bf16 v[48:63], a[28:31], v[20:23], 0
  v_exp_f32 v34, v34
  v_exp_f32 v35, v35
  v_cvt_pk_bf16_f32 v64, v32, v33
  v_exp_f32 v36, v36
  buffer_load_dwordx4 a[24:27], v2, s[4:7], s47 offen offset:2048 sc1
  v_exp_f32 v37, v37
  v_cvt_pk_bf16_f32 v65, v34, v35
  v_exp_f32 v38, v38
  v_mfma_f32_32x32x16_bf16 v[96:111], a[108:111], v[76:79], v[96:111]
  v_exp_f32 v39, v39
  v_cvt_pk_bf16_f32 v66, v36, v37
  v_exp_f32 v40, v40
  v_exp_f32 v41, v41
  v_cvt_pk_bf16_f32 v67, v38, v39
  v_exp_f32 v42, v42
  s_add_u32 s46, s59, 20480
  buffer_load_dwordx4 a[80:83], v2, s[4:7], s46 offen offset:0 sc1
  v_exp_f32 v43, v43
  v_cvt_pk_bf16_f32 v68, v40, v41
  v_mfma_f32_32x32x16_bf16 v[96:111], a[112:115], v[64:67], v[96:111]
  v_exp_f32 v44, v44
  v_exp_f32 v45, v45
  v_cvt_pk_bf16_f32 v69, v42, v43
  v_exp_f32 v46, v46
  v_exp_f32 v47, v47
  v_cvt_pk_bf16_f32 v70, v44, v45
  v_exp_f32 v48, v48
  v_cvt_pk_bf16_f32 v71, v46, v47
  v_exp_f32 v49, v49
  v_mfma_f32_32x32x16_bf16 v[32:47], a[32:35], v[20:23], 0
  v_exp_f32 v50, v50
  v_exp_f32 v51, v51
  v_cvt_pk_bf16_f32 v72, v48, v49
  v_exp_f32 v52, v52
  buffer_load_dwordx4 a[28:31], v2, s[4:7], s47 offen offset:3072 sc1
  v_exp_f32 v53, v53
  v_cvt_pk_bf16_f32 v73, v50, v51
  v_exp_f32 v54, v54
  v_mfma_f32_32x32x16_bf16 v[96:111], a[116:119], v[68:71], v[96:111]
  v_exp_f32 v55, v55
  v_cvt_pk_bf16_f32 v74, v52, v53
  v_exp_f32 v56, v56
  v_exp_f32 v57, v57
  v_cvt_pk_bf16_f32 v75, v54, v55
  v_exp_f32 v58, v58
  buffer_load_dwordx4 a[84:87], v2, s[4:7], s46 offen offset:1024 sc1
  v_exp_f32 v59, v59
  v_cvt_pk_bf16_f32 v76, v56, v57
  v_mfma_f32_32x32x16_bf16 v[96:111], a[120:123], v[72:75], v[96:111]
  v_exp_f32 v60, v60
  v_exp_f32 v61, v61
  v_cvt_pk_bf16_f32 v77, v58, v59
  v_exp_f32 v62, v62
  v_exp_f32 v63, v63
  v_cvt_pk_bf16_f32 v78, v60, v61
  v_exp_f32 v32, v32
  v_cvt_pk_bf16_f32 v79, v62, v63
  v_exp_f32 v33, v33
  v_mfma_f32_32x32x16_bf16 v[48:63], a[36:39], v[20:23], 0
  v_exp_f32 v34, v34
  v_exp_f32 v35, v35
  v_cvt_pk_bf16_f32 v64, v32, v33
  v_exp_f32 v36, v36
  s_add_u32 s47, s59, 8192
  buffer_load_dwordx4 a[32:35], v2, s[4:7], s47 offen offset:0 sc1
  v_exp_f32 v37, v37
  v_cvt_pk_bf16_f32 v65, v34, v35
  v_exp_f32 v38, v38
  v_mfma_f32_32x32x16_bf16 v[96:111], a[124:127], v[76:79], v[96:111]
  v_exp_f32 v39, v39
  v_cvt_pk_bf16_f32 v66, v36, v37
  v_exp_f32 v40, v40
  v_exp_f32 v41, v41
  v_cvt_pk_bf16_f32 v67, v38, v39
  v_exp_f32 v42, v42
  buffer_load_dwordx4 a[88:91], v2, s[4:7], s46 offen offset:2048 sc1
  v_exp_f32 v43, v43
  v_cvt_pk_bf16_f32 v68, v40, v41
  v_mfma_f32_32x32x16_bf16 v[96:111], a[128:131], v[64:67], v[96:111]
  v_exp_f32 v44, v44
  v_exp_f32 v45, v45
  v_cvt_pk_bf16_f32 v69, v42, v43
  v_exp_f32 v46, v46
  v_exp_f32 v47, v47
  v_cvt_pk_bf16_f32 v70, v44, v45
  v_exp_f32 v48, v48
  v_cvt_pk_bf16_f32 v71, v46, v47
  v_exp_f32 v49, v49
  v_mfma_f32_32x32x16_bf16 v[32:47], a[40:43], v[20:23], 0
  v_exp_f32 v50, v50
  v_exp_f32 v51, v51
  v_cvt_pk_bf16_f32 v72, v48, v49
  v_exp_f32 v52, v52
  buffer_load_dwordx4 a[36:39], v2, s[4:7], s47 offen offset:1024 sc1
  v_exp_f32 v53, v53
  v_cvt_pk_bf16_f32 v73, v50, v51
  v_exp_f32 v54, v54
  v_mfma_f32_32x32x16_bf16 v[96:111], a[132:135], v[68:71], v[96:111]
  v_exp_f32 v55, v55
  v_cvt_pk_bf16_f32 v74, v52, v53
  v_exp_f32 v56, v56
  v_exp_f32 v57, v57
  v_cvt_pk_bf16_f32 v75, v54, v55
  v_exp_f32 v58, v58
  buffer_load_dwordx4 a[92:95], v2, s[4:7], s46 offen offset:3072 sc1
  v_exp_f32 v59, v59
  v_cvt_pk_bf16_f32 v76, v56, v57
  v_mfma_f32_32x32x16_bf16 v[96:111], a[136:139], v[72:75], v[96:111]
  v_exp_f32 v60, v60
  v_exp_f32 v61, v61
  v_cvt_pk_bf16_f32 v77, v58, v59
  v_exp_f32 v62, v62
  v_exp_f32 v63, v63
  v_cvt_pk_bf16_f32 v78, v60, v61
  v_exp_f32 v32, v32
  v_cvt_pk_bf16_f32 v79, v62, v63
  v_exp_f32 v33, v33
  v_mfma_f32_32x32x16_bf16 v[48:63], a[44:47], v[20:23], 0
  v_exp_f32 v34, v34
  v_exp_f32 v35, v35
  v_cvt_pk_bf16_f32 v64, v32, v33
  v_exp_f32 v36, v36
  buffer_load_dwordx4 a[40:43], v2, s[4:7], s47 offen offset:2048 sc1
  v_exp_f32 v37, v37
  v_cvt_pk_bf16_f32 v65, v34, v35
  v_exp_f32 v38, v38
  v_mfma_f32_32x32x16_bf16 v[96:111], a[140:143], v[76:79], v[96:111]
  v_exp_f32 v39, v39
  v_cvt_pk_bf16_f32 v66, v36, v37
  v_exp_f32 v40, v40
  v_exp_f32 v41, v41
  v_cvt_pk_bf16_f32 v67, v38, v39
  v_exp_f32 v42, v42
  s_add_u32 s46, s59, 24576
  buffer_load_dwordx4 a[96:99], v2, s[4:7], s46 offen offset:0 sc1
  v_exp_f32 v43, v43
  v_cvt_pk_bf16_f32 v68, v40, v41
  v_mfma_f32_32x32x16_bf16 v[96:111], a[144:147], v[64:67], v[96:111]
  v_exp_f32 v44, v44
  v_exp_f32 v45, v45
  v_cvt_pk_bf16_f32 v69, v42, v43
  v_exp_f32 v46, v46
  v_exp_f32 v47, v47
  v_cvt_pk_bf16_f32 v70, v44, v45
  v_exp_f32 v48, v48
  v_cvt_pk_bf16_f32 v71, v46, v47
  v_exp_f32 v49, v49
  v_mfma_f32_32x32x16_bf16 v[32:47], a[48:51], v[20:23], 0
  v_exp_f32 v50, v50
  v_exp_f32 v51, v51
  v_cvt_pk_bf16_f32 v72, v48, v49
  v_exp_f32 v52, v52
  buffer_load_dwordx4 a[44:47], v2, s[4:7], s47 offen offset:3072 sc1
  v_exp_f32 v53, v53
  v_cvt_pk_bf16_f32 v73, v50, v51
  v_exp_f32 v54, v54
  v_mfma_f32_32x32x16_bf16 v[96:111], a[148:151], v[68:71], v[96:111]
  v_exp_f32 v55, v55
  v_cvt_pk_bf16_f32 v74, v52, v53
  v_exp_f32 v56, v56
  v_exp_f32 v57, v57
  v_cvt_pk_bf16_f32 v75, v54, v55
  v_exp_f32 v58, v58
  buffer_load_dwordx4 a[100:103], v2, s[4:7], s46 offen offset:1024 sc1
  v_exp_f32 v59, v59
  v_cvt_pk_bf16_f32 v76, v56, v57
  v_mfma_f32_32x32x16_bf16 v[96:111], a[152:155], v[72:75], v[96:111]
  v_exp_f32 v60, v60
  v_exp_f32 v61, v61
  v_cvt_pk_bf16_f32 v77, v58, v59
  v_exp_f32 v62, v62
  v_exp_f32 v63, v63
  v_cvt_pk_bf16_f32 v78, v60, v61
  v_exp_f32 v32, v32
  v_cvt_pk_bf16_f32 v79, v62, v63
  v_exp_f32 v33, v33
  v_mfma_f32_32x32x16_bf16 v[48:63], a[52:55], v[20:23], 0
  v_exp_f32 v34, v34
  v_exp_f32 v35, v35
  v_cvt_pk_bf16_f32 v64, v32, v33
  v_exp_f32 v36, v36
  s_add_u32 s47, s59, 12288
  buffer_load_dwordx4 a[48:51], v2, s[4:7], s47 offen offset:0 sc1
  v_exp_f32 v37, v37
  v_cvt_pk_bf16_f32 v65, v34, v35
  v_exp_f32 v38, v38
  v_mfma_f32_32x32x16_bf16 v[96:111], a[156:159], v[76:79], v[96:111]
  v_exp_f32 v39, v39
  v_cvt_pk_bf16_f32 v66, v36, v37
  v_exp_f32 v40, v40
  v_exp_f32 v41, v41
  v_cvt_pk_bf16_f32 v67, v38, v39
  v_exp_f32 v42, v42
  buffer_load_dwordx4 a[104:107], v2, s[4:7], s46 offen offset:2048 sc1
  v_exp_f32 v43, v43
  v_cvt_pk_bf16_f32 v68, v40, v41
  v_mfma_f32_32x32x16_bf16 v[96:111], a[160:163], v[64:67], v[96:111]
  v_exp_f32 v44, v44
  v_exp_f32 v45, v45
  v_cvt_pk_bf16_f32 v69, v42, v43
  v_exp_f32 v46, v46
  v_exp_f32 v47, v47
  v_cvt_pk_bf16_f32 v70, v44, v45
  v_exp_f32 v48, v48
  v_cvt_pk_bf16_f32 v71, v46, v47
  v_exp_f32 v49, v49
  v_mfma_f32_32x32x16_bf16 v[32:47], a[56:59], v[20:23], 0
  v_exp_f32 v50, v50
  v_exp_f32 v51, v51
  v_cvt_pk_bf16_f32 v72, v48, v49
  v_exp_f32 v52, v52
  buffer_load_dwordx4 a[52:55], v2, s[4:7], s47 offen offset:1024 sc1
  v_exp_f32 v53, v53
  v_cvt_pk_bf16_f32 v73, v50, v51
  v_exp_f32 v54, v54
  v_mfma_f32_32x32x16_bf16 v[96:111], a[164:167], v[68:71], v[96:111]
  v_exp_f32 v55, v55
  v_cvt_pk_bf16_f32 v74, v52, v53
  v_exp_f32 v56, v56
  v_exp_f32 v57, v57
  v_cvt_pk_bf16_f32 v75, v54, v55
  v_exp_f32 v58, v58
  buffer_load_dwordx4 a[108:111], v2, s[4:7], s46 offen offset:3072 sc1
  v_exp_f32 v59, v59
  v_cvt_pk_bf16_f32 v76, v56, v57
  v_mfma_f32_32x32x16_bf16 v[96:111], a[168:171], v[72:75], v[96:111]
  v_exp_f32 v60, v60
  v_exp_f32 v61, v61
  v_cvt_pk_bf16_f32 v77, v58, v59
  v_exp_f32 v62, v62
  v_exp_f32 v63, v63
  v_cvt_pk_bf16_f32 v78, v60, v61
  v_exp_f32 v32, v32
  v_cvt_pk_bf16_f32 v79, v62, v63
  v_exp_f32 v33, v33
  v_mfma_f32_32x32x16_bf16 v[48:63], a[60:63], v[20:23], 0
  v_exp_f32 v34, v34
  v_exp_f32 v35, v35
  v_cvt_pk_bf16_f32 v64, v32, v33
  v_exp_f32 v36, v36
  buffer_load_dwordx4 a[56:59], v2, s[4:7], s47 offen offset:2048 sc1
  v_exp_f32 v37, v37
  v_cvt_pk_bf16_f32 v65, v34, v35
  v_exp_f32 v38, v38
  v_mfma_f32_32x32x16_bf16 v[96:111], a[172:175], v[76:79], v[96:111]
  v_exp_f32 v39, v39
  v_cvt_pk_bf16_f32 v66, v36, v37
  v_exp_f32 v40, v40
  v_exp_f32 v41, v41
  v_cvt_pk_bf16_f32 v67, v38, v39
  v_exp_f32 v42, v42
  s_add_u32 s46, s59, 28672
  buffer_load_dwordx4 a[112:115], v2, s[4:7], s46 offen offset:0 sc1
  v_exp_f32 v43, v43
  v_cvt_pk_bf16_f32 v68, v40, v41
  v_mfma_f32_32x32x16_bf16 v[96:111], a[176:179], v[64:67], v[96:111]
  v_exp_f32 v44, v44
  v_exp_f32 v45, v45
  v_cvt_pk_bf16_f32 v69, v42, v43
  buffer_load_dwordx4 a[120:123], v2, s[4:7], s46 offen offset:2048 sc1
  v_exp_f32 v46, v46
  v_exp_f32 v47, v47
  v_cvt_pk_bf16_f32 v70, v44, v45
  v_exp_f32 v48, v48
  v_cvt_pk_bf16_f32 v71, v46, v47
  v_exp_f32 v49, v49
  v_exp_f32 v50, v50
  v_exp_f32 v51, v51
  v_cvt_pk_bf16_f32 v72, v48, v49
  v_exp_f32 v52, v52
  buffer_load_dwordx4 a[60:63], v2, s[4:7], s47 offen offset:3072 sc1
  v_exp_f32 v53, v53
  v_cvt_pk_bf16_f32 v73, v50, v51
  v_exp_f32 v54, v54
  v_mfma_f32_32x32x16_bf16 v[96:111], a[180:183], v[68:71], v[96:111]
  v_exp_f32 v55, v55
  v_cvt_pk_bf16_f32 v74, v52, v53
  v_exp_f32 v56, v56
  v_exp_f32 v57, v57
  v_cvt_pk_bf16_f32 v75, v54, v55
  v_exp_f32 v58, v58
  buffer_load_dwordx4 a[116:119], v2, s[4:7], s46 offen offset:1024 sc1
  v_exp_f32 v59, v59
  v_cvt_pk_bf16_f32 v76, v56, v57
  v_mfma_f32_32x32x16_bf16 v[96:111], a[184:187], v[72:75], v[96:111]
  v_exp_f32 v60, v60
  v_exp_f32 v61, v61
  v_cvt_pk_bf16_f32 v77, v58, v59
  buffer_load_dwordx4 a[124:127], v2, s[4:7], s46 offen offset:3072 sc1
  v_exp_f32 v62, v62
  v_exp_f32 v63, v63
  v_cvt_pk_bf16_f32 v78, v60, v61
  v_cvt_pk_bf16_f32 v79, v62, v63
  s_nop 1
  v_mfma_f32_32x32x16_bf16 v[96:111], a[188:191], v[76:79], v[96:111]
L_ATT_TAIL:
  s_sub_u32 s40, s18, 1
  s_and_b32 s40, s40, 3
  s_mul_i32 s40, s40, 13824
  s_add_u32 s40, s40, 8192
  v_add_u32 v24, s40, v2
  s_add_u32 s40, s40, 2048
  v_add_u32 v28, s40, v3
  s_sub_u32 s40, s18, 2
  s_and_b32 s40, s40, 3
  s_mul_i32 s40, s40, 13824
  s_add_u32 s40, s40, 12800
  v_add_u32 v25, s40, v2
  s_add_u32 s40, s40, 2048
  v_add_u32 v29, s40, v3
  s_sub_u32 s40, s18, 3
  s_and_b32 s40, s40, 3
  s_mul_i32 s40, s40, 13824
  s_add_u32 s40, s40, 17408
  v_add_u32 v26, s40, v2
  s_add_u32 s40, s40, 2048
  v_add_u32 v30, s40, v3
  s_waitcnt vmcnt(27) lgkmcnt(0)
  s_barrier
  ds_read_b128 v[32:35], v24 offset:0
  ds_read_b128 v[36:39], v24 offset:1024
  ds_read_b32 v40, v28 offset:0
  ds_read_b128 v[44:47], v25 offset:0
  ds_read_b128 v[48:51], v25 offset:1024
  ds_read_b32 v52, v29 offset:0
  ds_read_b128 v[56:59], v26 offset:0
  ds_read_b128 v[60:63], v26 offset:1024
  ds_read_b32 v64, v30 offset:0
  ds_read_b128 v[68:71], v24 offset:2304
  ds_read_b128 v[72:75], v24 offset:3328
  ds_read_b32 v76, v28 offset:2304
  ds_read_b128 v[112:115], v25 offset:2304
  ds_read_b128 v[116:119], v25 offset:3328
  ds_read_b32 v120, v29 offset:2304
  ds_read_b128 v[16:19], v26 offset:2304
  ds_read_b128 v[20:23], v26 offset:3328
  ds_read_b32 v31, v30 offset:2304
  s_lshl_b32 s40, s17, 2
  s_add_u32 s40, s40, s18
  s_lshl_b32 s40, s40, 10
  s_lshl_b32 s41, s16, 16
  s_add_u32 s40, s40, s41
  s_add_u32 s40, s40, s34
  s_add_u32 s41, s40, 32768
  s_waitcnt lgkmcnt(9)
  v_add_f32 v88, v88, v40
  v_pk_add_f32 v[80:81], v[80:81], v[32:33]
  v_pk_add_f32 v[82:83], v[82:83], v[34:35]
  v_pk_add_f32 v[84:85], v[84:85], v[36:37]
  v_pk_add_f32 v[86:87], v[86:87], v[38:39]
  v_add_f32 v88, v88, v52
  v_pk_add_f32 v[80:81], v[80:81], v[44:45]
  v_pk_add_f32 v[82:83], v[82:83], v[46:47]
  v_pk_add_f32 v[84:85], v[84:85], v[48:49]
  v_pk_add_f32 v[86:87], v[86:87], v[50:51]
  v_add_f32 v88, v88, v64
  v_pk_add_f32 v[80:81], v[80:81], v[56:57]
  v_pk_add_f32 v[82:83], v[82:83], v[58:59]
  v_pk_add_f32 v[84:85], v[84:85], v[60:61]
  v_pk_add_f32 v[86:87], v[86:87], v[62:63]
  v_rcp_f32 v90, v88
  s_nop 0
  v_pk_mul_f32 v[80:81], v[80:81], v[90:91] op_sel_hi:[1,0]
  v_pk_mul_f32 v[82:83], v[82:83], v[90:91] op_sel_hi:[1,0]
  v_pk_mul_f32 v[84:85], v[84:85], v[90:91] op_sel_hi:[1,0]
  v_pk_mul_f32 v[86:87], v[86:87], v[90:91] op_sel_hi:[1,0]
  v_cvt_pk_bf16_f32 v92, v80, v81
  v_cvt_pk_bf16_f32 v93, v82, v83
  v_cvt_pk_bf16_f32 v94, v84, v85
  v_cvt_pk_bf16_f32 v95, v86, v87
  s_cmp_eq_u32 s39, 1
  s_cbranch_scc1 FAST_47
  buffer_store_dwordx4 v[92:95], v2, s[4:7], s40 offen offset:0 sc1
  s_branch MDONE_48
FAST_47:
  buffer_store_dwordx4 v[92:95], v2, s[4:7], s40 offen offset:0
MDONE_48:
  s_waitcnt lgkmcnt(0)
  v_add_f32 v104, v104, v76
  v_pk_add_f32 v[96:97], v[96:97], v[68:69]
  v_pk_add_f32 v[98:99], v[98:99], v[70:71]
  v_pk_add_f32 v[100:101], v[100:101], v[72:73]
  v_pk_add_f32 v[102:103], v[102:103], v[74:75]
  v_add_f32 v104, v104, v120
  v_pk_add_f32 v[96:97], v[96:97], v[112:113]
  v_pk_add_f32 v[98:99], v[98:99], v[114:115]
  v_pk_add_f32 v[100:101], v[100:101], v[116:117]
  v_pk_add_f32 v[102:103], v[102:103], v[118:119]
  v_add_f32 v104, v104, v31
  v_pk_add_f32 v[96:97], v[96:97], v[16:17]
  v_pk_add_f32 v[98:99], v[98:99], v[18:19]
  v_pk_add_f32 v[100:101], v[100:101], v[20:21]
  v_pk_add_f32 v[102:103], v[102:103], v[22:23]
  v_rcp_f32 v106, v104
  s_nop 0
  v_pk_mul_f32 v[96:97], v[96:97], v[106:107] op_sel_hi:[1,0]
  v_pk_mul_f32 v[98:99], v[98:99], v[106:107] op_sel_hi:[1,0]
  v_pk_mul_f32 v[100:101], v[100:101], v[106:107] op_sel_hi:[1,0]
  v_pk_mul_f32 v[102:103], v[102:103], v[106:107] op_sel_hi:[1,0]
  v_cvt_pk_bf16_f32 v108, v96, v97
  v_cvt_pk_bf16_f32 v109, v98, v99
  v_cvt_pk_bf16_f32 v110, v100, v101
  v_cvt_pk_bf16_f32 v111, v102, v103
  s_cmp_eq_u32 s39, 1
  s_cbranch_scc1 FAST_49
  buffer_store_dwordx4 v[108:111], v2, s[4:7], s41 offen offset:0 sc1
  s_branch MDONE_50
FAST_49:
  buffer_store_dwordx4 v[108:111], v2, s[4:7], s41 offen offset:0
MDONE_50:
  v_cmp_nle_f32 vcc, 0x1f800000, v88
  s_nop 1
  s_mov_b64 s[48:49], vcc
  v_cmp_nge_f32 vcc, 0x5f800000, v88
  s_nop 1
  s_or_b64 s[48:49], s[48:49], vcc
  v_cmp_nle_f32 vcc, 0x1f800000, v104
  s_nop 1
  s_or_b64 s[48:49], s[48:49], vcc
  v_cmp_nge_f32 vcc, 0x5f800000, v104
  s_nop 1
  s_or_b64 s[48:49], s[48:49], vcc
  s_cmp_eq_u64 s[48:49], 0
  s_cbranch_scc1 LSUMOK_51
  v_mov_b32 v24, 1
  v_mov_b32 v25, 0
  ds_write_b32 v25, v24 offset:63488
LSUMOK_51:
  s_lshl_b32 s61, s16, 7
  s_add_u32 s61, s61, s38
  s_add_u32 s61, s61, 0
  s_waitcnt vmcnt(0)
  s_waitcnt lgkmcnt(0)
  s_barrier
  v_mov_b32 v16, 0
  ds_read_b32 v17, v16 offset:63488
  s_waitcnt lgkmcnt(0)
  v_readfirstlane_b32 s40, v17
  s_nop 1
  s_cmp_eq_u32 s40, 0
  s_cbranch_scc1 NOFB_52
  s_cmp_eq_u32 s101, 0
  s_cbranch_scc1 L_FALLBACK
NOFB_52:
  s_cmp_lg_u32 s18, 0
  s_cbranch_scc1 SYNCA_53
  s_mov_b64 exec, 1
  s_cmp_eq_u32 s39, 1
  s_cbranch_scc1 FAST_55
  buffer_store_dword v245, v244, s[4:7], s61 offen sc1
  s_branch MDONE_56
FAST_55:
  buffer_store_dword v245, v244, s[4:7], s61 offen
MDONE_56:
  s_mov_b64 exec, -1
  buffer_load_dword v247, v246, s[4:7], s61 offen sc1
SYNCA_53:
  s_lshl_b32 s94, s57, 7
  s_add_u32 s94, s94, 4718592
  s_lshl_b32 s95, s58, 7
  s_add_u32 s95, s95, 4718592
  v_and_b32 v18, 31, v1
  v_lshrrev_b32 v19, 5, v1
  v_lshlrev_b32 v19, 2, v19
  v_sub_u32 v18, v18, v19
  v_mov_b32 v19, 0xff800000
  v_subrev_u32 v20, 0, v18
  v_cmp_ge_u32 vcc, 7, v20
  s_nop 1
  v_cndmask_b32 v212, v19, 0, vcc
  v_subrev_u32 v20, 1, v18
  v_cmp_ge_u32 vcc, 7, v20
  s_nop 1
  v_cndmask_b32 v213, v19, 0, vcc
  v_subrev_u32 v20, 2, v18
  v_cmp_ge_u32 vcc, 7, v20
  s_nop 1
  v_cndmask_b32 v214, v19, 0, vcc
  v_subrev_u32 v20, 3, v18
  v_cmp_ge_u32 vcc, 7, v20
  s_nop 1
  v_cndmask_b32 v215, v19, 0, vcc
  v_subrev_u32 v20, 8, v18
  v_cmp_ge_u32 vcc, 7, v20
  s_nop 1
  v_cndmask_b32 v216, v19, 0, vcc
  v_subrev_u32 v20, 9, v18
  v_cmp_ge_u32 vcc, 7, v20
  s_nop 1
  v_cndmask_b32 v217, v19, 0, vcc
  v_subrev_u32 v20, 10, v18
  v_cmp_ge_u32 vcc, 7, v20
  s_nop 1
  v_cndmask_b32 v218, v19, 0, vcc
  v_subrev_u32 v20, 11, v18
  v_cmp_ge_u32 vcc, 7, v20
  s_nop 1
  v_cndmask_b32 v219, v19, 0, vcc
  v_subrev_u32 v20, 16, v18
  v_cmp_ge_u32 vcc, 7, v20
  s_nop 1
  v_cndmask_b32 v220, v19, 0, vcc
  v_subrev_u32 v20, 17, v18
  v_cmp_ge_u32 vcc, 7, v20
  s_nop 1
  v_cndmask_b32 v221, v19, 0, vcc
  v_subrev_u32 v20, 18, v18
  v_cmp_ge_u32 vcc, 7, v20
  s_nop 1
  v_cndmask_b32 v222, v19, 0, vcc
  v_subrev_u32 v20, 19, v18
  v_cmp_ge_u32 vcc, 7, v20
  s_nop 1
  v_cndmask_b32 v223, v19, 0, vcc
  v_subrev_u32 v20, 24, v18
  v_cmp_ge_u32 vcc, 7, v20
  s_nop 1
  v_cndmask_b32 v224, v19, 0, vcc
  v_subrev_u32 v20, 25, v18
  v_cmp_ge_u32 vcc, 7, v20
  s_nop 1
  v_cndmask_b32 v225, v19, 0, vcc
  v_subrev_u32 v20, 26, v18
  v_cmp_ge_u32 vcc, 7, v20
  s_nop 1
  v_cndmask_b32 v226, v19, 0, vcc
  v_subrev_u32 v20, 27, v18
  v_cmp_ge_u32 vcc, 7, v20
  s_nop 1
  v_cndmask_b32 v227, v19, 0, vcc
  s_cmp_eq_u32 s16, 0
  s_cselect_b32 s40, -64, 0
  s_add_u32 s41, s40, -1
  v_cmp_ge_i32 vcc, s41, v18
  s_nop 1
  v_cndmask_b32 v232, v19, 0, vcc
  v_mov_b32 v240, v232
  v_mov_b32 v228, 0
  v_mov_b32 v236, 0
  s_add_u32 s41, s40, 0
  v_cmp_ge_i32 vcc, s41, v18
  s_nop 1
  v_cndmask_b32 v233, v19, 0, vcc
  v_mov_b32 v241, v233
  v_mov_b32 v229, 0
  v_mov_b32 v237, 0
  s_add_u32 s41, s40, 1
  v_cmp_ge_i32 vcc, s41, v18
  s_nop 1
  v_cndmask_b32 v234, v19, 0, vcc
  v_mov_b32 v242, v234
  v_mov_b32 v230, 0
  v_mov_b32 v238, 0
  s_add_u32 s41, s40, 2
  v_cmp_ge_i32 vcc, s41, v18
  s_nop 1
  v_cndmask_b32 v235, v19, 0, vcc
  v_mov_b32 v243, v235
  v_mov_b32 v231, 0
  v_mov_b32 v239, 0
  s_cmp_lg_u32 s18, 0
  s_cbranch_scc1 SYNC_54
  s_mov_b32 s52, 0
  s_waitcnt vmcnt(0)
  v_cmp_ne_u32 vcc, s21, v247
  s_nop 4
  s_cbranch_vccz SYNC_54
POLL_57:
  buffer_load_dword v247, v246, s[4:7], s61 offen sc1
  s_waitcnt vmcnt(0)
  v_cmp_ne_u32 vcc, s21, v247
  s_nop 4
  s_cbranch_vccz SYNC_54
  s_add_u32 s52, s52, 1
  s_cmp_lt_u32 s52, 400000
  s_cbranch_scc1 POLL_57
  s_branch L_END
SYNC_54:
  s_barrier
  s_lshl_b32 s91, s26, 15
  s_lshl_b32 s41, s20, 14
  s_add_u32 s91, s91, s41
  s_add_u32 s91, s91, s34
  buffer_load_dwordx4 v[16:19], v2, s[4:7], s91 offen offset:0 sc1
  buffer_load_dwordx4 v[20:23], v2, s[4:7], s91 offen offset:1024 sc1
  buffer_load_dwordx4 v[24:27], v2, s[4:7], s91 offen offset:2048 sc1
  buffer_load_dwordx4 v[28:31], v2, s[4:7], s91 offen offset:3072 sc1
  s_add_u32 s91, s91, 4096
  buffer_load_dwordx4 v[32:35], v2, s[4:7], s91 offen offset:0 sc1
  buffer_load_dwordx4 v[36:39], v2, s[4:7], s91 offen offset:1024 sc1
  buffer_load_dwordx4 v[40:43], v2, s[4:7], s91 offen offset:2048 sc1
  buffer_load_dwordx4 v[44:47], v2, s[4:7], s91 offen offset:3072 sc1
  s_lshl_b32 s42, s20, 14
  s_lshl_b32 s43, s20, 15
  s_add_u32 s43, s43, s42
  s_add_u32 s43, s43, 65536
  v_add_u32 v254, s43, v2
  s_xor_b32 s43, s20, 1
  s_lshl_b32 s43, s43, 15
  s_add_u32 s43, s43, s42
  s_add_u32 s43, s43, 65536
  v_add_u32 v255, s43, v2
  ds_read_b128 v[112:115], v254 offset:0
  ds_read_b128 v[116:119], v255 offset:0
  ds_read_b128 v[120:123], v254 offset:1024
  ds_read_b128 v[124:127], v255 offset:1024
  ds_read_b128 v[128:131], v254 offset:2048
  ds_read_b128 v[132:135], v255 offset:2048
  ds_read_b128 v[136:139], v254 offset:3072
  ds_read_b128 v[140:143], v255 offset:3072
  s_add_u32 s91, s91, 4096
  buffer_load_dwordx4 v[48:51], v2, s[4:7], s91 offen offset:0 sc1
  s_waitcnt vmcnt(8)
  s_waitcnt lgkmcnt(6)
  v_mfma_f32_32x32x16_bf16 v[80:95], v[112:115], v[16:19], 0
  v_mfma_f32_32x32x16_bf16 v[96:111], v[116:119], v[16:19], 0
  ds_read_b128 v[112:115], v254 offset:4096
  ds_read_b128 v[116:119], v255 offset:4096
  buffer_load_dwordx4 v[52:55], v2, s[4:7], s91 offen offset:1024 sc1
  s_waitcnt vmcnt(8)
  s_waitcnt lgkmcnt(6)
  v_mfma_f32_32x32x16_bf16 v[80:95], v[120:123], v[20:23], v[80:95]
  v_mfma_f32_32x32x16_bf16 v[96:111], v[124:127], v[20:23], v[96:111]
  ds_read_b128 v[120:123], v254 offset:5120
  ds_read_b128 v[124:127], v255 offset:5120
  buffer_load_dwordx4 v[56:59], v2, s[4:7], s91 offen offset:2048 sc1
  s_waitcnt vmcnt(8)
  s_waitcnt lgkmcnt(6)
  v_mfma_f32_32x32x16_bf16 v[80:95], v[128:131], v[24:27], v[80:95]
  v_mfma_f32_32x32x16_bf16 v[96:111], v[132:135], v[24:27], v[96:111]
  ds_read_b128 v[128:131], v254 offset:6144
  ds_read_b128 v[132:135], v255 offset:6144
  buffer_load_dwordx4 v[60:63], v2, s[4:7], s91 offen offset:3072 sc1
  s_waitcnt vmcnt(8)
  s_waitcnt lgkmcnt(6)
  v_mfma_f32_32x32x16_bf16 v[80:95], v[136:139], v[28:31], v[80:95]
  v_mfma_f32_32x32x16_bf16 v[96:111], v[140:143], v[28:31], v[96:111]
  ds_read_b128 v[136:139], v254 offset:7168
  ds_read_b128 v[140:143], v255 offset:7168
  s_add_u32 s91, s91, 4096
  buffer_load_dwordx4 v[64:67], v2, s[4:7], s91 offen offset:0 sc1
  s_waitcnt vmcnt(8)
  s_waitcnt lgkmcnt(6)
  v_mfma_f32_32x32x16_bf16 v[80:95], v[112:115], v[32:35], v[80:95]
  v_mfma_f32_32x32x16_bf16 v[96:111], v[116:119], v[32:35], v[96:111]
  ds_read_b128 v[112:115], v254 offset:8192
  ds_read_b128 v[116:119], v255 offset:8192
  buffer_load_dwordx4 v[68:71], v2, s[4:7], s91 offen offset:1024 sc1
  s_waitcnt vmcnt(8)
  s_waitcnt lgkmcnt(6)
  v_mfma_f32_32x32x16_bf16 v[80:95], v[120:123], v[36:39], v[80:95]
  v_mfma_f32_32x32x16_bf16 v[96:111], v[124:127], v[36:39], v[96:111]
  ds_read_b128 v[120:123], v254 offset:9216
  ds_read_b128 v[124:127], v255 offset:9216
  buffer_load_dwordx4 v[72:75], v2, s[4:7], s91 offen offset:2048 sc1
  s_waitcnt vmcnt(8)
  s_waitcnt lgkmcnt(6)
  v_mfma_f32_32x32x16_bf16 v[80:95], v[128:131], v[40:43], v[80:95]
  v_mfma_f32_32x32x16_bf16 v[96:111], v[132:135], v[40:43], v[96:111]
  ds_read_b128 v[128:131], v254 offset:10240
  ds_read_b128 v[132:135], v255 offset:10240
  buffer_load_dwordx4 v[76:79], v2, s[4:7], s91 offen offset:3072 sc1
  s_waitcnt vmcnt(8)
  s_waitcnt lgkmcnt(6)
  v_mfma_f32_32x32x16_bf16 v[80:95], v[136:139], v[44:47], v[80:95]
  v_mfma_f32_32x32x16_bf16 v[96:111], v[140:143], v[44:47], v[96:111]
  ds_read_b128 v[136:139], v254 offset:11264
  ds_read_b128 v[140:143], v255 offset:11264
  s_waitcnt vmcnt(7)
  s_waitcnt lgkmcnt(6)
  v_mfma_f32_32x32x16_bf16 v[80:95], v[112:115], v[48:51], v[80:95]
  v_mfma_f32_32x32x16_bf16 v[96:111], v[116:119], v[48:51], v[96:111]
  s_add_u32 s47, s60, 0
  buffer_load_dwordx4 a[128:131], v2, s[4:7], s47 offen offset:0 sc1
  ds_read_b128 v[112:115], v254 offset:12288
  ds_read_b128 v[116:119], v255 offset:12288
  s_waitcnt vmcnt(7)
  s_waitcnt lgkmcnt(6)
  v_mfma_f32_32x32x16_bf16 v[80:95], v[120:123], v[52:55], v[80:95]
  v_mfma_f32_32x32x16_bf16 v[96:111], v[124:127], v[52:55], v[96:111]
  s_add_u32 s47, s60, 0
  buffer_load_dwordx4 a[132:135], v2, s[4:7], s47 offen offset:1024 sc1
  ds_read_b128 v[120:123], v254 offset:13312
  ds_read_b128 v[124:127], v255 offset:13312
  s_waitcnt vmcnt(7)
  s_waitcnt lgkmcnt(6)
  v_mfma_f32_32x32x16_bf16 v[80:95], v[128:131], v[56:59], v[80:95]
  v_mfma_f32_32x32x16_bf16 v[96:111], v[132:135], v[56:59], v[96:111]
  s_add_u32 s47, s60, 0
  buffer_load_dwordx4 a[136:139], v2, s[4:7], s47 offen offset:2048 sc1
  ds_read_b128 v[128:131], v254 offset:14336
  ds_read_b128 v[132:135], v255 offset:14336
  s_waitcnt vmcnt(7)
  s_waitcnt lgkmcnt(6)
  v_mfma_f32_32x32x16_bf16 v[80:95], v[136:139], v[60:63], v[80:95]
  v_mfma_f32_32x32x16_bf16 v[96:111], v[140:143], v[60:63], v[96:111]
  s_add_u32 s47, s60, 0
  buffer_load_dwordx4 a[140:143], v2, s[4:7], s47 offen offset:3072 sc1
  ds_read_b128 v[136:139], v254 offset:15360
  ds_read_b128 v[140:143], v255 offset:15360
  s_waitcnt vmcnt(7)
  s_waitcnt lgkmcnt(6)
  v_mfma_f32_32x32x16_bf16 v[80:95], v[112:115], v[64:67], v[80:95]
  v_mfma_f32_32x32x16_bf16 v[96:111], v[116:119], v[64:67], v[96:111]
  s_add_u32 s47, s60, 4096
  buffer_load_dwordx4 a[144:147], v2, s[4:7], s47 offen offset:0 sc1
  s_waitcnt vmcnt(7)
  s_waitcnt lgkmcnt(4)
  v_mfma_f32_32x32x16_bf16 v[80:95], v[120:123], v[68:71], v[80:95]
  v_mfma_f32_32x32x16_bf16 v[96:111], v[124:127], v[68:71], v[96:111]
  s_add_u32 s47, s60, 4096
  buffer_load_dwordx4 a[148:151], v2, s[4:7], s47 offen offset:1024 sc1
  s_waitcnt vmcnt(7)
  s_waitcnt lgkmcnt(2)
  v_mfma_f32_32x32x16_bf16 v[80:95], v[128:131], v[72:75], v[80:95]
  v_mfma_f32_32x32x16_bf16 v[96:111], v[132:135], v[72:75], v[96:111]
  s_add_u32 s47, s60, 4096
  buffer_load_dwordx4 a[152:155], v2, s[4:7], s47 offen offset:2048 sc1
  s_waitcnt vmcnt(7)
  s_waitcnt lgkmcnt(0)
  v_mfma_f32_32x32x16_bf16 v[80:95], v[136:139], v[76:79], v[80:95]
  v_mfma_f32_32x32x16_bf16 v[96:111], v[140:143], v[76:79], v[96:111]
  s_add_u32 s47, s60, 4096
  buffer_load_dwordx4 a[156:159], v2, s[4:7], s47 offen offset:3072 sc1
  v_lshlrev_b32 v16, 16, v4
  v_and_b32 v17, 0xffff0000, v4
  v_lshlrev_b32 v18, 16, v5
  v_and_b32 v19, 0xffff0000, v5
  s_add_u32 s47, s60, 8192
  buffer_load_dwordx4 a[160:163], v2, s[4:7], s47 offen offset:0 sc1
  v_lshlrev_b32 v20, 16, v6
  v_and_b32 v21, 0xffff0000, v6
  v_lshlrev_b32 v22, 16, v7
  v_and_b32 v23, 0xffff0000, v7
  s_add_u32 s47, s60, 8192
  buffer_load_dwordx4 a[164:167], v2, s[4:7], s47 offen offset:1024 sc1
  v_lshlrev_b32 v24, 16, v8
  v_and_b32 v25, 0xffff0000, v8
  v_lshlrev_b32 v26, 16, v9
  v_and_b32 v27, 0xffff0000, v9
  buffer_load_dwordx4 v[176:179], v248, s[4:7], s94 offen offset:0 sc1
  v_lshlrev_b32 v28, 16, v10
  v_and_b32 v29, 0xffff0000, v10
  v_lshlrev_b32 v30, 16, v11
  v_and_b32 v31, 0xffff0000, v11
  buffer_load_dwordx4 v[180:183], v248, s[4:7], s94 offen offset:32 sc1
  s_lshl_b32 s40, s18, 12
  s_add_u32 s40, s40, 131072
  v_add_u32 v14, s40, v2
  s_xor_b32 s40, s40, 8192
  v_add_u32 v15, s40, v2
  ds_write_b128 v14, v[96:99] offset:0
  ds_write_b128 v14, v[100:103] offset:1024
  ds_write_b128 v14, v[104:107] offset:2048
  ds_write_b128 v14, v[108:111] offset:3072
  buffer_load_dwordx4 v[184:187], v248, s[4:7], s94 offen offset:64 sc1
  buffer_load_dwordx4 v[188:191], v248, s[4:7], s94 offen offset:96 sc1
  buffer_load_dwordx4 v[192:195], v248, s[4:7], s95 offen offset:0 sc1
  buffer_load_dwordx4 v[196:199], v248, s[4:7], s95 offen offset:32 sc1
  s_waitcnt lgkmcnt(0)
  s_barrier
  ds_read_b128 v[96:99], v15 offset:0
  ds_read_b128 v[100:103], v15 offset:1024
  ds_read_b128 v[104:107], v15 offset:2048
  ds_read_b128 v[108:111], v15 offset:3072
  buffer_load_dwordx4 v[200:203], v248, s[4:7], s95 offen offset:64 sc1
  buffer_load_dwordx4 v[204:207], v248, s[4:7], s95 offen offset:96 sc1
  buffer_load_dword v208, v249, s[4:7], s94 offen sc1
  buffer_load_dword v209, v249, s[4:7], s95 offen sc1
  s_waitcnt lgkmcnt(3)
  v_pk_add_f32 v[80:81], v[80:81], v[96:97]
  v_pk_add_f32 v[82:83], v[82:83], v[98:99]
  s_waitcnt lgkmcnt(2)
  v_pk_add_f32 v[84:85], v[84:85], v[100:101]
  v_pk_add_f32 v[86:87], v[86:87], v[102:103]
  s_waitcnt lgkmcnt(1)
  v_pk_add_f32 v[88:89], v[88:89], v[104:105]
  v_pk_add_f32 v[90:91], v[90:91], v[106:107]
  s_waitcnt lgkmcnt(0)
  v_pk_add_f32 v[92:93], v[92:93], v[108:109]
  v_pk_add_f32 v[94:95], v[94:95], v[110:111]
  v_pk_add_f32 v[80:81], v[80:81], v[16:17]
  v_pk_add_f32 v[82:83], v[82:83], v[18:19]
  v_pk_add_f32 v[84:85], v[84:85], v[20:21]
  v_pk_add_f32 v[86:87], v[86:87], v[22:23]
  v_pk_add_f32 v[88:89], v[88:89], v[24:25]
  v_pk_add_f32 v[90:91], v[90:91], v[26:27]
  v_pk_add_f32 v[92:93], v[92:93], v[28:29]
  v_pk_add_f32 v[94:95], v[94:95], v[30:31]
  v_cvt_pk_bf16_f32 v4, v80, v81
  v_cvt_pk_bf16_f32 v5, v82, v83
  v_cvt_pk_bf16_f32 v6, v84, v85
  v_cvt_pk_bf16_f32 v7, v86, v87
  v_cvt_pk_bf16_f32 v8, v88, v89
  v_cvt_pk_bf16_f32 v9, v90, v91
  v_cvt_pk_bf16_f32 v10, v92, v93
  v_cvt_pk_bf16_f32 v11, v94, v95
  s_add_u32 s40, s29, s24
  s_cmp_eq_u32 s39, 1
  s_cbranch_scc1 FAST_58
  buffer_store_dwordx4 v[4:7], v2, s[4:7], s40 offen offset:0 sc1
  buffer_store_dwordx4 v[8:11], v2, s[4:7], s40 offen offset:1024 sc1
  s_branch MDONE_59
FAST_58:
  buffer_store_dwordx4 v[4:7], v2, s[4:7], s40 offen offset:0
  buffer_store_dwordx4 v[8:11], v2, s[4:7], s40 offen offset:1024
MDONE_59:
  v_mov_b32 v16, 0x3f803f80
  v_mov_b32 v17, 0
  v_mov_b32 v18, 0
  v_mov_b32 v19, 0
  v_mov_b32 v20, 0
  v_dot2c_f32_bf16 v17, v16, v4
  v_dot2c_f32_bf16 v18, v4, v4
  v_dot2c_f32_bf16 v19, v16, v5
  v_dot2c_f32_bf16 v20, v5, v5
  v_dot2c_f32_bf16 v17, v16, v6
  v_dot2c_f32_bf16 v18, v6, v6
  v_dot2c_f32_bf16 v19, v16, v7
  v_dot2c_f32_bf16 v20, v7, v7
  v_dot2c_f32_bf16 v17, v16, v8
  v_dot2c_f32_bf16 v18, v8, v8
  v_dot2c_f32_bf16 v19, v16, v9
  v_dot2c_f32_bf16 v20, v9, v9
  v_dot2c_f32_bf16 v17, v16, v10
  v_dot2c_f32_bf16 v18, v10, v10
  v_dot2c_f32_bf16 v19, v16, v11
  v_dot2c_f32_bf16 v20, v11, v11
  s_nop 1
  v_add_f32 v17, v17, v19
  v_add_f32 v18, v18, v20
  s_nop 1
  v_permlane32_swap_b32 v17, v18
  v_add_f32 v17, v17, v18
  s_add_u32 s40, s32, s25
  s_cmp_eq_u32 s39, 1
  s_cbranch_scc1 FAST_60
  buffer_store_dword v17, v12, s[4:7], s40 offen offset:0 sc1
  s_branch MDONE_61
FAST_60:
  buffer_store_dword v17, v12, s[4:7], s40 offen offset:0
MDONE_61:
  s_lshl_b32 s41, s16, 15
  s_add_u32 s41, s41, s36
  s_lshl_b32 s42, s27, 11
  s_add_u32 s41, s41, s42
  s_mov_b32 exec_lo, 0xffff0000
  s_mov_b32 exec_hi, 0xffff0000
  buffer_store_dwordx4 v[4:7], v13, s[4:7], s41 offen offset:0 sc1
  buffer_store_dwordx4 v[8:11], v13, s[4:7], s41 offen offset:1024 sc1
  s_mov_b64 exec, -1
  s_add_u32 s40, s53, s25
  buffer_store_dword v17, v12, s[4:7], s40 offen offset:0 sc1
  s_lshl_b32 s61, s16, 7
  s_add_u32 s61, s61, s38
  s_add_u32 s61, s61, 4096
  s_waitcnt vmcnt(3)
  s_barrier
  s_cmp_lg_u32 s18, 0
  s_cbranch_scc1 SYNCA_62
  s_mov_b64 exec, 1
  s_cmp_eq_u32 s39, 1
  s_cbranch_scc1 FAST_64
  buffer_store_dword v245, v244, s[4:7], s61 offen sc1
  s_branch MDONE_65
FAST_64:
  buffer_store_dword v245, v244, s[4:7], s61 offen
MDONE_65:
  s_mov_b64 exec, -1
  buffer_load_dword v247, v246, s[4:7], s61 offen sc1
SYNCA_62:
  s_lshl_b32 s88, s16, 16
  s_add_u32 s88, s88, s29
  v_and_b32 v18, 31, v1
  v_lshrrev_b32 v19, 5, v1
  s_lshl_b32 s90, s16, 1
  s_and_b32 s45, s18, 1
  s_add_u32 s90, s90, s45
  s_lshl_b32 s90, s90, 12
  s_add_u32 s90, s90, s32
  v_lshlrev_b32 v20, 3, v18
  v_lshl_add_u32 v20, v19, 11, v20
  s_lshl_b32 s92, s23, 13
  s_add_u32 s92, s92, s53
  v_and_b32 v22, 15, v18
  v_add_u32 v22, 16, v22
  v_lshlrev_b32 v22, 3, v22
  v_lshrrev_b32 v23, 4, v18
  v_lshl_add_u32 v22, v23, 12, v22
  v_lshl_add_u32 v22, v19, 11, v22
  s_lshl_b32 s93, s22, 12
  s_lshl_b32 s41, s23, 7
  s_add_u32 s93, s93, s41
  s_add_u32 s93, s93, 131072
  v_and_b32 v23, 7, v1
  v_lshlrev_b32 v23, 2, v23
  s_lshl_b32 s89, s23, 15
  s_add_u32 s89, s89, s36
  v_and_b32 v134, 31, v1
  v_lshlrev_b32 v134, 2, v134
  v_add_u32 v134, 131072, v134
  v_lshrrev_b32 v135, 5, v1
  v_lshlrev_b32 v135, 4, v135
  v_add_u32 v135, 131072, v135
  v_add_u32 v21, 0x10000, v2
  s_lshl_b32 s96, s22, 12
  s_lshl_b32 s41, s16, 7
  s_add_u32 s96, s96, s41
  s_add_u32 s96, s96, 131072
  s_cmp_lg_u32 s18, 0
  s_cbranch_scc1 SYNC_63
  s_mov_b32 s52, 0
  s_waitcnt vmcnt(0)
  v_cmp_ne_u32 vcc, s21, v247
  s_nop 4
  s_cbranch_vccz SYNC_63
POLL_66:
  buffer_load_dword v247, v246, s[4:7], s61 offen sc1
  s_waitcnt vmcnt(0)
  v_cmp_ne_u32 vcc, s21, v247
  s_nop 4
  s_cbranch_vccz SYNC_63
  s_add_u32 s52, s52, 1
  s_cmp_lt_u32 s52, 400000
  s_cbranch_scc1 POLL_66
  s_branch L_END
SYNC_63:
  s_waitcnt vmcnt(0)
  s_barrier
  s_mul_i32 s41, s20, 3072
  s_lshl_b32 s42, s19, 15
  s_add_u32 s41, s41, s42
  s_add_u32 s41, s41, 0
  s_mov_b32 m0, s41
  s_add_u32 s43, s88, s41
  buffer_load_dwordx4 v2, s[4:7], s43 offen offset:0 sc1 lds
  buffer_load_dwordx4 v2, s[4:7], s43 offen offset:1024 sc1 lds
  buffer_load_dwordx4 v2, s[4:7], s43 offen offset:2048 sc1 lds
  s_mul_i32 s41, s20, 5120
  s_lshl_b32 s42, s19, 15
  s_add_u32 s41, s41, s42
  s_add_u32 s41, s41, 6144
  s_mov_b32 m0, s41
  s_add_u32 s43, s88, s41
  buffer_load_dwordx4 v2, s[4:7], s43 offen offset:0 sc1 lds
  buffer_load_dwordx4 v2, s[4:7], s43 offen offset:1024 sc1 lds
  buffer_load_dwordx4 v2, s[4:7], s43 offen offset:2048 sc1 lds
  buffer_load_dwordx4 v2, s[4:7], s43 offen offset:3072 sc1 lds
  s_mul_i32 s41, s20, 5120
  s_lshl_b32 s42, s19, 15
  s_add_u32 s41, s41, s42
  s_add_u32 s41, s41, 10240
  s_mov_b32 m0, s41
  s_add_u32 s43, s88, s41
  buffer_load_dwordx4 v2, s[4:7], s43 offen offset:0 sc1 lds
  s_cmp_lg_u32 s18, 0
  s_cbranch_scc1 HF_72
  s_mov_b64 exec, 1
  buffer_store_dword v245, v244, s[4:7], s96 offen sc1
  s_mov_b64 exec, -1
  s_waitcnt vmcnt(6)
  s_branch HF2_73
HF_72:
  s_waitcnt vmcnt(5)
HF2_73:
  s_barrier
  s_cmp_eq_u32 s18, 1
  s_cbranch_scc1 G2W1_68
  s_cmp_eq_u32 s18, 2
  s_cbranch_scc1 G2W2_69
  s_cmp_eq_u32 s18, 3
  s_cbranch_scc1 G2W3_70
G2W0_67:
  ds_read_b128 v[96:99], v2 offset:0
  ds_read_b128 v[100:103], v2 offset:32768
  ds_read_b128 v[104:107], v2 offset:1024
  ds_read_b128 v[108:111], v2 offset:33792
  ds_read_b128 v[112:115], v2 offset:2048
  ds_read_b128 v[116:119], v2 offset:34816
  ds_read_b128 v[120:123], v2 offset:3072
  ds_read_b128 v[124:127], v2 offset:35840
  s_waitcnt lgkmcnt(6)
  v_mfma_f32_32x32x16_bf16 v[32:47], a[0:3], v[96:99], 0
  s_mul_i32 s41, s20, 8192
  s_lshl_b32 s42, s19, 15
  s_add_u32 s41, s41, s42
  s_add_u32 s41, s41, 16384
  s_mov_b32 m0, s41
  s_add_u32 s43, s88, s41
  buffer_load_dwordx4 v2, s[4:7], s43 offen offset:0 sc1 lds
  v_mfma_f32_32x32x16_bf16 v[48:63], a[0:3], v[100:103], 0
  v_mfma_f32_32x32x16_bf16 v[64:79], a[128:131], v[96:99], 0
  buffer_load_dwordx4 v2, s[4:7], s43 offen offset:1024 sc1 lds
  v_mfma_f32_32x32x16_bf16 v[80:95], a[128:131], v[100:103], 0
  ds_read_b128 v[96:99], v2 offset:4096
  ds_read_b128 v[100:103], v2 offset:36864
  s_waitcnt lgkmcnt(6)
  v_mfma_f32_32x32x16_bf16 v[32:47], a[4:7], v[104:107], v[32:47]
  buffer_load_dwordx4 v2, s[4:7], s43 offen offset:2048 sc1 lds
  v_mfma_f32_32x32x16_bf16 v[48:63], a[4:7], v[108:111], v[48:63]
  v_mfma_f32_32x32x16_bf16 v[64:79], a[132:135], v[104:107], v[64:79]
  buffer_load_dwordx4 v2, s[4:7], s43 offen offset:3072 sc1 lds
  v_mfma_f32_32x32x16_bf16 v[80:95], a[132:135], v[108:111], v[80:95]
  ds_read_b128 v[104:107], v2 offset:5120
  ds_read_b128 v[108:111], v2 offset:37888
  s_waitcnt lgkmcnt(6)
  v_mfma_f32_32x32x16_bf16 v[32:47], a[8:11], v[112:115], v[32:47]
  s_mul_i32 s41, s20, 8192
  s_lshl_b32 s42, s19, 15
  s_add_u32 s41, s41, s42
  s_add_u32 s41, s41, 20480
  s_mov_b32 m0, s41
  s_add_u32 s43, s88, s41
  buffer_load_dwordx4 v2, s[4:7], s43 offen offset:0 sc1 lds
  v_mfma_f32_32x32x16_bf16 v[48:63], a[8:11], v[116:119], v[48:63]
  s_waitcnt vmcnt(6)
  s_barrier
  v_mfma_f32_32x32x16_bf16 v[64:79], a[136:139], v[112:115], v[64:79]
  buffer_load_dwordx4 v2, s[4:7], s43 offen offset:1024 sc1 lds
  v_mfma_f32_32x32x16_bf16 v[80:95], a[136:139], v[116:119], v[80:95]
  ds_read_b128 v[112:115], v2 offset:6144
  ds_read_b128 v[116:119], v2 offset:38912
  s_waitcnt lgkmcnt(6)
  v_mfma_f32_32x32x16_bf16 v[32:47], a[12:15], v[120:123], v[32:47]
  buffer_load_dwordx4 v2, s[4:7], s43 offen offset:2048 sc1 lds
  v_mfma_f32_32x32x16_bf16 v[48:63], a[12:15], v[124:127], v[48:63]
  v_mfma_f32_32x32x16_bf16 v[64:79], a[140:143], v[120:123], v[64:79]
  buffer_load_dwordx4 v2, s[4:7], s43 offen offset:3072 sc1 lds
  v_mfma_f32_32x32x16_bf16 v[80:95], a[140:143], v[124:127], v[80:95]
  ds_read_b128 v[120:123], v2 offset:7168
  ds_read_b128 v[124:127], v2 offset:39936
  s_waitcnt lgkmcnt(6)
  v_mfma_f32_32x32x16_bf16 v[32:47], a[16:19], v[96:99], v[32:47]
  v_mfma_f32_32x32x16_bf16 v[48:63], a[16:19], v[100:103], v[48:63]
  s_add_u32 s47, s60, 8192
  buffer_load_dwordx4 a[168:171], v2, s[4:7], s47 offen offset:2048 sc1
  v_mfma_f32_32x32x16_bf16 v[64:79], a[144:147], v[96:99], v[64:79]
  buffer_load_dword v24, v23, s[4:7], s93 offen sc1
  buffer_load_dwordx2 v[144:145], v20, s[4:7], s90 offen offset:0 sc1
  v_mfma_f32_32x32x16_bf16 v[80:95], a[144:147], v[100:103], v[80:95]
  buffer_load_dwordx2 v[146:147], v20, s[4:7], s90 offen offset:256 sc1
  ds_read_b128 v[96:99], v2 offset:8192
  ds_read_b128 v[100:103], v2 offset:40960
  s_waitcnt lgkmcnt(6)
  v_mfma_f32_32x32x16_bf16 v[32:47], a[20:23], v[104:107], v[32:47]
  buffer_load_dwordx2 v[148:149], v20, s[4:7], s90 offen offset:512 sc1
  v_mfma_f32_32x32x16_bf16 v[48:63], a[20:23], v[108:111], v[48:63]
  buffer_load_dwordx2 v[150:151], v20, s[4:7], s90 offen offset:768 sc1
  v_mfma_f32_32x32x16_bf16 v[64:79], a[148:151], v[104:107], v[64:79]
  s_add_u32 s47, s60, 8192
  buffer_load_dwordx4 a[172:175], v2, s[4:7], s47 offen offset:3072 sc1
  v_mfma_f32_32x32x16_bf16 v[80:95], a[148:151], v[108:111], v[80:95]
  buffer_load_dwordx2 v[152:153], v20, s[4:7], s90 offen offset:1024 sc1
  ds_read_b128 v[104:107], v2 offset:9216
  ds_read_b128 v[108:111], v2 offset:41984
  s_waitcnt lgkmcnt(6)
  v_mfma_f32_32x32x16_bf16 v[32:47], a[24:27], v[112:115], v[32:47]
  buffer_load_dwordx2 v[154:155], v20, s[4:7], s90 offen offset:1280 sc1
  v_mfma_f32_32x32x16_bf16 v[48:63], a[24:27], v[116:119], v[48:63]
  buffer_load_dwordx2 v[156:157], v20, s[4:7], s90 offen offset:1536 sc1
  v_mfma_f32_32x32x16_bf16 v[64:79], a[152:155], v[112:115], v[64:79]
  buffer_load_dwordx2 v[158:159], v20, s[4:7], s90 offen offset:1792 sc1
  v_mfma_f32_32x32x16_bf16 v[80:95], a[152:155], v[116:119], v[80:95]
  s_add_u32 s47, s60, 12288
  buffer_load_dwordx4 a[176:179], v2, s[4:7], s47 offen offset:0 sc1
  ds_read_b128 v[112:115], v2 offset:10240
  ds_read_b128 v[116:119], v2 offset:43008
  s_waitcnt lgkmcnt(6)
  v_mfma_f32_32x32x16_bf16 v[32:47], a[28:31], v[120:123], v[32:47]
  s_add_u32 s47, s60, 12288
  buffer_load_dwordx4 a[180:183], v2, s[4:7], s47 offen offset:1024 sc1
  v_mfma_f32_32x32x16_bf16 v[48:63], a[28:31], v[124:127], v[48:63]
  s_waitcnt vmcnt(11)
  v_cmp_ne_u32 vcc, s21, v24
  s_nop 4
  s_cbranch_vccz HOK_74
  s_mov_b32 s52, 0
HPOLL_75:
  buffer_load_dword v24, v23, s[4:7], s93 offen sc1
  s_waitcnt vmcnt(0)
  v_cmp_ne_u32 vcc, s21, v24
  s_nop 4
  s_cbranch_vccz HOK_74
  s_add_u32 s52, s52, 1
  s_cmp_lt_u32 s52, 400000
  s_cbranch_scc1 HPOLL_75
  s_branch L_END
HOK_74:
  s_barrier
  v_mfma_f32_32x32x16_bf16 v[64:79], a[156:159], v[120:123], v[64:79]
  s_lshl_b32 s41, s18, 13
  s_add_u32 s42, s89, s41
  s_add_u32 s41, s41, 65536
  s_mov_b32 m0, s41
  s_nop 0
  buffer_load_dwordx4 v2, s[4:7], s42 offen offset:0 sc1 lds
  v_mfma_f32_32x32x16_bf16 v[80:95], a[156:159], v[124:127], v[80:95]
  s_add_u32 s47, s60, 12288
  buffer_load_dwordx4 a[184:187], v2, s[4:7], s47 offen offset:2048 sc1
  ds_read_b128 v[120:123], v2 offset:11264
  ds_read_b128 v[124:127], v2 offset:44032
  s_waitcnt lgkmcnt(6)
  v_mfma_f32_32x32x16_bf16 v[32:47], a[32:35], v[96:99], v[32:47]
  buffer_load_dwordx4 v2, s[4:7], s42 offen offset:1024 sc1 lds
  v_mfma_f32_32x32x16_bf16 v[48:63], a[32:35], v[100:103], v[48:63]
  v_mfma_f32_32x32x16_bf16 v[64:79], a[160:163], v[96:99], v[64:79]
  buffer_load_dwordx4 v2, s[4:7], s42 offen offset:2048 sc1 lds
  v_mfma_f32_32x32x16_bf16 v[80:95], a[160:163], v[100:103], v[80:95]
  s_add_u32 s47, s60, 12288
  buffer_load_dwordx4 a[188:191], v2, s[4:7], s47 offen offset:3072 sc1
  ds_read_b128 v[96:99], v2 offset:12288
  ds_read_b128 v[100:103], v2 offset:45056
  s_waitcnt lgkmcnt(6)
  v_mfma_f32_32x32x16_bf16 v[32:47], a[36:39], v[104:107], v[32:47]
  buffer_load_dwordx4 v2, s[4:7], s42 offen offset:3072 sc1 lds
  v_mfma_f32_32x32x16_bf16 v[48:63], a[36:39], v[108:111], v[48:63]
  v_mfma_f32_32x32x16_bf16 v[64:79], a[164:167], v[104:107], v[64:79]
  s_lshl_b32 s41, s18, 13
  s_add_u32 s41, s41, 4096
  s_add_u32 s42, s89, s41
  s_add_u32 s41, s41, 65536
  s_mov_b32 m0, s41
  s_nop 0
  buffer_load_dwordx4 v2, s[4:7], s42 offen offset:0 sc1 lds
  v_mfma_f32_32x32x16_bf16 v[80:95], a[164:167], v[108:111], v[80:95]
  ds_read_b128 v[104:107], v2 offset:13312
  ds_read_b128 v[108:111], v2 offset:46080
  s_waitcnt lgkmcnt(6)
  v_mfma_f32_32x32x16_bf16 v[32:47], a[40:43], v[112:115], v[32:47]
  buffer_load_dwordx4 v2, s[4:7], s42 offen offset:1024 sc1 lds
  v_mfma_f32_32x32x16_bf16 v[48:63], a[40:43], v[116:119], v[48:63]
  v_mfma_f32_32x32x16_bf16 v[64:79], a[168:171], v[112:115], v[64:79]
  buffer_load_dwordx4 v2, s[4:7], s42 offen offset:2048 sc1 lds
  v_mfma_f32_32x32x16_bf16 v[80:95], a[168:171], v[116:119], v[80:95]
  ds_read_b128 v[112:115], v2 offset:14336
  ds_read_b128 v[116:119], v2 offset:47104
  s_waitcnt lgkmcnt(6)
  v_mfma_f32_32x32x16_bf16 v[32:47], a[44:47], v[120:123], v[32:47]
  buffer_load_dwordx4 v2, s[4:7], s42 offen offset:3072 sc1 lds
  v_mfma_f32_32x32x16_bf16 v[48:63], a[44:47], v[124:127], v[48:63]
  s_waitcnt vmcnt(16)
  v_mfma_f32_32x32x16_bf16 v[64:79], a[172:175], v[120:123], v[64:79]
  s_add_u32 s47, s60, 16384
  buffer_load_dwordx4 a[192:195], v2, s[4:7], s47 offen offset:0 sc1
  s_waitcnt vmcnt(13)
  v_add_f32 v144, v144, v146
  v_add_f32 v145, v145, v147
  v_add_f32 v144, v144, v148
  v_mfma_f32_32x32x16_bf16 v[80:95], a[172:175], v[124:127], v[80:95]
  v_add_f32 v145, v145, v149
  v_add_f32 v144, v144, v150
  v_add_f32 v145, v145, v151
  ds_read_b128 v[120:123], v2 offset:15360
  ds_read_b128 v[124:127], v2 offset:48128
  s_waitcnt lgkmcnt(6)
  v_mfma_f32_32x32x16_bf16 v[32:47], a[48:51], v[96:99], v[32:47]
  s_add_u32 s47, s60, 16384
  buffer_load_dwordx4 a[196:199], v2, s[4:7], s47 offen offset:1024 sc1
  v_add_f32 v144, v144, v152
  v_add_f32 v145, v145, v153
  v_add_f32 v144, v144, v154
  v_mfma_f32_32x32x16_bf16 v[48:63], a[48:51], v[100:103], v[48:63]
  v_add_f32 v145, v145, v155
  v_add_f32 v144, v144, v156
  v_add_f32 v145, v145, v157
  s_waitcnt vmcnt(13)
  v_mfma_f32_32x32x16_bf16 v[64:79], a[176:179], v[96:99], v[64:79]
  s_add_u32 s47, s60, 16384
  buffer_load_dwordx4 a[200:203], v2, s[4:7], s47 offen offset:2048 sc1
  v_add_f32 v144, v144, v158
  v_add_f32 v145, v145, v159
  s_nop 1
  v_permlane32_swap_b32 v144, v145
  v_mfma_f32_32x32x16_bf16 v[80:95], a[176:179], v[100:103], v[80:95]
  v_add_f32 v144, v144, v145
  v_mov_b32 v145, v144
  s_nop 1
  v_permlane32_swap_b32 v144, v145
  ds_read_b128 v[96:99], v2 offset:16384
  ds_read_b128 v[100:103], v2 offset:49152
  s_waitcnt lgkmcnt(6)
  v_mfma_f32_32x32x16_bf16 v[32:47], a[52:55], v[104:107], v[32:47]
  s_add_u32 s47, s60, 16384
  buffer_load_dwordx4 a[204:207], v2, s[4:7], s47 offen offset:3072 sc1
  v_mul_f32 v130, 0x3b000000, v144
  v_mul_f32 v145, 0x3b000000, v145
  v_fma_f32 v145, -v130, v130, v145
  v_mfma_f32_32x32x16_bf16 v[48:63], a[52:55], v[108:111], v[48:63]
  v_add_f32 v145, 0x3727c5ac, v145
  v_rsq_f32 v131, v145
  s_nop 0
  v_mul_f32 v130, v130, v131
  s_waitcnt vmcnt(14)
  v_mfma_f32_32x32x16_bf16 v[64:79], a[180:183], v[104:107], v[64:79]
  s_add_u32 s47, s60, 20480
  buffer_load_dwordx4 a[208:211], v2, s[4:7], s47 offen offset:0 sc1
  v_sub_f32 v130, 0, v130
  v_cmp_gt_u32 vcc, 32, v1
  s_nop 1
  v_mfma_f32_32x32x16_bf16 v[80:95], a[180:183], v[108:111], v[80:95]
  v_cndmask_b32 v130, v130, v131, vcc
  v_add_u32 v131, 131072, v3
  ds_write_b32 v131, v130
  ds_read_b128 v[104:107], v2 offset:17408
  ds_read_b128 v[108:111], v2 offset:50176
  s_waitcnt lgkmcnt(7)
  v_mfma_f32_32x32x16_bf16 v[32:47], a[56:59], v[112:115], v[32:47]
  s_add_u32 s47, s60, 20480
  buffer_load_dwordx4 a[212:215], v2, s[4:7], s47 offen offset:1024 sc1
  v_mfma_f32_32x32x16_bf16 v[48:63], a[56:59], v[116:119], v[48:63]
  s_waitcnt vmcnt(14)
  v_mfma_f32_32x32x16_bf16 v[64:79], a[184:187], v[112:115], v[64:79]
  s_add_u32 s47, s60, 20480
  buffer_load_dwordx4 a[216:219], v2, s[4:7], s47 offen offset:2048 sc1
  v_mfma_f32_32x32x16_bf16 v[80:95], a[184:187], v[116:119], v[80:95]
  ds_read_b128 v[112:115], v2 offset:18432
  ds_read_b128 v[116:119], v2 offset:51200
  s_waitcnt lgkmcnt(7)
  v_mfma_f32_32x32x16_bf16 v[32:47], a[60:63], v[120:123], v[32:47]
  s_add_u32 s47, s60, 20480
  buffer_load_dwordx4 a[220:223], v2, s[4:7], s47 offen offset:3072 sc1
  v_mfma_f32_32x32x16_bf16 v[48:63], a[60:63], v[124:127], v[48:63]
  s_waitcnt vmcnt(8)
  s_waitcnt lgkmcnt(0)
  s_barrier
  ds_read_b32 v136, v134 offset:0
  ds_read_b32 v137, v134 offset:128
  ds_read_b32 v138, v134 offset:256
  ds_read_b32 v139, v134 offset:384
  v_mfma_f32_32x32x16_bf16 v[64:79], a[188:191], v[120:123], v[64:79]
  s_add_u32 s47, s60, 24576
  buffer_load_dwordx4 a[224:227], v2, s[4:7], s47 offen offset:0 sc1
  v_mfma_f32_32x32x16_bf16 v[80:95], a[188:191], v[124:127], v[80:95]
  ds_read_b128 v[120:123], v2 offset:19456
  ds_read_b128 v[124:127], v2 offset:52224
  v_mfma_f32_32x32x16_bf16 v[32:47], a[64:67], v[96:99], v[32:47]
  s_add_u32 s47, s60, 24576
  buffer_load_dwordx4 a[228:231], v2, s[4:7], s47 offen offset:1024 sc1
  v_mfma_f32_32x32x16_bf16 v[48:63], a[64:67], v[100:103], v[48:63]
  ds_read_b128 v[96:99], v2 offset:20480
  ds_read_b128 v[100:103], v2 offset:53248
  v_mfma_f32_32x32x16_bf16 v[32:47], a[68:71], v[104:107], v[32:47]
  s_add_u32 s47, s60, 24576
  buffer_load_dwordx4 a[232:235], v2, s[4:7], s47 offen offset:2048 sc1
  v_mfma_f32_32x32x16_bf16 v[48:63], a[68:71], v[108:111], v[48:63]
  ds_read_b128 v[104:107], v2 offset:21504
  ds_read_b128 v[108:111], v2 offset:54272
  v_mfma_f32_32x32x16_bf16 v[32:47], a[72:75], v[112:115], v[32:47]
  s_add_u32 s47, s60, 24576
  buffer_load_dwordx4 a[236:239], v2, s[4:7], s47 offen offset:3072 sc1
  v_mfma_f32_32x32x16_bf16 v[48:63], a[72:75], v[116:119], v[48:63]
  ds_read_b128 v[112:115], v2 offset:22528
  ds_read_b128 v[116:119], v2 offset:55296
  s_waitcnt lgkmcnt(6)
  v_mfma_f32_32x32x16_bf16 v[32:47], a[76:79], v[120:123], v[32:47]
  s_add_u32 s47, s60, 28672
  buffer_load_dwordx4 a[240:243], v2, s[4:7], s47 offen offset:0 sc1
  v_mfma_f32_32x32x16_bf16 v[48:63], a[76:79], v[124:127], v[48:63]
  ds_read_b128 v[120:123], v2 offset:23552
  ds_read_b128 v[124:127], v2 offset:56320
  s_waitcnt lgkmcnt(6)
  v_mfma_f32_32x32x16_bf16 v[32:47], a[80:83], v[96:99], v[32:47]
  s_add_u32 s47, s60, 28672
  buffer_load_dwordx4 a[244:247], v2, s[4:7], s47 offen offset:1024 sc1
  v_mfma_f32_32x32x16_bf16 v[48:63], a[80:83], v[100:103], v[48:63]
  ds_read_b128 v[96:99], v2 offset:24576
  ds_read_b128 v[100:103], v2 offset:57344
  s_waitcnt lgkmcnt(6)
  v_mfma_f32_32x32x16_bf16 v[32:47], a[84:87], v[104:107], v[32:47]
  s_add_u32 s47, s60, 28672
  buffer_load_dwordx4 a[248:251], v2, s[4:7], s47 offen offset:2048 sc1
  v_mfma_f32_32x32x16_bf16 v[48:63], a[84:87], v[108:111], v[48:63]
  ds_read_b128 v[104:107], v2 offset:25600
  ds_read_b128 v[108:111], v2 offset:58368
  s_waitcnt lgkmcnt(6)
  v_mfma_f32_32x32x16_bf16 v[32:47], a[88:91], v[112:115], v[32:47]
  s_add_u32 s47, s60, 28672
  buffer_load_dwordx4 a[252:255], v2, s[4:7], s47 offen offset:3072 sc1
  v_mfma_f32_32x32x16_bf16 v[48:63], a[88:91], v[116:119], v[48:63]
  ds_read_b128 v[112:115], v2 offset:26624
  ds_read_b128 v[116:119], v2 offset:59392
  s_waitcnt lgkmcnt(6)
  v_mfma_f32_32x32x16_bf16 v[32:47], a[92:95], v[120:123], v[32:47]
  v_mfma_f32_32x32x16_bf16 v[48:63], a[92:95], v[124:127], v[48:63]
  ds_read_b128 v[120:123], v2 offset:27648
  ds_read_b128 v[124:127], v2 offset:60416
  s_waitcnt lgkmcnt(6)
  v_mfma_f32_32x32x16_bf16 v[32:47], a[96:99], v[96:99], v[32:47]
  v_mfma_f32_32x32x16_bf16 v[48:63], a[96:99], v[100:103], v[48:63]
  ds_read_b128 v[96:99], v2 offset:28672
  ds_read_b128 v[100:103], v2 offset:61440
  s_waitcnt lgkmcnt(6)
  v_mfma_f32_32x32x16_bf16 v[32:47], a[100:103], v[104:107], v[32:47]
  v_mfma_f32_32x32x16_bf16 v[48:63], a[100:103], v[108:111], v[48:63]
  ds_read_b128 v[104:107], v2 offset:29696
  ds_read_b128 v[108:111], v2 offset:62464
  s_waitcnt lgkmcnt(6)
  v_mfma_f32_32x32x16_bf16 v[32:47], a[104:107], v[112:115], v[32:47]
  v_mfma_f32_32x32x16_bf16 v[48:63], a[104:107], v[116:119], v[48:63]
  ds_read_b128 v[112:115], v2 offset:30720
  ds_read_b128 v[116:119], v2 offset:63488
  s_waitcnt lgkmcnt(6)
  v_mfma_f32_32x32x16_bf16 v[32:47], a[108:111], v[120:123], v[32:47]
  v_mfma_f32_32x32x16_bf16 v[48:63], a[108:111], v[124:127], v[48:63]
  ds_read_b128 v[120:123], v2 offset:31744
  ds_read_b128 v[124:127], v2 offset:64512
  s_waitcnt lgkmcnt(6)
  v_mfma_f32_32x32x16_bf16 v[32:47], a[112:115], v[96:99], v[32:47]
  v_mfma_f32_32x32x16_bf16 v[48:63], a[112:115], v[100:103], v[48:63]
  ds_read_b128 v[96:99], v2 offset:16384
  ds_read_b128 v[100:103], v2 offset:49152
  s_waitcnt lgkmcnt(6)
  v_mfma_f32_32x32x16_bf16 v[32:47], a[116:119], v[104:107], v[32:47]
  v_mfma_f32_32x32x16_bf16 v[48:63], a[116:119], v[108:111], v[48:63]
  ds_read_b128 v[104:107], v2 offset:17408
  ds_read_b128 v[108:111], v2 offset:50176
  s_waitcnt lgkmcnt(6)
  v_mfma_f32_32x32x16_bf16 v[32:47], a[120:123], v[112:115], v[32:47]
  v_mfma_f32_32x32x16_bf16 v[48:63], a[120:123], v[116:119], v[48:63]
  ds_read_b128 v[112:115], v2 offset:18432
  ds_read_b128 v[116:119], v2 offset:51200
  s_waitcnt lgkmcnt(6)
  v_mfma_f32_32x32x16_bf16 v[32:47], a[124:127], v[120:123], v[32:47]
  v_mfma_f32_32x32x16_bf16 v[48:63], a[124:127], v[124:127], v[48:63]
  ds_read_b128 v[120:123], v2 offset:19456
  ds_read_b128 v[124:127], v2 offset:52224
  s_waitcnt lgkmcnt(6)
  s_waitcnt vmcnt(15)
  v_mfma_f32_32x32x16_bf16 v[64:79], a[192:195], v[96:99], v[64:79]
  v_mfma_f32_32x32x16_bf16 v[80:95], a[192:195], v[100:103], v[80:95]
  ds_read_b128 v[96:99], v2 offset:20480
  ds_read_b128 v[100:103], v2 offset:53248
  s_waitcnt lgkmcnt(6)
  s_waitcnt vmcnt(14)
  v_mfma_f32_32x32x16_bf16 v[64:79], a[196:199], v[104:107], v[64:79]
  v_mul_f32 v142, 0x3eb8aa3b, v136
  v_mul_f32 v143, 0x3eb8aa3b, v137
  v_mul_f32 v144, v143, v176
  v_fmac_f32 v144, v32, v142
  v_mfma_f32_32x32x16_bf16 v[80:95], a[196:199], v[108:111], v[80:95]
  v_mul_f32 v145, v143, v177
  v_fmac_f32 v145, v33, v142
  v_mul_f32 v146, v143, v178
  v_fmac_f32 v146, v34, v142
  ds_read_b128 v[104:107], v2 offset:21504
  ds_read_b128 v[108:111], v2 offset:54272
  s_waitcnt lgkmcnt(6)
  s_waitcnt vmcnt(13)
  v_mfma_f32_32x32x16_bf16 v[64:79], a[200:203], v[112:115], v[64:79]
  v_mul_f32 v147, v143, v179
  v_fmac_f32 v147, v35, v142
  v_mul_f32 v148, v143, v180
  v_fmac_f32 v148, v36, v142
  v_mfma_f32_32x32x16_bf16 v[80:95], a[200:203], v[116:119], v[80:95]
  v_mul_f32 v149, v143, v181
  v_fmac_f32 v149, v37, v142
  v_mul_f32 v150, v143, v182
  v_fmac_f32 v150, v38, v142
  ds_read_b128 v[112:115], v2 offset:22528
  ds_read_b128 v[116:119], v2 offset:55296
  s_waitcnt lgkmcnt(6)
  s_waitcnt vmcnt(12)
  v_mfma_f32_32x32x16_bf16 v[64:79], a[204:207], v[120:123], v[64:79]
  v_mul_f32 v151, v143, v183
  v_fmac_f32 v151, v39, v142
  v_mul_f32 v152, v143, v184
  v_fmac_f32 v152, v40, v142
  v_mfma_f32_32x32x16_bf16 v[80:95], a[204:207], v[124:127], v[80:95]
  v_mul_f32 v153, v143, v185
  v_fmac_f32 v153, v41, v142
  v_mul_f32 v154, v143, v186
  v_fmac_f32 v154, v42, v142
  ds_read_b128 v[120:123], v2 offset:23552
  ds_read_b128 v[124:127], v2 offset:56320
  s_waitcnt lgkmcnt(6)
  s_waitcnt vmcnt(11)
  v_mfma_f32_32x32x16_bf16 v[64:79], a[208:211], v[96:99], v[64:79]
  v_mul_f32 v155, v143, v187
  v_fmac_f32 v155, v43, v142
  v_mul_f32 v156, v143, v188
  v_fmac_f32 v156, v44, v142
  v_mfma_f32_32x32x16_bf16 v[80:95], a[208:211], v[100:103], v[80:95]
  v_mul_f32 v157, v143, v189
  v_fmac_f32 v157, v45, v142
  v_mul_f32 v158, v143, v190
  v_fmac_f32 v158, v46, v142
  ds_read_b128 v[96:99], v2 offset:24576
  ds_read_b128 v[100:103], v2 offset:57344
  s_waitcnt lgkmcnt(6)
  s_waitcnt vmcnt(10)
  v_mfma_f32_32x32x16_bf16 v[64:79], a[212:215], v[104:107], v[64:79]
  v_mul_f32 v159, v143, v191
  v_fmac_f32 v159, v47, v142
  v_cvt_pk_bf16_f32 v32, v144, v145
  v_cvt_pk_bf16_f32 v33, v146, v147
  v_mfma_f32_32x32x16_bf16 v[80:95], a[212:215], v[108:111], v[80:95]
  v_cvt_pk_bf16_f32 v34, v148, v149
  v_cvt_pk_bf16_f32 v35, v150, v151
  v_cvt_pk_bf16_f32 v36, v152, v153
  v_cvt_pk_bf16_f32 v37, v154, v155
  ds_read_b128 v[104:107], v2 offset:25600
  ds_read_b128 v[108:111], v2 offset:58368
  s_waitcnt lgkmcnt(6)
  s_waitcnt vmcnt(9)
  v_mfma_f32_32x32x16_bf16 v[64:79], a[216:219], v[112:115], v[64:79]
  v_cvt_pk_bf16_f32 v38, v156, v157
  v_cvt_pk_bf16_f32 v39, v158, v159
  v_add_u32 v133, 98304, v2
  ds_write_b128 v133, v[32:35]
  v_mfma_f32_32x32x16_bf16 v[80:95], a[216:219], v[116:119], v[80:95]
  ds_write_b128 v133, v[36:39] offset:1024
  v_mul_f32 v142, 0x3eb8aa3b, v138
  v_mul_f32 v143, 0x3eb8aa3b, v139
  v_mul_f32 v144, v143, v176
  ds_read_b128 v[112:115], v2 offset:26624
  ds_read_b128 v[116:119], v2 offset:59392
  s_waitcnt lgkmcnt(8)
  s_waitcnt vmcnt(8)
  v_mfma_f32_32x32x16_bf16 v[64:79], a[220:223], v[120:123], v[64:79]
  v_fmac_f32 v144, v48, v142
  v_mul_f32 v145, v143, v177
  v_fmac_f32 v145, v49, v142
  v_mul_f32 v146, v143, v178
  v_mfma_f32_32x32x16_bf16 v[80:95], a[220:223], v[124:127], v[80:95]
  v_fmac_f32 v146, v50, v142
  v_mul_f32 v147, v143, v179
  v_fmac_f32 v147, v51, v142
  v_mul_f32 v148, v143, v180
  ds_read_b128 v[120:123], v2 offset:27648
  ds_read_b128 v[124:127], v2 offset:60416
  s_waitcnt lgkmcnt(8)
  s_waitcnt vmcnt(7)
  v_mfma_f32_32x32x16_bf16 v[64:79], a[224:227], v[96:99], v[64:79]
  v_fmac_f32 v148, v52, v142
  v_mul_f32 v149, v143, v181
  v_fmac_f32 v149, v53, v142
  v_mul_f32 v150, v143, v182
  v_mfma_f32_32x32x16_bf16 v[80:95], a[224:227], v[100:103], v[80:95]
  v_fmac_f32 v150, v54, v142
  v_mul_f32 v151, v143, v183
  v_fmac_f32 v151, v55, v142
  v_mul_f32 v152, v143, v184
  ds_read_b128 v[96:99], v2 offset:28672
  ds_read_b128 v[100:103], v2 offset:61440
  s_waitcnt lgkmcnt(8)
  s_waitcnt vmcnt(6)
  v_mfma_f32_32x32x16_bf16 v[64:79], a[228:231], v[104:107], v[64:79]
  v_fmac_f32 v152, v56, v142
  v_mul_f32 v153, v143, v185
  v_fmac_f32 v153, v57, v142
  v_mul_f32 v154, v143, v186
  v_mfma_f32_32x32x16_bf16 v[80:95], a[228:231], v[108:111], v[80:95]
  v_fmac_f32 v154, v58, v142
  v_mul_f32 v155, v143, v187
  v_fmac_f32 v155, v59, v142
  v_mul_f32 v156, v143, v188
  ds_read_b128 v[104:107], v2 offset:29696
  ds_read_b128 v[108:111], v2 offset:62464
  s_waitcnt lgkmcnt(6)
  s_waitcnt vmcnt(5)
  v_mfma_f32_32x32x16_bf16 v[64:79], a[232:235], v[112:115], v[64:79]
  v_fmac_f32 v156, v60, v142
  v_mul_f32 v157, v143, v189
  v_fmac_f32 v157, v61, v142
  v_mul_f32 v158, v143, v190
  v_mfma_f32_32x32x16_bf16 v[80:95], a[232:235], v[116:119], v[80:95]
  v_fmac_f32 v158, v62, v142
  v_mul_f32 v159, v143, v191
  v_fmac_f32 v159, v63, v142
  v_cvt_pk_bf16_f32 v48, v144, v145
  ds_read_b128 v[112:115], v2 offset:30720
  ds_read_b128 v[116:119], v2 offset:63488
  s_waitcnt lgkmcnt(6)
  s_waitcnt vmcnt(4)
  v_mfma_f32_32x32x16_bf16 v[64:79], a[236:239], v[120:123], v[64:79]
  v_cvt_pk_bf16_f32 v49, v146, v147
  v_cvt_pk_bf16_f32 v50, v148, v149
  v_cvt_pk_bf16_f32 v51, v150, v151
  v_cvt_pk_bf16_f32 v52, v152, v153
  v_mfma_f32_32x32x16_bf16 v[80:95], a[236:239], v[124:127], v[80:95]
  v_cvt_pk_bf16_f32 v53, v154, v155
  v_cvt_pk_bf16_f32 v54, v156, v157
  v_cvt_pk_bf16_f32 v55, v158, v159
  v_add_u32 v133, 102400, v2
  ds_read_b128 v[120:123], v2 offset:31744
  ds_read_b128 v[124:127], v2 offset:64512
  s_waitcnt lgkmcnt(6)
  s_waitcnt vmcnt(3)
  v_mfma_f32_32x32x16_bf16 v[64:79], a[240:243], v[96:99], v[64:79]
  ds_write_b128 v133, v[48:51]
  ds_write_b128 v133, v[52:55] offset:1024
  v_mfma_f32_32x32x16_bf16 v[80:95], a[240:243], v[100:103], v[80:95]
  s_waitcnt lgkmcnt(6)
  s_waitcnt vmcnt(2)
  v_mfma_f32_32x32x16_bf16 v[64:79], a[244:247], v[104:107], v[64:79]
  v_mfma_f32_32x32x16_bf16 v[80:95], a[244:247], v[108:111], v[80:95]
  s_waitcnt lgkmcnt(4)
  s_waitcnt vmcnt(1)
  v_mfma_f32_32x32x16_bf16 v[64:79], a[248:251], v[112:115], v[64:79]
  v_mfma_f32_32x32x16_bf16 v[80:95], a[248:251], v[116:119], v[80:95]
  s_waitcnt lgkmcnt(2)
  s_waitcnt vmcnt(0)
  v_mfma_f32_32x32x16_bf16 v[64:79], a[252:255], v[120:123], v[64:79]
  v_mfma_f32_32x32x16_bf16 v[80:95], a[252:255], v[124:127], v[80:95]
  v_mul_f32 v142, 0x3eb8aa3b, v136
  v_mul_f32 v143, 0x3eb8aa3b, v137
  v_mov_b32 v128, v142
  v_mov_b32 v130, v143
  v_pk_mul_f32 v[144:145], v[192:193], v[130:131] op_sel_hi:[1,0]
  v_pk_mul_f32 v[146:147], v[194:195], v[130:131] op_sel_hi:[1,0]
  v_pk_mul_f32 v[148:149], v[196:197], v[130:131] op_sel_hi:[1,0]
  v_pk_mul_f32 v[150:151], v[198:199], v[130:131] op_sel_hi:[1,0]
  v_pk_mul_f32 v[152:153], v[200:201], v[130:131] op_sel_hi:[1,0]
  v_pk_mul_f32 v[154:155], v[202:203], v[130:131] op_sel_hi:[1,0]
  v_pk_mul_f32 v[156:157], v[204:205], v[130:131] op_sel_hi:[1,0]
  v_pk_mul_f32 v[158:159], v[206:207], v[130:131] op_sel_hi:[1,0]
  v_pk_fma_f32 v[144:145], v[64:65], v[128:129], v[144:145] op_sel_hi:[1,0,1]
  v_pk_fma_f32 v[146:147], v[66:67], v[128:129], v[146:147] op_sel_hi:[1,0,1]
  v_pk_fma_f32 v[148:149], v[68:69], v[128:129], v[148:149] op_sel_hi:[1,0,1]
  v_pk_fma_f32 v[150:151], v[70:71], v[128:129], v[150:151] op_sel_hi:[1,0,1]
  v_pk_fma_f32 v[152:153], v[72:73], v[128:129], v[152:153] op_sel_hi:[1,0,1]
  v_pk_fma_f32 v[154:155], v[74:75], v[128:129], v[154:155] op_sel_hi:[1,0,1]
  v_pk_fma_f32 v[156:157], v[76:77], v[128:129], v[156:157] op_sel_hi:[1,0,1]
  v_pk_fma_f32 v[158:159], v[78:79], v[128:129], v[158:159] op_sel_hi:[1,0,1]
  v_cvt_pk_bf16_f32 v64, v144, v145
  v_cvt_pk_bf16_f32 v65, v146, v147
  v_cvt_pk_bf16_f32 v66, v148, v149
  v_cvt_pk_bf16_f32 v67, v150, v151
  v_cvt_pk_bf16_f32 v68, v152, v153
  v_cvt_pk_bf16_f32 v69, v154, v155
  v_cvt_pk_bf16_f32 v70, v156, v157
  v_cvt_pk_bf16_f32 v71, v158, v159
  v_add_u32 v133, 100352, v2
  ds_write_b128 v133, v[64:67]
  ds_write_b128 v133, v[68:71] offset:1024
  v_mul_f32 v142, 0x3eb8aa3b, v138
  v_mul_f32 v143, 0x3eb8aa3b, v139
  v_mov_b32 v128, v142
  v_mov_b32 v130, v143
  v_pk_mul_f32 v[96:97], v[192:193], v[130:131] op_sel_hi:[1,0]
  v_pk_mul_f32 v[98:99], v[194:195], v[130:131] op_sel_hi:[1,0]
  v_pk_mul_f32 v[100:101], v[196:197], v[130:131] op_sel_hi:[1,0]
  v_pk_mul_f32 v[102:103], v[198:199], v[130:131] op_sel_hi:[1,0]
  v_pk_mul_f32 v[104:105], v[200:201], v[130:131] op_sel_hi:[1,0]
  v_pk_mul_f32 v[106:107], v[202:203], v[130:131] op_sel_hi:[1,0]
  v_pk_mul_f32 v[108:109], v[204:205], v[130:131] op_sel_hi:[1,0]
  v_pk_mul_f32 v[110:111], v[206:207], v[130:131] op_sel_hi:[1,0]
  v_pk_fma_f32 v[96:97], v[80:81], v[128:129], v[96:97] op_sel_hi:[1,0,1]
  v_pk_fma_f32 v[98:99], v[82:83], v[128:129], v[98:99] op_sel_hi:[1,0,1]
  v_pk_fma_f32 v[100:101], v[84:85], v[128:129], v[100:101] op_sel_hi:[1,0,1]
  v_pk_fma_f32 v[102:103], v[86:87], v[128:129], v[102:103] op_sel_hi:[1,0,1]
  v_pk_fma_f32 v[104:105], v[88:89], v[128:129], v[104:105] op_sel_hi:[1,0,1]
  v_pk_fma_f32 v[106:107], v[90:91], v[128:129], v[106:107] op_sel_hi:[1,0,1]
  v_pk_fma_f32 v[108:109], v[92:93], v[128:129], v[108:109] op_sel_hi:[1,0,1]
  v_pk_fma_f32 v[110:111], v[94:95], v[128:129], v[110:111] op_sel_hi:[1,0,1]
  v_cvt_pk_bf16_f32 v80, v96, v97
  v_cvt_pk_bf16_f32 v81, v98, v99
  v_cvt_pk_bf16_f32 v82, v100, v101
  v_cvt_pk_bf16_f32 v83, v102, v103
  v_cvt_pk_bf16_f32 v84, v104, v105
  v_cvt_pk_bf16_f32 v85, v106, v107
  v_cvt_pk_bf16_f32 v86, v108, v109
  v_cvt_pk_bf16_f32 v87, v110, v111
  v_add_u32 v133, 104448, v2
  ds_write_b128 v133, v[80:83]
  ds_write_b128 v133, v[84:87] offset:1024
  s_branch G2GD_71
G2W1_68:
  ds_read_b128 v[96:99], v2 offset:0
  ds_read_b128 v[100:103], v2 offset:32768
  ds_read_b128 v[104:107], v2 offset:1024
  ds_read_b128 v[108:111], v2 offset:33792
  ds_read_b128 v[112:115], v2 offset:2048
  ds_read_b128 v[116:119], v2 offset:34816
  ds_read_b128 v[120:123], v2 offset:3072
  ds_read_b128 v[124:127], v2 offset:35840
  s_waitcnt lgkmcnt(6)
  v_mfma_f32_32x32x16_bf16 v[32:47], a[0:3], v[96:99], 0
  s_mul_i32 s41, s20, 8192
  s_lshl_b32 s42, s19, 15
  s_add_u32 s41, s41, s42
  s_add_u32 s41, s41, 16384
  s_mov_b32 m0, s41
  s_add_u32 s43, s88, s41
  buffer_load_dwordx4 v2, s[4:7], s43 offen offset:0 sc1 lds
  v_mfma_f32_32x32x16_bf16 v[48:63], a[0:3], v[100:103], 0
  ds_read_b128 v[96:99], v2 offset:4096
  ds_read_b128 v[100:103], v2 offset:36864
  s_waitcnt lgkmcnt(6)
  v_mfma_f32_32x32x16_bf16 v[32:47], a[4:7], v[104:107], v[32:47]
  buffer_load_dwordx4 v2, s[4:7], s43 offen offset:1024 sc1 lds
  v_mfma_f32_32x32x16_bf16 v[48:63], a[4:7], v[108:111], v[48:63]
  ds_read_b128 v[104:107], v2 offset:5120
  ds_read_b128 v[108:111], v2 offset:37888
  s_waitcnt lgkmcnt(6)
  v_mfma_f32_32x32x16_bf16 v[32:47], a[8:11], v[112:115], v[32:47]
  buffer_load_dwordx4 v2, s[4:7], s43 offen offset:2048 sc1 lds
  v_mfma_f32_32x32x16_bf16 v[48:63], a[8:11], v[116:119], v[48:63]
  s_waitcnt lgkmcnt(4)
  v_mfma_f32_32x32x16_bf16 v[32:47], a[12:15], v[120:123], v[32:47]
  buffer_load_dwordx4 v2, s[4:7], s43 offen offset:3072 sc1 lds
  v_mfma_f32_32x32x16_bf16 v[48:63], a[12:15], v[124:127], v[48:63]
  s_waitcnt lgkmcnt(2)
  v_mfma_f32_32x32x16_bf16 v[32:47], a[16:19], v[96:99], v[32:47]
  s_mul_i32 s41, s20, 8192
  s_lshl_b32 s42, s19, 15
  s_add_u32 s41, s41, s42
  s_add_u32 s41, s41, 20480
  s_mov_b32 m0, s41
  s_add_u32 s43, s88, s41
  buffer_load_dwordx4 v2, s[4:7], s43 offen offset:0 sc1 lds
  v_mfma_f32_32x32x16_bf16 v[48:63], a[16:19], v[100:103], v[48:63]
  s_waitcnt vmcnt(5)
  s_barrier
  ds_read_b128 v[112:115], v2 offset:6144
  ds_read_b128 v[116:119], v2 offset:38912
  ds_read_b128 v[120:123], v2 offset:7168
  ds_read_b128 v[124:127], v2 offset:39936
  ds_read_b128 v[96:99], v2 offset:8192
  ds_read_b128 v[100:103], v2 offset:40960
  s_waitcnt lgkmcnt(6)
  v_mfma_f32_32x32x16_bf16 v[32:47], a[20:23], v[104:107], v[32:47]
  buffer_load_dwordx4 v2, s[4:7], s43 offen offset:1024 sc1 lds
  v_mfma_f32_32x32x16_bf16 v[48:63], a[20:23], v[108:111], v[48:63]
  ds_read_b128 v[104:107], v2 offset:9216
  ds_read_b128 v[108:111], v2 offset:41984
  s_waitcnt lgkmcnt(6)
  v_mfma_f32_32x32x16_bf16 v[32:47], a[24:27], v[112:115], v[32:47]
  buffer_load_dwordx4 v2, s[4:7], s43 offen offset:2048 sc1 lds
  v_mfma_f32_32x32x16_bf16 v[48:63], a[24:27], v[116:119], v[48:63]
  ds_read_b128 v[112:115], v2 offset:10240
  ds_read_b128 v[116:119], v2 offset:43008
  s_waitcnt lgkmcnt(6)
  v_mfma_f32_32x32x16_bf16 v[32:47], a[28:31], v[120:123], v[32:47]
  buffer_load_dwordx4 v2, s[4:7], s43 offen offset:3072 sc1 lds
  v_mfma_f32_32x32x16_bf16 v[48:63], a[28:31], v[124:127], v[48:63]
  ds_read_b128 v[120:123], v2 offset:11264
  ds_read_b128 v[124:127], v2 offset:44032
  s_waitcnt lgkmcnt(6)
  v_mfma_f32_32x32x16_bf16 v[32:47], a[32:35], v[96:99], v[32:47]
  buffer_load_dwordx2 v[144:145], v20, s[4:7], s90 offen offset:0 sc1
  v_mfma_f32_32x32x16_bf16 v[48:63], a[32:35], v[100:103], v[48:63]
  buffer_load_dwordx2 v[146:147], v20, s[4:7], s90 offen offset:256 sc1
  ds_read_b128 v[96:99], v2 offset:12288
  ds_read_b128 v[100:103], v2 offset:45056
  s_waitcnt lgkmcnt(6)
  v_mfma_f32_32x32x16_bf16 v[32:47], a[36:39], v[104:107], v[32:47]
  buffer_load_dwordx2 v[148:149], v20, s[4:7], s90 offen offset:512 sc1
  v_mfma_f32_32x32x16_bf16 v[48:63], a[36:39], v[108:111], v[48:63]
  buffer_load_dwordx2 v[150:151], v20, s[4:7], s90 offen offset:768 sc1
  ds_read_b128 v[104:107], v2 offset:13312
  ds_read_b128 v[108:111], v2 offset:46080
  s_waitcnt lgkmcnt(6)
  v_mfma_f32_32x32x16_bf16 v[32:47], a[40:43], v[112:115], v[32:47]
  buffer_load_dwordx2 v[152:153], v20, s[4:7], s90 offen offset:1024 sc1
  v_mfma_f32_32x32x16_bf16 v[48:63], a[40:43], v[116:119], v[48:63]
  buffer_load_dwordx2 v[154:155], v20, s[4:7], s90 offen offset:1280 sc1
  ds_read_b128 v[112:115], v2 offset:14336
  ds_read_b128 v[116:119], v2 offset:47104
  s_waitcnt lgkmcnt(6)
  v_mfma_f32_32x32x16_bf16 v[32:47], a[44:47], v[120:123], v[32:47]
  buffer_load_dwordx2 v[156:157], v20, s[4:7], s90 offen offset:1536 sc1
  v_mfma_f32_32x32x16_bf16 v[48:63], a[44:47], v[124:127], v[48:63]
  buffer_load_dwordx2 v[158:159], v20, s[4:7], s90 offen offset:1792 sc1
  ds_read_b128 v[120:123], v2 offset:15360
  ds_read_b128 v[124:127], v2 offset:48128
  s_waitcnt lgkmcnt(6)
  v_mfma_f32_32x32x16_bf16 v[32:47], a[48:51], v[96:99], v[32:47]
  v_mfma_f32_32x32x16_bf16 v[48:63], a[48:51], v[100:103], v[48:63]
  s_waitcnt lgkmcnt(4)
  v_mfma_f32_32x32x16_bf16 v[32:47], a[52:55], v[104:107], v[32:47]
  v_mfma_f32_32x32x16_bf16 v[48:63], a[52:55], v[108:111], v[48:63]
  s_waitcnt lgkmcnt(2)
  v_mfma_f32_32x32x16_bf16 v[32:47], a[56:59], v[112:115], v[32:47]
  v_mfma_f32_32x32x16_bf16 v[48:63], a[56:59], v[116:119], v[48:63]
  s_waitcnt vmcnt(8)
  s_barrier
  ds_read_b128 v[96:99], v2 offset:16384
  ds_read_b128 v[100:103], v2 offset:49152
  ds_read_b128 v[104:107], v2 offset:17408
  ds_read_b128 v[108:111], v2 offset:50176
  ds_read_b128 v[112:115], v2 offset:18432
  ds_read_b128 v[116:119], v2 offset:51200
  s_waitcnt lgkmcnt(6)
  v_mfma_f32_32x32x16_bf16 v[32:47], a[60:63], v[120:123], v[32:47]
  s_lshl_b32 s41, s18, 13
  s_add_u32 s42, s89, s41
  s_add_u32 s41, s41, 65536
  s_mov_b32 m0, s41
  s_nop 0
  buffer_load_dwordx4 v2, s[4:7], s42 offen offset:0 sc1 lds
  v_mfma_f32_32x32x16_bf16 v[48:63], a[60:63], v[124:127], v[48:63]
  ds_read_b128 v[120:123], v2 offset:19456
  ds_read_b128 v[124:127], v2 offset:52224
  s_waitcnt lgkmcnt(6)
  v_mfma_f32_32x32x16_bf16 v[32:47], a[64:67], v[96:99], v[32:47]
  buffer_load_dwordx4 v2, s[4:7], s42 offen offset:1024 sc1 lds
  v_mfma_f32_32x32x16_bf16 v[48:63], a[64:67], v[100:103], v[48:63]
  ds_read_b128 v[96:99], v2 offset:20480
  ds_read_b128 v[100:103], v2 offset:53248
  s_waitcnt lgkmcnt(6)
  v_mfma_f32_32x32x16_bf16 v[32:47], a[68:71], v[104:107], v[32:47]
  buffer_load_dwordx4 v2, s[4:7], s42 offen offset:2048 sc1 lds
  v_mfma_f32_32x32x16_bf16 v[48:63], a[68:71], v[108:111], v[48:63]
  ds_read_b128 v[104:107], v2 offset:21504
  ds_read_b128 v[108:111], v2 offset:54272
  s_waitcnt lgkmcnt(6)
  v_mfma_f32_32x32x16_bf16 v[32:47], a[72:75], v[112:115], v[32:47]
  buffer_load_dwordx4 v2, s[4:7], s42 offen offset:3072 sc1 lds
  v_mfma_f32_32x32x16_bf16 v[48:63], a[72:75], v[116:119], v[48:63]
  ds_read_b128 v[112:115], v2 offset:22528
  ds_read_b128 v[116:119], v2 offset:55296
  s_waitcnt lgkmcnt(6)
  v_mfma_f32_32x32x16_bf16 v[32:47], a[76:79], v[120:123], v[32:47]
  s_lshl_b32 s41, s18, 13
  s_add_u32 s41, s41, 4096
  s_add_u32 s42, s89, s41
  s_add_u32 s41, s41, 65536
  s_mov_b32 m0, s41
  s_nop 0
  buffer_load_dwordx4 v2, s[4:7], s42 offen offset:0 sc1 lds
  v_mfma_f32_32x32x16_bf16 v[48:63], a[76:79], v[124:127], v[48:63]
  ds_read_b128 v[120:123], v2 offset:23552
  ds_read_b128 v[124:127], v2 offset:56320
  s_waitcnt lgkmcnt(6)
  v_mfma_f32_32x32x16_bf16 v[32:47], a[80:83], v[96:99], v[32:47]
  buffer_load_dwordx4 v2, s[4:7], s42 offen offset:1024 sc1 lds
  v_mfma_f32_32x32x16_bf16 v[48:63], a[80:83], v[100:103], v[48:63]
  ds_read_b128 v[96:99], v2 offset:24576
  ds_read_b128 v[100:103], v2 offset:57344
  s_waitcnt lgkmcnt(6)
  v_mfma_f32_32x32x16_bf16 v[32:47], a[84:87], v[104:107], v[32:47]
  buffer_load_dwordx4 v2, s[4:7], s42 offen offset:2048 sc1 lds
  v_mfma_f32_32x32x16_bf16 v[48:63], a[84:87], v[108:111], v[48:63]
  ds_read_b128 v[104:107], v2 offset:25600
  ds_read_b128 v[108:111], v2 offset:58368
  s_waitcnt lgkmcnt(6)
  v_mfma_f32_32x32x16_bf16 v[32:47], a[88:91], v[112:115], v[32:47]
  buffer_load_dwordx4 v2, s[4:7], s42 offen offset:3072 sc1 lds
  v_mfma_f32_32x32x16_bf16 v[48:63], a[88:91], v[116:119], v[48:63]
  ds_read_b128 v[112:115], v2 offset:26624
  ds_read_b128 v[116:119], v2 offset:59392
  s_waitcnt lgkmcnt(6)
  v_mfma_f32_32x32x16_bf16 v[32:47], a[92:95], v[120:123], v[32:47]
  s_add_u32 s47, s60, 8192
  buffer_load_dwordx4 a[168:171], v2, s[4:7], s47 offen offset:2048 sc1
  s_waitcnt vmcnt(9)
  v_add_f32 v144, v144, v146
  v_add_f32 v145, v145, v147
  v_add_f32 v144, v144, v148
  v_mfma_f32_32x32x16_bf16 v[48:63], a[92:95], v[124:127], v[48:63]
  v_add_f32 v145, v145, v149
  v_add_f32 v144, v144, v150
  v_add_f32 v145, v145, v151
  ds_read_b128 v[120:123], v2 offset:27648
  ds_read_b128 v[124:127], v2 offset:60416
  s_waitcnt lgkmcnt(6)
  v_mfma_f32_32x32x16_bf16 v[32:47], a[96:99], v[96:99], v[32:47]
  s_add_u32 s47, s60, 8192
  buffer_load_dwordx4 a[172:175], v2, s[4:7], s47 offen offset:3072 sc1
  v_add_f32 v144, v144, v152
  v_add_f32 v145, v145, v153
  v_add_f32 v144, v144, v154
  v_mfma_f32_32x32x16_bf16 v[48:63], a[96:99], v[100:103], v[48:63]
  v_add_f32 v145, v145, v155
  v_add_f32 v144, v144, v156
  v_add_f32 v145, v145, v157
  ds_read_b128 v[96:99], v2 offset:28672
  ds_read_b128 v[100:103], v2 offset:61440
  s_waitcnt lgkmcnt(6)
  v_mfma_f32_32x32x16_bf16 v[32:47], a[100:103], v[104:107], v[32:47]
  s_add_u32 s47, s60, 12288
  buffer_load_dwordx4 a[176:179], v2, s[4:7], s47 offen offset:0 sc1
  v_add_f32 v144, v144, v158
  v_add_f32 v145, v145, v159
  s_nop 1
  v_permlane32_swap_b32 v144, v145
  v_mfma_f32_32x32x16_bf16 v[48:63], a[100:103], v[108:111], v[48:63]
  v_add_f32 v144, v144, v145
  v_mov_b32 v145, v144
  s_nop 1
  v_permlane32_swap_b32 v144, v145
  ds_read_b128 v[104:107], v2 offset:29696
  ds_read_b128 v[108:111], v2 offset:62464
  s_waitcnt lgkmcnt(6)
  v_mfma_f32_32x32x16_bf16 v[32:47], a[104:107], v[112:115], v[32:47]
  s_add_u32 s47, s60, 12288
  buffer_load_dwordx4 a[180:183], v2, s[4:7], s47 offen offset:1024 sc1
  v_mul_f32 v130, 0x3b000000, v144
  v_mul_f32 v145, 0x3b000000, v145
  v_fma_f32 v145, -v130, v130, v145
  v_mfma_f32_32x32x16_bf16 v[48:63], a[104:107], v[116:119], v[48:63]
  v_add_f32 v145, 0x3727c5ac, v145
  v_rsq_f32 v131, v145
  s_nop 0
  v_mul_f32 v130, v130, v131
  ds_read_b128 v[112:115], v2 offset:30720
  ds_read_b128 v[116:119], v2 offset:63488
  s_waitcnt lgkmcnt(6)
  v_mfma_f32_32x32x16_bf16 v[32:47], a[108:111], v[120:123], v[32:47]
  s_add_u32 s47, s60, 12288
  buffer_load_dwordx4 a[184:187], v2, s[4:7], s47 offen offset:2048 sc1
  v_sub_f32 v130, 0, v130
  v_cmp_gt_u32 vcc, 32, v1
  s_nop 1
  v_mfma_f32_32x32x16_bf16 v[48:63], a[108:111], v[124:127], v[48:63]
  v_cndmask_b32 v130, v130, v131, vcc
  v_add_u32 v131, 131328, v3
  ds_write_b32 v131, v130
  ds_read_b128 v[120:123], v2 offset:31744
  ds_read_b128 v[124:127], v2 offset:64512
  s_waitcnt lgkmcnt(7)
  v_mfma_f32_32x32x16_bf16 v[32:47], a[112:115], v[96:99], v[32:47]
  s_add_u32 s47, s60, 12288
  buffer_load_dwordx4 a[188:191], v2, s[4:7], s47 offen offset:3072 sc1
  v_mfma_f32_32x32x16_bf16 v[48:63], a[112:115], v[100:103], v[48:63]
  s_waitcnt lgkmcnt(5)
  v_mfma_f32_32x32x16_bf16 v[32:47], a[116:119], v[104:107], v[32:47]
  s_add_u32 s47, s60, 16384
  buffer_load_dwordx4 a[192:195], v2, s[4:7], s47 offen offset:0 sc1
  v_mfma_f32_32x32x16_bf16 v[48:63], a[116:119], v[108:111], v[48:63]
  s_waitcnt lgkmcnt(3)
  v_mfma_f32_32x32x16_bf16 v[32:47], a[120:123], v[112:115], v[32:47]
  s_add_u32 s47, s60, 16384
  buffer_load_dwordx4 a[196:199], v2, s[4:7], s47 offen offset:1024 sc1
  v_mfma_f32_32x32x16_bf16 v[48:63], a[120:123], v[116:119], v[48:63]
  s_waitcnt vmcnt(8)
  s_waitcnt lgkmcnt(0)
  s_barrier
  ds_read_b32 v136, v134 offset:0
  ds_read_b32 v137, v134 offset:128
  ds_read_b32 v138, v134 offset:256
  ds_read_b32 v139, v134 offset:384
  ds_read_b128 v[96:99], v21 offset:0
  ds_read_b128 v[104:107], v21 offset:1024
  ds_read_b128 v[112:115], v21 offset:2048
  v_mfma_f32_32x32x16_bf16 v[32:47], a[124:127], v[120:123], v[32:47]
  s_add_u32 s47, s60, 16384
  buffer_load_dwordx4 a[200:203], v2, s[4:7], s47 offen offset:2048 sc1
  v_mfma_f32_32x32x16_bf16 v[48:63], a[124:127], v[124:127], v[48:63]
  ds_read_b128 v[120:123], v21 offset:3072
  s_waitcnt lgkmcnt(3)
  v_mfma_f32_32x32x16_bf16 v[64:79], a[0:3], v[96:99], 0
  s_add_u32 s47, s60, 16384
  buffer_load_dwordx4 a[204:207], v2, s[4:7], s47 offen offset:3072 sc1
  v_mfma_f32_32x32x16_bf16 v[80:95], a[128:131], v[96:99], 0
  buffer_load_dwordx2 v[160:161], v22, s[4:7], s92 offen offset:0 sc1
  ds_read_b128 v[96:99], v21 offset:4096
  s_waitcnt lgkmcnt(3)
  v_mfma_f32_32x32x16_bf16 v[64:79], a[4:7], v[104:107], v[64:79]
  s_add_u32 s47, s60, 20480
  buffer_load_dwordx4 a[208:211], v2, s[4:7], s47 offen offset:0 sc1
  v_mfma_f32_32x32x16_bf16 v[80:95], a[132:135], v[104:107], v[80:95]
  buffer_load_dwordx2 v[162:163], v22, s[4:7], s92 offen offset:256 sc1
  v_mul_f32 v144, v137, v176
  v_fmac_f32 v144, v32, v136
  v_mul_f32 v145, v137, v177
  ds_read_b128 v[104:107], v21 offset:5120
  s_waitcnt lgkmcnt(3)
  v_mfma_f32_32x32x16_bf16 v[64:79], a[8:11], v[112:115], v[64:79]
  s_add_u32 s47, s60, 20480
  buffer_load_dwordx4 a[212:215], v2, s[4:7], s47 offen offset:1024 sc1
  v_fmac_f32 v145, v33, v136
  v_mul_f32 v146, v137, v178
  v_fmac_f32 v146, v34, v136
  v_mfma_f32_32x32x16_bf16 v[80:95], a[136:139], v[112:115], v[80:95]
  buffer_load_dwordx2 v[164:165], v22, s[4:7], s92 offen offset:512 sc1
  v_mul_f32 v147, v137, v179
  v_fmac_f32 v147, v35, v136
  v_mul_f32 v148, v137, v180
  ds_read_b128 v[112:115], v21 offset:6144
  s_waitcnt lgkmcnt(3)
  v_mfma_f32_32x32x16_bf16 v[64:79], a[12:15], v[120:123], v[64:79]
  s_add_u32 s47, s60, 20480
  buffer_load_dwordx4 a[216:219], v2, s[4:7], s47 offen offset:2048 sc1
  v_fmac_f32 v148, v36, v136
  v_mul_f32 v149, v137, v181
  v_fmac_f32 v149, v37, v136
  v_mfma_f32_32x32x16_bf16 v[80:95], a[140:143], v[120:123], v[80:95]
  buffer_load_dwordx2 v[166:167], v22, s[4:7], s92 offen offset:768 sc1
  v_mul_f32 v150, v137, v182
  v_fmac_f32 v150, v38, v136
  v_mul_f32 v151, v137, v183
  ds_read_b128 v[120:123], v21 offset:7168
  s_waitcnt lgkmcnt(3)
  v_mfma_f32_32x32x16_bf16 v[64:79], a[16:19], v[96:99], v[64:79]
  s_add_u32 s47, s60, 20480
  buffer_load_dwordx4 a[220:223], v2, s[4:7], s47 offen offset:3072 sc1
  v_fmac_f32 v151, v39, v136
  v_mul_f32 v152, v137, v184
  v_fmac_f32 v152, v40, v136
  v_mfma_f32_32x32x16_bf16 v[80:95], a[144:147], v[96:99], v[80:95]
  buffer_load_dwordx2 v[168:169], v22, s[4:7], s92 offen offset:1024 sc1
  v_mul_f32 v153, v137, v185
  v_fmac_f32 v153, v41, v136
  v_mul_f32 v154, v137, v186
  ds_read_b128 v[96:99], v21 offset:8192
  s_waitcnt lgkmcnt(3)
  v_mfma_f32_32x32x16_bf16 v[64:79], a[20:23], v[104:107], v[64:79]
  s_add_u32 s47, s60, 24576
  buffer_load_dwordx4 a[224:227], v2, s[4:7], s47 offen offset:0 sc1
  v_fmac_f32 v154, v42, v136
  v_mul_f32 v155, v137, v187
  v_fmac_f32 v155, v43, v136
  v_mfma_f32_32x32x16_bf16 v[80:95], a[148:151], v[104:107], v[80:95]
  buffer_load_dwordx2 v[170:171], v22, s[4:7], s92 offen offset:1280 sc1
  v_mul_f32 v156, v137, v188
  v_fmac_f32 v156, v44, v136
  v_mul_f32 v157, v137, v189
  ds_read_b128 v[104:107], v21 offset:9216
  s_waitcnt lgkmcnt(3)
  v_mfma_f32_32x32x16_bf16 v[64:79], a[24:27], v[112:115], v[64:79]
  s_add_u32 s47, s60, 24576
  buffer_load_dwordx4 a[228:231], v2, s[4:7], s47 offen offset:1024 sc1
  v_fmac_f32 v157, v45, v136
  v_mul_f32 v158, v137, v190
  v_fmac_f32 v158, v46, v136
  v_mfma_f32_32x32x16_bf16 v[80:95], a[152:155], v[112:115], v[80:95]
  buffer_load_dwordx2 v[172:173], v22, s[4:7], s92 offen offset:1536 sc1
  v_mul_f32 v159, v137, v191
  v_fmac_f32 v159, v47, v136
  v_cvt_pk_bf16_f32 v32, v144, v145
  ds_read_b128 v[112:115], v21 offset:10240
  s_waitcnt lgkmcnt(3)
  v_mfma_f32_32x32x16_bf16 v[64:79], a[28:31], v[120:123], v[64:79]
  s_add_u32 s47, s60, 24576
  buffer_load_dwordx4 a[232:235], v2, s[4:7], s47 offen offset:2048 sc1
  v_cvt_pk_bf16_f32 v33, v146, v147
  v_cvt_pk_bf16_f32 v34, v148, v149
  v_cvt_pk_bf16_f32 v35, v150, v151
  v_mfma_f32_32x32x16_bf16 v[80:95], a[156:159], v[120:123], v[80:95]
  buffer_load_dwordx2 v[174:175], v22, s[4:7], s92 offen offset:1792 sc1
  v_cvt_pk_bf16_f32 v36, v152, v153
  v_cvt_pk_bf16_f32 v37, v154, v155
  v_cvt_pk_bf16_f32 v38, v156, v157
  ds_read_b128 v[120:123], v21 offset:11264
  s_waitcnt lgkmcnt(3)
  v_mfma_f32_32x32x16_bf16 v[64:79], a[32:35], v[96:99], v[64:79]
  s_add_u32 s47, s60, 24576
  buffer_load_dwordx4 a[236:239], v2, s[4:7], s47 offen offset:3072 sc1
  v_cvt_pk_bf16_f32 v39, v158, v159
  v_add_u32 v133, 106496, v2
  ds_write_b128 v133, v[32:35]
  v_mfma_f32_32x32x16_bf16 v[80:95], a[160:163], v[96:99], v[80:95]
  ds_write_b128 v133, v[36:39] offset:1024
  v_mul_f32 v144, v139, v176
  v_fmac_f32 v144, v48, v138
  ds_read_b128 v[96:99], v21 offset:12288
  s_waitcnt lgkmcnt(5)
  v_mfma_f32_32x32x16_bf16 v[64:79], a[36:39], v[104:107], v[64:79]
  s_add_u32 s47, s60, 28672
  buffer_load_dwordx4 a[240:243], v2, s[4:7], s47 offen offset:0 sc1
  v_mul_f32 v145, v139, v177
  v_fmac_f32 v145, v49, v138
  v_mul_f32 v146, v139, v178
  v_mfma_f32_32x32x16_bf16 v[80:95], a[164:167], v[104:107], v[80:95]
  v_fmac_f32 v146, v50, v138
  v_mul_f32 v147, v139, v179
  v_fmac_f32 v147, v51, v138
  ds_read_b128 v[104:107], v21 offset:13312
  s_waitcnt lgkmcnt(5)
  v_mfma_f32_32x32x16_bf16 v[64:79], a[40:43], v[112:115], v[64:79]
  s_add_u32 s47, s60, 28672
  buffer_load_dwordx4 a[244:247], v2, s[4:7], s47 offen offset:1024 sc1
  v_mul_f32 v148, v139, v180
  v_fmac_f32 v148, v52, v138
  v_mul_f32 v149, v139, v181
  s_waitcnt vmcnt(27)
  v_mfma_f32_32x32x16_bf16 v[80:95], a[168:171], v[112:115], v[80:95]
  v_fmac_f32 v149, v53, v138
  v_mul_f32 v150, v139, v182
  v_fmac_f32 v150, v54, v138
  ds_read_b128 v[112:115], v21 offset:14336
  s_waitcnt lgkmcnt(5)
  v_mfma_f32_32x32x16_bf16 v[64:79], a[44:47], v[120:123], v[64:79]
  s_add_u32 s47, s60, 28672
  buffer_load_dwordx4 a[248:251], v2, s[4:7], s47 offen offset:2048 sc1
  v_mul_f32 v151, v139, v183
  v_fmac_f32 v151, v55, v138
  v_mul_f32 v152, v139, v184
  s_waitcnt vmcnt(27)
  v_mfma_f32_32x32x16_bf16 v[80:95], a[172:175], v[120:123], v[80:95]
  v_fmac_f32 v152, v56, v138
  v_mul_f32 v153, v139, v185
  v_fmac_f32 v153, v57, v138
  ds_read_b128 v[120:123], v21 offset:15360
  s_waitcnt lgkmcnt(3)
  v_mfma_f32_32x32x16_bf16 v[64:79], a[48:51], v[96:99], v[64:79]
  s_add_u32 s47, s60, 28672
  buffer_load_dwordx4 a[252:255], v2, s[4:7], s47 offen offset:3072 sc1
  v_mul_f32 v154, v139, v186
  v_fmac_f32 v154, v58, v138
  v_mul_f32 v155, v139, v187
  s_waitcnt vmcnt(27)
  v_mfma_f32_32x32x16_bf16 v[80:95], a[176:179], v[96:99], v[80:95]
  v_fmac_f32 v155, v59, v138
  v_mul_f32 v156, v139, v188
  v_fmac_f32 v156, v60, v138
  ds_read_b128 v[96:99], v21 offset:16384
  s_waitcnt lgkmcnt(3)
  v_mfma_f32_32x32x16_bf16 v[64:79], a[52:55], v[104:107], v[64:79]
  v_mul_f32 v157, v139, v189
  v_fmac_f32 v157, v61, v138
  v_mul_f32 v158, v139, v190
  s_waitcnt vmcnt(26)
  v_mfma_f32_32x32x16_bf16 v[80:95], a[180:183], v[104:107], v[80:95]
  v_fmac_f32 v158, v62, v138
  v_mul_f32 v159, v139, v191
  v_fmac_f32 v159, v63, v138
  ds_read_b128 v[104:107], v21 offset:17408
  s_waitcnt lgkmcnt(3)
  v_mfma_f32_32x32x16_bf16 v[64:79], a[56:59], v[112:115], v[64:79]
  v_cvt_pk_bf16_f32 v48, v144, v145
  v_cvt_pk_bf16_f32 v49, v146, v147
  v_cvt_pk_bf16_f32 v50, v148, v149
  s_waitcnt vmcnt(25)
  v_mfma_f32_32x32x16_bf16 v[80:95], a[184:187], v[112:115], v[80:95]
  v_cvt_pk_bf16_f32 v51, v150, v151
  v_cvt_pk_bf16_f32 v52, v152, v153
  v_cvt_pk_bf16_f32 v53, v154, v155
  ds_read_b128 v[112:115], v21 offset:18432
  s_waitcnt lgkmcnt(3)
  v_mfma_f32_32x32x16_bf16 v[64:79], a[60:63], v[120:123], v[64:79]
  v_cvt_pk_bf16_f32 v54, v156, v157
  v_cvt_pk_bf16_f32 v55, v158, v159
  v_add_u32 v133, 110592, v2
  s_waitcnt vmcnt(24)
  v_mfma_f32_32x32x16_bf16 v[80:95], a[188:191], v[120:123], v[80:95]
  ds_write_b128 v133, v[48:51]
  ds_write_b128 v133, v[52:55] offset:1024
  s_waitcnt vmcnt(5)
  v_add_f32 v160, v160, v162
  v_add_f32 v161, v161, v163
  v_add_f32 v160, v160, v164
  ds_read_b128 v[120:123], v21 offset:19456
  s_waitcnt lgkmcnt(5)
  v_mfma_f32_32x32x16_bf16 v[64:79], a[64:67], v[96:99], v[64:79]
  v_add_f32 v161, v161, v165
  v_add_f32 v160, v160, v166
  v_add_f32 v161, v161, v167
  v_mfma_f32_32x32x16_bf16 v[80:95], a[192:195], v[96:99], v[80:95]
  v_add_f32 v160, v160, v168
  v_add_f32 v161, v161, v169
  v_add_f32 v160, v160, v170
  ds_read_b128 v[96:99], v21 offset:20480
  s_waitcnt lgkmcnt(5)
  v_mfma_f32_32x32x16_bf16 v[64:79], a[68:71], v[104:107], v[64:79]
  v_add_f32 v161, v161, v171
  v_add_f32 v160, v160, v172
  v_add_f32 v161, v161, v173
  v_mfma_f32_32x32x16_bf16 v[80:95], a[196:199], v[104:107], v[80:95]
  v_add_f32 v160, v160, v174
  v_add_f32 v161, v161, v175
  s_nop 1
  v_permlane32_swap_b32 v160, v161
  ds_read_b128 v[104:107], v21 offset:21504
  s_waitcnt lgkmcnt(5)
  v_mfma_f32_32x32x16_bf16 v[64:79], a[72:75], v[112:115], v[64:79]
  v_add_f32 v160, v160, v161
  v_mov_b32 v161, v160
  s_nop 1
  v_permlane32_swap_b32 v160, v161
  v_mfma_f32_32x32x16_bf16 v[80:95], a[200:203], v[112:115], v[80:95]
  v_mul_f32 v130, 0x3b000000, v160
  v_mul_f32 v161, 0x3b000000, v161
  v_fma_f32 v161, -v130, v130, v161
  ds_read_b128 v[112:115], v21 offset:22528
  s_waitcnt lgkmcnt(3)
  v_mfma_f32_32x32x16_bf16 v[64:79], a[76:79], v[120:123], v[64:79]
  v_add_f32 v161, 0x3727c5ac, v161
  v_rsq_f32 v131, v161
  s_nop 0
  v_mul_f32 v130, v130, v131
  v_mfma_f32_32x32x16_bf16 v[80:95], a[204:207], v[120:123], v[80:95]
  v_sub_f32 v130, 0, v130
  v_mov_b32 v140, v131
  v_mov_b32 v141, v130
  ds_read_b128 v[120:123], v21 offset:23552
  s_waitcnt lgkmcnt(3)
  v_mfma_f32_32x32x16_bf16 v[64:79], a[80:83], v[96:99], v[64:79]
  v_mfma_f32_32x32x16_bf16 v[80:95], a[208:211], v[96:99], v[80:95]
  ds_read_b128 v[96:99], v21 offset:24576
  s_waitcnt lgkmcnt(3)
  v_mfma_f32_32x32x16_bf16 v[64:79], a[84:87], v[104:107], v[64:79]
  v_mfma_f32_32x32x16_bf16 v[80:95], a[212:215], v[104:107], v[80:95]
  ds_read_b128 v[104:107], v21 offset:25600
  s_waitcnt lgkmcnt(3)
  v_mfma_f32_32x32x16_bf16 v[64:79], a[88:91], v[112:115], v[64:79]
  v_mfma_f32_32x32x16_bf16 v[80:95], a[216:219], v[112:115], v[80:95]
  ds_read_b128 v[112:115], v21 offset:26624
  s_waitcnt lgkmcnt(3)
  v_mfma_f32_32x32x16_bf16 v[64:79], a[92:95], v[120:123], v[64:79]
  v_mfma_f32_32x32x16_bf16 v[80:95], a[220:223], v[120:123], v[80:95]
  ds_read_b128 v[120:123], v21 offset:27648
  s_waitcnt lgkmcnt(3)
  v_mfma_f32_32x32x16_bf16 v[64:79], a[96:99], v[96:99], v[64:79]
  v_mfma_f32_32x32x16_bf16 v[80:95], a[224:227], v[96:99], v[80:95]
  ds_read_b128 v[96:99], v21 offset:28672
  s_waitcnt lgkmcnt(3)
  v_mfma_f32_32x32x16_bf16 v[64:79], a[100:103], v[104:107], v[64:79]
  v_mfma_f32_32x32x16_bf16 v[80:95], a[228:231], v[104:107], v[80:95]
  ds_read_b128 v[104:107], v21 offset:29696
  s_waitcnt lgkmcnt(3)
  v_mfma_f32_32x32x16_bf16 v[64:79], a[104:107], v[112:115], v[64:79]
  v_mfma_f32_32x32x16_bf16 v[80:95], a[232:235], v[112:115], v[80:95]
  ds_read_b128 v[112:115], v21 offset:30720
  s_waitcnt lgkmcnt(3)
  v_mfma_f32_32x32x16_bf16 v[64:79], a[108:111], v[120:123], v[64:79]
  s_waitcnt vmcnt(4)
  v_mfma_f32_32x32x16_bf16 v[80:95], a[236:239], v[120:123], v[80:95]
  ds_read_b128 v[120:123], v21 offset:31744
  s_waitcnt lgkmcnt(3)
  v_mfma_f32_32x32x16_bf16 v[64:79], a[112:115], v[96:99], v[64:79]
  s_waitcnt vmcnt(3)
  v_mfma_f32_32x32x16_bf16 v[80:95], a[240:243], v[96:99], v[80:95]
  s_waitcnt lgkmcnt(2)
  v_mfma_f32_32x32x16_bf16 v[64:79], a[116:119], v[104:107], v[64:79]
  s_waitcnt vmcnt(2)
  v_mfma_f32_32x32x16_bf16 v[80:95], a[244:247], v[104:107], v[80:95]
  s_waitcnt lgkmcnt(1)
  v_mfma_f32_32x32x16_bf16 v[64:79], a[120:123], v[112:115], v[64:79]
  s_waitcnt vmcnt(1)
  v_mfma_f32_32x32x16_bf16 v[80:95], a[248:251], v[112:115], v[80:95]
  s_waitcnt lgkmcnt(0)
  v_mfma_f32_32x32x16_bf16 v[64:79], a[124:127], v[120:123], v[64:79]
  s_waitcnt vmcnt(0)
  v_mfma_f32_32x32x16_bf16 v[80:95], a[252:255], v[120:123], v[80:95]
  v_mov_b32 v128, v140
  v_mov_b32 v130, v141
  v_pk_mul_f32 v[144:145], v[176:177], v[130:131] op_sel_hi:[1,0]
  v_pk_mul_f32 v[146:147], v[178:179], v[130:131] op_sel_hi:[1,0]
  v_pk_mul_f32 v[148:149], v[180:181], v[130:131] op_sel_hi:[1,0]
  v_pk_mul_f32 v[150:151], v[182:183], v[130:131] op_sel_hi:[1,0]
  v_pk_mul_f32 v[152:153], v[184:185], v[130:131] op_sel_hi:[1,0]
  v_pk_mul_f32 v[154:155], v[186:187], v[130:131] op_sel_hi:[1,0]
  v_pk_mul_f32 v[156:157], v[188:189], v[130:131] op_sel_hi:[1,0]
  v_pk_mul_f32 v[158:159], v[190:191], v[130:131] op_sel_hi:[1,0]
  v_pk_fma_f32 v[144:145], v[64:65], v[128:129], v[144:145] op_sel_hi:[1,0,1]
  v_pk_fma_f32 v[146:147], v[66:67], v[128:129], v[146:147] op_sel_hi:[1,0,1]
  v_pk_fma_f32 v[148:149], v[68:69], v[128:129], v[148:149] op_sel_hi:[1,0,1]
  v_pk_fma_f32 v[150:151], v[70:71], v[128:129], v[150:151] op_sel_hi:[1,0,1]
  v_pk_fma_f32 v[152:153], v[72:73], v[128:129], v[152:153] op_sel_hi:[1,0,1]
  v_pk_fma_f32 v[154:155], v[74:75], v[128:129], v[154:155] op_sel_hi:[1,0,1]
  v_pk_fma_f32 v[156:157], v[76:77], v[128:129], v[156:157] op_sel_hi:[1,0,1]
  v_pk_fma_f32 v[158:159], v[78:79], v[128:129], v[158:159] op_sel_hi:[1,0,1]
  v_cvt_pk_bf16_f32 v64, v144, v145
  v_cvt_pk_bf16_f32 v65, v146, v147
  v_cvt_pk_bf16_f32 v66, v148, v149
  v_cvt_pk_bf16_f32 v67, v150, v151
  v_cvt_pk_bf16_f32 v68, v152, v153
  v_cvt_pk_bf16_f32 v69, v154, v155
  v_cvt_pk_bf16_f32 v70, v156, v157
  v_cvt_pk_bf16_f32 v71, v158, v159
  v_add_u32 v133, 114688, v2
  ds_write_b128 v133, v[64:67]
  ds_write_b128 v133, v[68:71] offset:1024
  v_mov_b32 v128, v140
  v_mov_b32 v130, v141
  v_pk_mul_f32 v[96:97], v[192:193], v[130:131] op_sel_hi:[1,0]
  v_pk_mul_f32 v[98:99], v[194:195], v[130:131] op_sel_hi:[1,0]
  v_pk_mul_f32 v[100:101], v[196:197], v[130:131] op_sel_hi:[1,0]
  v_pk_mul_f32 v[102:103], v[198:199], v[130:131] op_sel_hi:[1,0]
  v_pk_mul_f32 v[104:105], v[200:201], v[130:131] op_sel_hi:[1,0]
  v_pk_mul_f32 v[106:107], v[202:203], v[130:131] op_sel_hi:[1,0]
  v_pk_mul_f32 v[108:109], v[204:205], v[130:131] op_sel_hi:[1,0]
  v_pk_mul_f32 v[110:111], v[206:207], v[130:131] op_sel_hi:[1,0]
  v_pk_fma_f32 v[96:97], v[80:81], v[128:129], v[96:97] op_sel_hi:[1,0,1]
  v_pk_fma_f32 v[98:99], v[82:83], v[128:129], v[98:99] op_sel_hi:[1,0,1]
  v_pk_fma_f32 v[100:101], v[84:85], v[128:129], v[100:101] op_sel_hi:[1,0,1]
  v_pk_fma_f32 v[102:103], v[86:87], v[128:129], v[102:103] op_sel_hi:[1,0,1]
  v_pk_fma_f32 v[104:105], v[88:89], v[128:129], v[104:105] op_sel_hi:[1,0,1]
  v_pk_fma_f32 v[106:107], v[90:91], v[128:129], v[106:107] op_sel_hi:[1,0,1]
  v_pk_fma_f32 v[108:109], v[92:93], v[128:129], v[108:109] op_sel_hi:[1,0,1]
  v_pk_fma_f32 v[110:111], v[94:95], v[128:129], v[110:111] op_sel_hi:[1,0,1]
  v_cvt_pk_bf16_f32 v80, v96, v97
  v_cvt_pk_bf16_f32 v81, v98, v99
  v_cvt_pk_bf16_f32 v82, v100, v101
  v_cvt_pk_bf16_f32 v83, v102, v103
  v_cvt_pk_bf16_f32 v84, v104, v105
  v_cvt_pk_bf16_f32 v85, v106, v107
  v_cvt_pk_bf16_f32 v86, v108, v109
  v_cvt_pk_bf16_f32 v87, v110, v111
  v_add_u32 v133, 116736, v2
  ds_write_b128 v133, v[80:83]
  ds_write_b128 v133, v[84:87] offset:1024
  s_branch G2GD_71
G2W2_69:
  ds_read_b128 v[96:99], v2 offset:0
  ds_read_b128 v[100:103], v2 offset:32768
  ds_read_b128 v[104:107], v2 offset:1024
  ds_read_b128 v[108:111], v2 offset:33792
  ds_read_b128 v[112:115], v2 offset:2048
  ds_read_b128 v[116:119], v2 offset:34816
  ds_read_b128 v[120:123], v2 offset:3072
  ds_read_b128 v[124:127], v2 offset:35840
  s_waitcnt lgkmcnt(6)
  v_mfma_f32_32x32x16_bf16 v[32:47], a[0:3], v[96:99], 0
  s_mul_i32 s41, s20, 8192
  s_lshl_b32 s42, s19, 15
  s_add_u32 s41, s41, s42
  s_add_u32 s41, s41, 16384
  s_mov_b32 m0, s41
  s_add_u32 s43, s88, s41
  buffer_load_dwordx4 v2, s[4:7], s43 offen offset:0 sc1 lds
  v_mfma_f32_32x32x16_bf16 v[48:63], a[0:3], v[100:103], 0
  v_mfma_f32_32x32x16_bf16 v[64:79], v[96:99], a[128:131], 0
  buffer_load_dwordx4 v2, s[4:7], s43 offen offset:1024 sc1 lds
  v_mfma_f32_32x32x16_bf16 v[80:95], v[100:103], a[128:131], 0
  ds_read_b128 v[96:99], v2 offset:4096
  ds_read_b128 v[100:103], v2 offset:36864
  s_waitcnt lgkmcnt(6)
  v_mfma_f32_32x32x16_bf16 v[32:47], a[4:7], v[104:107], v[32:47]
  buffer_load_dwordx4 v2, s[4:7], s43 offen offset:2048 sc1 lds
  v_mfma_f32_32x32x16_bf16 v[48:63], a[4:7], v[108:111], v[48:63]
  v_mfma_f32_32x32x16_bf16 v[64:79], v[104:107], a[132:135], v[64:79]
  buffer_load_dwordx4 v2, s[4:7], s43 offen offset:3072 sc1 lds
  v_mfma_f32_32x32x16_bf16 v[80:95], v[108:111], a[132:135], v[80:95]
  ds_read_b128 v[104:107], v2 offset:5120
  ds_read_b128 v[108:111], v2 offset:37888
  s_waitcnt lgkmcnt(6)
  v_mfma_f32_32x32x16_bf16 v[32:47], a[8:11], v[112:115], v[32:47]
  s_mul_i32 s41, s20, 8192
  s_lshl_b32 s42, s19, 15
  s_add_u32 s41, s41, s42
  s_add_u32 s41, s41, 20480
  s_mov_b32 m0, s41
  s_add_u32 s43, s88, s41
  buffer_load_dwordx4 v2, s[4:7], s43 offen offset:0 sc1 lds
  v_mfma_f32_32x32x16_bf16 v[48:63], a[8:11], v[116:119], v[48:63]
  s_waitcnt vmcnt(5)
  s_barrier
  v_mfma_f32_32x32x16_bf16 v[64:79], v[112:115], a[136:139], v[64:79]
  buffer_load_dwordx4 v2, s[4:7], s43 offen offset:1024 sc1 lds
  v_mfma_f32_32x32x16_bf16 v[80:95], v[116:119], a[136:139], v[80:95]
  ds_read_b128 v[112:115], v2 offset:6144
  ds_read_b128 v[116:119], v2 offset:38912
  s_waitcnt lgkmcnt(6)
  v_mfma_f32_32x32x16_bf16 v[32:47], a[12:15], v[120:123], v[32:47]
  buffer_load_dwordx4 v2, s[4:7], s43 offen offset:2048 sc1 lds
  v_mfma_f32_32x32x16_bf16 v[48:63], a[12:15], v[124:127], v[48:63]
  v_mfma_f32_32x32x16_bf16 v[64:79], v[120:123], a[140:143], v[64:79]
  buffer_load_dwordx4 v2, s[4:7], s43 offen offset:3072 sc1 lds
  v_mfma_f32_32x32x16_bf16 v[80:95], v[124:127], a[140:143], v[80:95]
  ds_read_b128 v[120:123], v2 offset:7168
  ds_read_b128 v[124:127], v2 offset:39936
  s_waitcnt lgkmcnt(6)
  v_mfma_f32_32x32x16_bf16 v[32:47], a[16:19], v[96:99], v[32:47]
  v_mfma_f32_32x32x16_bf16 v[48:63], a[16:19], v[100:103], v[48:63]
  s_add_u32 s47, s60, 8192
  buffer_load_dwordx4 a[168:171], v2, s[4:7], s47 offen offset:2048 sc1
  v_mfma_f32_32x32x16_bf16 v[64:79], v[96:99], a[144:147], v[64:79]
  v_mfma_f32_32x32x16_bf16 v[80:95], v[100:103], a[144:147], v[80:95]
  ds_read_b128 v[96:99], v2 offset:8192
  ds_read_b128 v[100:103], v2 offset:40960
  s_waitcnt lgkmcnt(6)
  v_mfma_f32_32x32x16_bf16 v[32:47], a[20:23], v[104:107], v[32:47]
  s_add_u32 s47, s60, 8192
  buffer_load_dwordx4 a[172:175], v2, s[4:7], s47 offen offset:3072 sc1
  v_mfma_f32_32x32x16_bf16 v[48:63], a[20:23], v[108:111], v[48:63]
  v_mfma_f32_32x32x16_bf16 v[64:79], v[104:107], a[148:151], v[64:79]
  v_mfma_f32_32x32x16_bf16 v[80:95], v[108:111], a[148:151], v[80:95]
  s_add_u32 s47, s60, 12288
  buffer_load_dwordx4 a[176:179], v2, s[4:7], s47 offen offset:0 sc1
  ds_read_b128 v[104:107], v2 offset:9216
  ds_read_b128 v[108:111], v2 offset:41984
  s_waitcnt lgkmcnt(6)
  v_mfma_f32_32x32x16_bf16 v[32:47], a[24:27], v[112:115], v[32:47]
  v_mfma_f32_32x32x16_bf16 v[48:63], a[24:27], v[116:119], v[48:63]
  v_mfma_f32_32x32x16_bf16 v[64:79], v[112:115], a[152:155], v[64:79]
  s_add_u32 s47, s60, 12288
  buffer_load_dwordx4 a[180:183], v2, s[4:7], s47 offen offset:1024 sc1
  v_mfma_f32_32x32x16_bf16 v[80:95], v[116:119], a[152:155], v[80:95]
  ds_read_b128 v[112:115], v2 offset:10240
  ds_read_b128 v[116:119], v2 offset:43008
  s_waitcnt lgkmcnt(6)
  v_mfma_f32_32x32x16_bf16 v[32:47], a[28:31], v[120:123], v[32:47]
  v_mfma_f32_32x32x16_bf16 v[48:63], a[28:31], v[124:127], v[48:63]
  s_waitcnt vmcnt(4)
  s_barrier
  v_mfma_f32_32x32x16_bf16 v[64:79], v[120:123], a[156:159], v[64:79]
  s_lshl_b32 s41, s18, 13
  s_add_u32 s42, s89, s41
  s_add_u32 s41, s41, 65536
  s_mov_b32 m0, s41
  s_nop 0
  buffer_load_dwordx4 v2, s[4:7], s42 offen offset:0 sc1 lds
  v_mfma_f32_32x32x16_bf16 v[80:95], v[124:127], a[156:159], v[80:95]
  s_add_u32 s47, s60, 12288
  buffer_load_dwordx4 a[184:187], v2, s[4:7], s47 offen offset:2048 sc1
  ds_read_b128 v[120:123], v2 offset:11264
  ds_read_b128 v[124:127], v2 offset:44032
  s_waitcnt lgkmcnt(6)
  v_mfma_f32_32x32x16_bf16 v[32:47], a[32:35], v[96:99], v[32:47]
  buffer_load_dwordx4 v2, s[4:7], s42 offen offset:1024 sc1 lds
  v_mfma_f32_32x32x16_bf16 v[48:63], a[32:35], v[100:103], v[48:63]
  v_mfma_f32_32x32x16_bf16 v[64:79], v[96:99], a[160:163], v[64:79]
  buffer_load_dwordx4 v2, s[4:7], s42 offen offset:2048 sc1 lds
  v_mfma_f32_32x32x16_bf16 v[80:95], v[100:103], a[160:163], v[80:95]
  s_add_u32 s47, s60, 12288
  buffer_load_dwordx4 a[188:191], v2, s[4:7], s47 offen offset:3072 sc1
  ds_read_b128 v[96:99], v2 offset:12288
  ds_read_b128 v[100:103], v2 offset:45056
  s_waitcnt lgkmcnt(6)
  v_mfma_f32_32x32x16_bf16 v[32:47], a[36:39], v[104:107], v[32:47]
  buffer_load_dwordx4 v2, s[4:7], s42 offen offset:3072 sc1 lds
  v_mfma_f32_32x32x16_bf16 v[48:63], a[36:39], v[108:111], v[48:63]
  v_mfma_f32_32x32x16_bf16 v[64:79], v[104:107], a[164:167], v[64:79]
  s_lshl_b32 s41, s18, 13
  s_add_u32 s41, s41, 4096
  s_add_u32 s42, s89, s41
  s_add_u32 s41, s41, 65536
  s_mov_b32 m0, s41
  s_nop 0
  buffer_load_dwordx4 v2, s[4:7], s42 offen offset:0 sc1 lds
  v_mfma_f32_32x32x16_bf16 v[80:95], v[108:111], a[164:167], v[80:95]
  ds_read_b128 v[104:107], v2 offset:13312
  ds_read_b128 v[108:111], v2 offset:46080
  s_waitcnt lgkmcnt(6)
  v_mfma_f32_32x32x16_bf16 v[32:47], a[40:43], v[112:115], v[32:47]
  buffer_load_dwordx4 v2, s[4:7], s42 offen offset:1024 sc1 lds
  v_mfma_f32_32x32x16_bf16 v[48:63], a[40:43], v[116:119], v[48:63]
  s_waitcnt vmcnt(11)
  v_mfma_f32_32x32x16_bf16 v[64:79], v[112:115], a[168:171], v[64:79]
  buffer_load_dwordx4 v2, s[4:7], s42 offen offset:2048 sc1 lds
  v_mfma_f32_32x32x16_bf16 v[80:95], v[116:119], a[168:171], v[80:95]
  ds_read_b128 v[112:115], v2 offset:14336
  ds_read_b128 v[116:119], v2 offset:47104
  s_waitcnt lgkmcnt(6)
  v_mfma_f32_32x32x16_bf16 v[32:47], a[44:47], v[120:123], v[32:47]
  buffer_load_dwordx4 v2, s[4:7], s42 offen offset:3072 sc1 lds
  v_mfma_f32_32x32x16_bf16 v[48:63], a[44:47], v[124:127], v[48:63]
  s_waitcnt vmcnt(12)
  v_mfma_f32_32x32x16_bf16 v[64:79], v[120:123], a[172:175], v[64:79]
  s_add_u32 s47, s60, 16384
  buffer_load_dwordx4 a[192:195], v2, s[4:7], s47 offen offset:0 sc1
  v_mfma_f32_32x32x16_bf16 v[80:95], v[124:127], a[172:175], v[80:95]
  ds_read_b128 v[120:123], v2 offset:15360
  ds_read_b128 v[124:127], v2 offset:48128
  s_waitcnt lgkmcnt(6)
  v_mfma_f32_32x32x16_bf16 v[32:47], a[48:51], v[96:99], v[32:47]
  s_add_u32 s47, s60, 16384
  buffer_load_dwordx4 a[196:199], v2, s[4:7], s47 offen offset:1024 sc1
  v_mfma_f32_32x32x16_bf16 v[48:63], a[48:51], v[100:103], v[48:63]
  s_waitcnt vmcnt(13)
  v_mfma_f32_32x32x16_bf16 v[64:79], v[96:99], a[176:179], v[64:79]
  s_add_u32 s47, s60, 16384
  buffer_load_dwordx4 a[200:203], v2, s[4:7], s47 offen offset:2048 sc1
  v_mfma_f32_32x32x16_bf16 v[80:95], v[100:103], a[176:179], v[80:95]
  ds_read_b128 v[96:99], v2 offset:16384
  ds_read_b128 v[100:103], v2 offset:49152
  s_waitcnt lgkmcnt(6)
  v_mfma_f32_32x32x16_bf16 v[32:47], a[52:55], v[104:107], v[32:47]
  s_add_u32 s47, s60, 16384
  buffer_load_dwordx4 a[204:207], v2, s[4:7], s47 offen offset:3072 sc1
  v_mfma_f32_32x32x16_bf16 v[48:63], a[52:55], v[108:111], v[48:63]
  s_waitcnt vmcnt(14)
  v_mfma_f32_32x32x16_bf16 v[64:79], v[104:107], a[180:183], v[64:79]
  s_add_u32 s47, s60, 20480
  buffer_load_dwordx4 a[208:211], v2, s[4:7], s47 offen offset:0 sc1
  v_mfma_f32_32x32x16_bf16 v[80:95], v[108:111], a[180:183], v[80:95]
  ds_read_b128 v[104:107], v2 offset:17408
  ds_read_b128 v[108:111], v2 offset:50176
  s_waitcnt lgkmcnt(6)
  v_mfma_f32_32x32x16_bf16 v[32:47], a[56:59], v[112:115], v[32:47]
  s_add_u32 s47, s60, 20480
  buffer_load_dwordx4 a[212:215], v2, s[4:7], s47 offen offset:1024 sc1
  v_mfma_f32_32x32x16_bf16 v[48:63], a[56:59], v[116:119], v[48:63]
  s_waitcnt vmcnt(14)
  v_mfma_f32_32x32x16_bf16 v[64:79], v[112:115], a[184:187], v[64:79]
  s_add_u32 s47, s60, 20480
  buffer_load_dwordx4 a[216:219], v2, s[4:7], s47 offen offset:2048 sc1
  v_mfma_f32_32x32x16_bf16 v[80:95], v[116:119], a[184:187], v[80:95]
  ds_read_b128 v[112:115], v2 offset:18432
  ds_read_b128 v[116:119], v2 offset:51200
  s_waitcnt lgkmcnt(6)
  v_mfma_f32_32x32x16_bf16 v[32:47], a[60:63], v[120:123], v[32:47]
  s_add_u32 s47, s60, 20480
  buffer_load_dwordx4 a[220:223], v2, s[4:7], s47 offen offset:3072 sc1
  v_mfma_f32_32x32x16_bf16 v[48:63], a[60:63], v[124:127], v[48:63]
  s_waitcnt vmcnt(8)
  s_waitcnt lgkmcnt(0)
  s_barrier
  ds_read_b32 v136, v134 offset:0
  ds_read_b32 v137, v134 offset:128
  ds_read_b32 v138, v134 offset:256
  ds_read_b32 v139, v134 offset:384
  v_mfma_f32_32x32x16_bf16 v[64:79], v[120:123], a[188:191], v[64:79]
  s_add_u32 s47, s60, 24576
  buffer_load_dwordx4 a[224:227], v2, s[4:7], s47 offen offset:0 sc1
  v_mfma_f32_32x32x16_bf16 v[80:95], v[124:127], a[188:191], v[80:95]
  ds_read_b128 v[120:123], v2 offset:19456
  ds_read_b128 v[124:127], v2 offset:52224
  v_mfma_f32_32x32x16_bf16 v[32:47], a[64:67], v[96:99], v[32:47]
  s_add_u32 s47, s60, 24576
  buffer_load_dwordx4 a[228:231], v2, s[4:7], s47 offen offset:1024 sc1
  v_mfma_f32_32x32x16_bf16 v[48:63], a[64:67], v[100:103], v[48:63]
  ds_read_b128 v[96:99], v2 offset:20480
  ds_read_b128 v[100:103], v2 offset:53248
  v_mfma_f32_32x32x16_bf16 v[32:47], a[68:71], v[104:107], v[32:47]
  s_add_u32 s47, s60, 24576
  buffer_load_dwordx4 a[232:235], v2, s[4:7], s47 offen offset:2048 sc1
  v_mfma_f32_32x32x16_bf16 v[48:63], a[68:71], v[108:111], v[48:63]
  ds_read_b128 v[104:107], v2 offset:21504
  ds_read_b128 v[108:111], v2 offset:54272
  v_mfma_f32_32x32x16_bf16 v[32:47], a[72:75], v[112:115], v[32:47]
  s_add_u32 s47, s60, 24576
  buffer_load_dwordx4 a[236:239], v2, s[4:7], s47 offen offset:3072 sc1
  v_mfma_f32_32x32x16_bf16 v[48:63], a[72:75], v[116:119], v[48:63]
  ds_read_b128 v[112:115], v2 offset:22528
  ds_read_b128 v[116:119], v2 offset:55296
  s_waitcnt lgkmcnt(6)
  v_mfma_f32_32x32x16_bf16 v[32:47], a[76:79], v[120:123], v[32:47]
  s_add_u32 s47, s60, 28672
  buffer_load_dwordx4 a[240:243], v2, s[4:7], s47 offen offset:0 sc1
  v_mfma_f32_32x32x16_bf16 v[48:63], a[76:79], v[124:127], v[48:63]
  ds_read_b128 v[120:123], v2 offset:23552
  ds_read_b128 v[124:127], v2 offset:56320
  s_waitcnt lgkmcnt(6)
  v_mfma_f32_32x32x16_bf16 v[32:47], a[80:83], v[96:99], v[32:47]
  s_add_u32 s47, s60, 28672
  buffer_load_dwordx4 a[244:247], v2, s[4:7], s47 offen offset:1024 sc1
  v_mfma_f32_32x32x16_bf16 v[48:63], a[80:83], v[100:103], v[48:63]
  ds_read_b128 v[96:99], v2 offset:24576
  ds_read_b128 v[100:103], v2 offset:57344
  s_waitcnt lgkmcnt(6)
  v_mfma_f32_32x32x16_bf16 v[32:47], a[84:87], v[104:107], v[32:47]
  s_add_u32 s47, s60, 28672
  buffer_load_dwordx4 a[248:251], v2, s[4:7], s47 offen offset:2048 sc1
  v_mfma_f32_32x32x16_bf16 v[48:63], a[84:87], v[108:111], v[48:63]
  ds_read_b128 v[104:107], v2 offset:25600
  ds_read_b128 v[108:111], v2 offset:58368
  s_waitcnt lgkmcnt(6)
  v_mfma_f32_32x32x16_bf16 v[32:47], a[88:91], v[112:115], v[32:47]
  s_add_u32 s47, s60, 28672
  buffer_load_dwordx4 a[252:255], v2, s[4:7], s47 offen offset:3072 sc1
  v_mfma_f32_32x32x16_bf16 v[48:63], a[88:91], v[116:119], v[48:63]
  ds_read_b128 v[112:115], v2 offset:26624
  ds_read_b128 v[116:119], v2 offset:59392
  s_waitcnt lgkmcnt(6)
  v_mfma_f32_32x32x16_bf16 v[32:47], a[92:95], v[120:123], v[32:47]
  v_mfma_f32_32x32x16_bf16 v[48:63], a[92:95], v[124:127], v[48:63]
  ds_read_b128 v[120:123], v2 offset:27648
  ds_read_b128 v[124:127], v2 offset:60416
  s_waitcnt lgkmcnt(6)
  v_mfma_f32_32x32x16_bf16 v[32:47], a[96:99], v[96:99], v[32:47]
  v_mfma_f32_32x32x16_bf16 v[48:63], a[96:99], v[100:103], v[48:63]
  ds_read_b128 v[96:99], v2 offset:28672
  ds_read_b128 v[100:103], v2 offset:61440
  s_waitcnt lgkmcnt(6)
  v_mfma_f32_32x32x16_bf16 v[32:47], a[100:103], v[104:107], v[32:47]
  v_mfma_f32_32x32x16_bf16 v[48:63], a[100:103], v[108:111], v[48:63]
  ds_read_b128 v[104:107], v2 offset:29696
  ds_read_b128 v[108:111], v2 offset:62464
  s_waitcnt lgkmcnt(6)
  v_mfma_f32_32x32x16_bf16 v[32:47], a[104:107], v[112:115], v[32:47]
  v_mfma_f32_32x32x16_bf16 v[48:63], a[104:107], v[116:119], v[48:63]
  ds_read_b128 v[112:115], v2 offset:30720
  ds_read_b128 v[116:119], v2 offset:63488
  s_waitcnt lgkmcnt(6)
  v_mfma_f32_32x32x16_bf16 v[32:47], a[108:111], v[120:123], v[32:47]
  v_mfma_f32_32x32x16_bf16 v[48:63], a[108:111], v[124:127], v[48:63]
  ds_read_b128 v[120:123], v2 offset:31744
  ds_read_b128 v[124:127], v2 offset:64512
  s_waitcnt lgkmcnt(6)
  v_mfma_f32_32x32x16_bf16 v[32:47], a[112:115], v[96:99], v[32:47]
  v_mfma_f32_32x32x16_bf16 v[48:63], a[112:115], v[100:103], v[48:63]
  ds_read_b128 v[96:99], v2 offset:16384
  ds_read_b128 v[100:103], v2 offset:49152
  s_waitcnt lgkmcnt(6)
  v_mfma_f32_32x32x16_bf16 v[32:47], a[116:119], v[104:107], v[32:47]
  v_mfma_f32_32x32x16_bf16 v[48:63], a[116:119], v[108:111], v[48:63]
  ds_read_b128 v[104:107], v2 offset:17408
  ds_read_b128 v[108:111], v2 offset:50176
  s_waitcnt lgkmcnt(6)
  v_mfma_f32_32x32x16_bf16 v[32:47], a[120:123], v[112:115], v[32:47]
  v_mfma_f32_32x32x16_bf16 v[48:63], a[120:123], v[116:119], v[48:63]
  ds_read_b128 v[112:115], v2 offset:18432
  ds_read_b128 v[116:119], v2 offset:51200
  s_waitcnt lgkmcnt(6)
  v_mfma_f32_32x32x16_bf16 v[32:47], a[124:127], v[120:123], v[32:47]
  v_mfma_f32_32x32x16_bf16 v[48:63], a[124:127], v[124:127], v[48:63]
  ds_read_b128 v[120:123], v2 offset:19456
  ds_read_b128 v[124:127], v2 offset:52224
  s_waitcnt lgkmcnt(6)
  s_waitcnt vmcnt(15)
  v_mfma_f32_32x32x16_bf16 v[64:79], v[96:99], a[192:195], v[64:79]
  v_mfma_f32_32x32x16_bf16 v[80:95], v[100:103], a[192:195], v[80:95]
  ds_read_b128 v[96:99], v2 offset:20480
  ds_read_b128 v[100:103], v2 offset:53248
  s_waitcnt lgkmcnt(6)
  s_waitcnt vmcnt(14)
  v_mfma_f32_32x32x16_bf16 v[64:79], v[104:107], a[196:199], v[64:79]
  v_mul_f32 v144, v137, v176
  v_fmac_f32 v144, v32, v136
  v_mul_f32 v145, v137, v177
  v_fmac_f32 v145, v33, v136
  v_mfma_f32_32x32x16_bf16 v[80:95], v[108:111], a[196:199], v[80:95]
  v_mul_f32 v146, v137, v178
  v_fmac_f32 v146, v34, v136
  v_mul_f32 v147, v137, v179
  v_fmac_f32 v147, v35, v136
  ds_read_b128 v[104:107], v2 offset:21504
  ds_read_b128 v[108:111], v2 offset:54272
  s_waitcnt lgkmcnt(6)
  s_waitcnt vmcnt(13)
  v_mfma_f32_32x32x16_bf16 v[64:79], v[112:115], a[200:203], v[64:79]
  v_mul_f32 v148, v137, v180
  v_fmac_f32 v148, v36, v136
  v_mul_f32 v149, v137, v181
  v_fmac_f32 v149, v37, v136
  v_mfma_f32_32x32x16_bf16 v[80:95], v[116:119], a[200:203], v[80:95]
  v_mul_f32 v150, v137, v182
  v_fmac_f32 v150, v38, v136
  v_mul_f32 v151, v137, v183
  v_fmac_f32 v151, v39, v136
  ds_read_b128 v[112:115], v2 offset:22528
  ds_read_b128 v[116:119], v2 offset:55296
  s_waitcnt lgkmcnt(6)
  s_waitcnt vmcnt(12)
  v_mfma_f32_32x32x16_bf16 v[64:79], v[120:123], a[204:207], v[64:79]
  v_mul_f32 v152, v137, v184
  v_fmac_f32 v152, v40, v136
  v_mul_f32 v153, v137, v185
  v_fmac_f32 v153, v41, v136
  v_mfma_f32_32x32x16_bf16 v[80:95], v[124:127], a[204:207], v[80:95]
  v_mul_f32 v154, v137, v186
  v_fmac_f32 v154, v42, v136
  v_mul_f32 v155, v137, v187
  v_fmac_f32 v155, v43, v136
  ds_read_b128 v[120:123], v2 offset:23552
  ds_read_b128 v[124:127], v2 offset:56320
  s_waitcnt lgkmcnt(6)
  s_waitcnt vmcnt(11)
  v_mfma_f32_32x32x16_bf16 v[64:79], v[96:99], a[208:211], v[64:79]
  v_mul_f32 v156, v137, v188
  v_fmac_f32 v156, v44, v136
  v_mul_f32 v157, v137, v189
  v_fmac_f32 v157, v45, v136
  v_mfma_f32_32x32x16_bf16 v[80:95], v[100:103], a[208:211], v[80:95]
  v_mul_f32 v158, v137, v190
  v_fmac_f32 v158, v46, v136
  v_mul_f32 v159, v137, v191
  v_fmac_f32 v159, v47, v136
  ds_read_b128 v[96:99], v2 offset:24576
  ds_read_b128 v[100:103], v2 offset:57344
  s_waitcnt lgkmcnt(6)
  s_waitcnt vmcnt(10)
  v_mfma_f32_32x32x16_bf16 v[64:79], v[104:107], a[212:215], v[64:79]
  v_cvt_pk_bf16_f32 v32, v144, v145
  v_cvt_pk_bf16_f32 v33, v146, v147
  v_cvt_pk_bf16_f32 v34, v148, v149
  v_cvt_pk_bf16_f32 v35, v150, v151
  v_mfma_f32_32x32x16_bf16 v[80:95], v[108:111], a[212:215], v[80:95]
  v_cvt_pk_bf16_f32 v36, v152, v153
  v_cvt_pk_bf16_f32 v37, v154, v155
  v_cvt_pk_bf16_f32 v38, v156, v157
  v_cvt_pk_bf16_f32 v39, v158, v159
  ds_read_b128 v[104:107], v2 offset:25600
  ds_read_b128 v[108:111], v2 offset:58368
  s_waitcnt lgkmcnt(6)
  s_waitcnt vmcnt(9)
  v_mfma_f32_32x32x16_bf16 v[64:79], v[112:115], a[216:219], v[64:79]
  v_add_u32 v133, 108544, v2
  ds_write_b128 v133, v[32:35]
  ds_write_b128 v133, v[36:39] offset:1024
  v_mul_f32 v144, v139, v176
  v_mfma_f32_32x32x16_bf16 v[80:95], v[116:119], a[216:219], v[80:95]
  v_fmac_f32 v144, v48, v138
  v_mul_f32 v145, v139, v177
  v_fmac_f32 v145, v49, v138
  v_mul_f32 v146, v139, v178
  ds_read_b128 v[112:115], v2 offset:26624
  ds_read_b128 v[116:119], v2 offset:59392
  s_waitcnt lgkmcnt(8)
  s_waitcnt vmcnt(8)
  v_mfma_f32_32x32x16_bf16 v[64:79], v[120:123], a[220:223], v[64:79]
  v_fmac_f32 v146, v50, v138
  v_mul_f32 v147, v139, v179
  v_fmac_f32 v147, v51, v138
  v_mul_f32 v148, v139, v180
  v_mfma_f32_32x32x16_bf16 v[80:95], v[124:127], a[220:223], v[80:95]
  v_fmac_f32 v148, v52, v138
  v_mul_f32 v149, v139, v181
  v_fmac_f32 v149, v53, v138
  v_mul_f32 v150, v139, v182
  ds_read_b128 v[120:123], v2 offset:27648
  ds_read_b128 v[124:127], v2 offset:60416
  s_waitcnt lgkmcnt(8)
  s_waitcnt vmcnt(7)
  v_mfma_f32_32x32x16_bf16 v[64:79], v[96:99], a[224:227], v[64:79]
  v_fmac_f32 v150, v54, v138
  v_mul_f32 v151, v139, v183
  v_fmac_f32 v151, v55, v138
  v_mul_f32 v152, v139, v184
  v_mfma_f32_32x32x16_bf16 v[80:95], v[100:103], a[224:227], v[80:95]
  v_fmac_f32 v152, v56, v138
  v_mul_f32 v153, v139, v185
  v_fmac_f32 v153, v57, v138
  v_mul_f32 v154, v139, v186
  ds_read_b128 v[96:99], v2 offset:28672
  ds_read_b128 v[100:103], v2 offset:61440
  s_waitcnt lgkmcnt(8)
  s_waitcnt vmcnt(6)
  v_mfma_f32_32x32x16_bf16 v[64:79], v[104:107], a[228:231], v[64:79]
  v_fmac_f32 v154, v58, v138
  v_mul_f32 v155, v139, v187
  v_fmac_f32 v155, v59, v138
  v_mul_f32 v156, v139, v188
  v_mfma_f32_32x32x16_bf16 v[80:95], v[108:111], a[228:231], v[80:95]
  v_fmac_f32 v156, v60, v138
  v_mul_f32 v157, v139, v189
  v_fmac_f32 v157, v61, v138
  v_mul_f32 v158, v139, v190
  ds_read_b128 v[104:107], v2 offset:29696
  ds_read_b128 v[108:111], v2 offset:62464
  s_waitcnt lgkmcnt(6)
  s_waitcnt vmcnt(5)
  v_mfma_f32_32x32x16_bf16 v[64:79], v[112:115], a[232:235], v[64:79]
  v_fmac_f32 v158, v62, v138
  v_mul_f32 v159, v139, v191
  v_fmac_f32 v159, v63, v138
  v_cvt_pk_bf16_f32 v48, v144, v145
  v_mfma_f32_32x32x16_bf16 v[80:95], v[116:119], a[232:235], v[80:95]
  v_cvt_pk_bf16_f32 v49, v146, v147
  v_cvt_pk_bf16_f32 v50, v148, v149
  v_cvt_pk_bf16_f32 v51, v150, v151
  v_cvt_pk_bf16_f32 v52, v152, v153
  ds_read_b128 v[112:115], v2 offset:30720
  ds_read_b128 v[116:119], v2 offset:63488
  s_waitcnt lgkmcnt(6)
  s_waitcnt vmcnt(4)
  v_mfma_f32_32x32x16_bf16 v[64:79], v[120:123], a[236:239], v[64:79]
  v_cvt_pk_bf16_f32 v53, v154, v155
  v_cvt_pk_bf16_f32 v54, v156, v157
  v_cvt_pk_bf16_f32 v55, v158, v159
  v_add_u32 v133, 112640, v2
  v_mfma_f32_32x32x16_bf16 v[80:95], v[124:127], a[236:239], v[80:95]
  ds_write_b128 v133, v[48:51]
  ds_write_b128 v133, v[52:55] offset:1024
  ds_read_b128 v[120:123], v2 offset:31744
  ds_read_b128 v[124:127], v2 offset:64512
  s_waitcnt lgkmcnt(8)
  s_waitcnt vmcnt(3)
  v_mfma_f32_32x32x16_bf16 v[64:79], v[96:99], a[240:243], v[64:79]
  v_mfma_f32_32x32x16_bf16 v[80:95], v[100:103], a[240:243], v[80:95]
  s_waitcnt lgkmcnt(6)
  s_waitcnt vmcnt(2)
  v_mfma_f32_32x32x16_bf16 v[64:79], v[104:107], a[244:247], v[64:79]
  v_mfma_f32_32x32x16_bf16 v[80:95], v[108:111], a[244:247], v[80:95]
  s_waitcnt lgkmcnt(4)
  s_waitcnt vmcnt(1)
  v_mfma_f32_32x32x16_bf16 v[64:79], v[112:115], a[248:251], v[64:79]
  v_mfma_f32_32x32x16_bf16 v[80:95], v[116:119], a[248:251], v[80:95]
  s_waitcnt lgkmcnt(0)
  s_waitcnt vmcnt(0)
  v_mfma_f32_32x32x16_bf16 v[64:79], v[120:123], a[252:255], v[64:79]
  v_mfma_f32_32x32x16_bf16 v[80:95], v[124:127], a[252:255], v[80:95]
  ds_read_b128 v[144:147], v135 offset:0
  ds_read_b128 v[160:163], v135 offset:128
  ds_read_b128 v[148:151], v135 offset:32
  ds_read_b128 v[164:167], v135 offset:160
  ds_read_b128 v[152:155], v135 offset:64
  ds_read_b128 v[168:171], v135 offset:192
  ds_read_b128 v[156:159], v135 offset:96
  ds_read_b128 v[172:175], v135 offset:224
  s_waitcnt lgkmcnt(0)
  v_mov_b32 v128, v209
  v_pk_mul_f32 v[160:161], v[160:161], v[128:129] op_sel_hi:[1,0]
  v_pk_mul_f32 v[162:163], v[162:163], v[128:129] op_sel_hi:[1,0]
  v_pk_mul_f32 v[164:165], v[164:165], v[128:129] op_sel_hi:[1,0]
  v_pk_mul_f32 v[166:167], v[166:167], v[128:129] op_sel_hi:[1,0]
  v_pk_mul_f32 v[168:169], v[168:169], v[128:129] op_sel_hi:[1,0]
  v_pk_mul_f32 v[170:171], v[170:171], v[128:129] op_sel_hi:[1,0]
  v_pk_mul_f32 v[172:173], v[172:173], v[128:129] op_sel_hi:[1,0]
  v_pk_mul_f32 v[174:175], v[174:175], v[128:129] op_sel_hi:[1,0]
  v_pk_fma_f32 v[160:161], v[64:65], v[144:145], v[160:161]
  v_pk_fma_f32 v[162:163], v[66:67], v[146:147], v[162:163]
  v_pk_fma_f32 v[164:165], v[68:69], v[148:149], v[164:165]
  v_pk_fma_f32 v[166:167], v[70:71], v[150:151], v[166:167]
  v_pk_fma_f32 v[168:169], v[72:73], v[152:153], v[168:169]
  v_pk_fma_f32 v[170:171], v[74:75], v[154:155], v[170:171]
  v_pk_fma_f32 v[172:173], v[76:77], v[156:157], v[172:173]
  v_pk_fma_f32 v[174:175], v[78:79], v[158:159], v[174:175]
  v_cvt_pk_bf16_f32 v64, v160, v161
  v_cvt_pk_bf16_f32 v65, v162, v163
  v_cvt_pk_bf16_f32 v66, v164, v165
  v_cvt_pk_bf16_f32 v67, v166, v167
  v_cvt_pk_bf16_f32 v68, v168, v169
  v_cvt_pk_bf16_f32 v69, v170, v171
  v_cvt_pk_bf16_f32 v70, v172, v173
  v_cvt_pk_bf16_f32 v71, v174, v175
  v_add_u32 v133, 118784, v2
  ds_write_b128 v133, v[64:67]
  ds_write_b128 v133, v[68:71] offset:1024
  ds_read_b128 v[96:99], v135 offset:256
  ds_read_b128 v[112:115], v135 offset:384
  ds_read_b128 v[100:103], v135 offset:288
  ds_read_b128 v[116:119], v135 offset:416
  ds_read_b128 v[104:107], v135 offset:320
  ds_read_b128 v[120:123], v135 offset:448
  ds_read_b128 v[108:111], v135 offset:352
  ds_read_b128 v[124:127], v135 offset:480
  s_waitcnt lgkmcnt(0)
  v_mov_b32 v128, v209
  v_pk_mul_f32 v[112:113], v[112:113], v[128:129] op_sel_hi:[1,0]
  v_pk_mul_f32 v[114:115], v[114:115], v[128:129] op_sel_hi:[1,0]
  v_pk_mul_f32 v[116:117], v[116:117], v[128:129] op_sel_hi:[1,0]
  v_pk_mul_f32 v[118:119], v[118:119], v[128:129] op_sel_hi:[1,0]
  v_pk_mul_f32 v[120:121], v[120:121], v[128:129] op_sel_hi:[1,0]
  v_pk_mul_f32 v[122:123], v[122:123], v[128:129] op_sel_hi:[1,0]
  v_pk_mul_f32 v[124:125], v[124:125], v[128:129] op_sel_hi:[1,0]
  v_pk_mul_f32 v[126:127], v[126:127], v[128:129] op_sel_hi:[1,0]
  v_pk_fma_f32 v[112:113], v[80:81], v[96:97], v[112:113]
  v_pk_fma_f32 v[114:115], v[82:83], v[98:99], v[114:115]
  v_pk_fma_f32 v[116:117], v[84:85], v[100:101], v[116:117]
  v_pk_fma_f32 v[118:119], v[86:87], v[102:103], v[118:119]
  v_pk_fma_f32 v[120:121], v[88:89], v[104:105], v[120:121]
  v_pk_fma_f32 v[122:123], v[90:91], v[106:107], v[122:123]
  v_pk_fma_f32 v[124:125], v[92:93], v[108:109], v[124:125]
  v_pk_fma_f32 v[126:127], v[94:95], v[110:111], v[126:127]
  v_cvt_pk_bf16_f32 v80, v112, v113
  v_cvt_pk_bf16_f32 v81, v114, v115
  v_cvt_pk_bf16_f32 v82, v116, v117
  v_cvt_pk_bf16_f32 v83, v118, v119
  v_cvt_pk_bf16_f32 v84, v120, v121
  v_cvt_pk_bf16_f32 v85, v122, v123
  v_cvt_pk_bf16_f32 v86, v124, v125
  v_cvt_pk_bf16_f32 v87, v126, v127
  v_add_u32 v133, 122880, v2
  ds_write_b128 v133, v[80:83]
  ds_write_b128 v133, v[84:87] offset:1024
  s_branch G2GD_71
G2W3_70:
  ds_read_b128 v[96:99], v2 offset:0
  ds_read_b128 v[100:103], v2 offset:32768
  ds_read_b128 v[104:107], v2 offset:1024
  ds_read_b128 v[108:111], v2 offset:33792
  ds_read_b128 v[112:115], v2 offset:2048
  ds_read_b128 v[116:119], v2 offset:34816
  ds_read_b128 v[120:123], v2 offset:3072
  ds_read_b128 v[124:127], v2 offset:35840
  s_waitcnt lgkmcnt(6)
  v_mfma_f32_32x32x16_bf16 v[32:47], v[96:99], a[0:3], 0
  s_mul_i32 s41, s20, 8192
  s_lshl_b32 s42, s19, 15
  s_add_u32 s41, s41, s42
  s_add_u32 s41, s41, 16384
  s_mov_b32 m0, s41
  s_add_u32 s43, s88, s41
  buffer_load_dwordx4 v2, s[4:7], s43 offen offset:0 sc1 lds
  v_mfma_f32_32x32x16_bf16 v[48:63], v[100:103], a[0:3], 0
  ds_read_b128 v[96:99], v2 offset:4096
  ds_read_b128 v[100:103], v2 offset:36864
  s_waitcnt lgkmcnt(6)
  v_mfma_f32_32x32x16_bf16 v[32:47], v[104:107], a[4:7], v[32:47]
  buffer_load_dwordx4 v2, s[4:7], s43 offen offset:1024 sc1 lds
  v_mfma_f32_32x32x16_bf16 v[48:63], v[108:111], a[4:7], v[48:63]
  ds_read_b128 v[104:107], v2 offset:5120
  ds_read_b128 v[108:111], v2 offset:37888
  s_waitcnt lgkmcnt(6)
  v_mfma_f32_32x32x16_bf16 v[32:47], v[112:115], a[8:11], v[32:47]
  buffer_load_dwordx4 v2, s[4:7], s43 offen offset:2048 sc1 lds
  v_mfma_f32_32x32x16_bf16 v[48:63], v[116:119], a[8:11], v[48:63]
  s_waitcnt lgkmcnt(4)
  v_mfma_f32_32x32x16_bf16 v[32:47], v[120:123], a[12:15], v[32:47]
  buffer_load_dwordx4 v2, s[4:7], s43 offen offset:3072 sc1 lds
  v_mfma_f32_32x32x16_bf16 v[48:63], v[124:127], a[12:15], v[48:63]
  s_waitcnt lgkmcnt(2)
  v_mfma_f32_32x32x16_bf16 v[32:47], v[96:99], a[16:19], v[32:47]
  s_mul_i32 s41, s20, 8192
  s_lshl_b32 s42, s19, 15
  s_add_u32 s41, s41, s42
  s_add_u32 s41, s41, 20480
  s_mov_b32 m0, s41
  s_add_u32 s43, s88, s41
  buffer_load_dwordx4 v2, s[4:7], s43 offen offset:0 sc1 lds
  v_mfma_f32_32x32x16_bf16 v[48:63], v[100:103], a[16:19], v[48:63]
  s_waitcnt vmcnt(5)
  s_barrier
  ds_read_b128 v[112:115], v2 offset:6144
  ds_read_b128 v[116:119], v2 offset:38912
  ds_read_b128 v[120:123], v2 offset:7168
  ds_read_b128 v[124:127], v2 offset:39936
  ds_read_b128 v[96:99], v2 offset:8192
  ds_read_b128 v[100:103], v2 offset:40960
  s_waitcnt lgkmcnt(6)
  v_mfma_f32_32x32x16_bf16 v[32:47], v[104:107], a[20:23], v[32:47]
  buffer_load_dwordx4 v2, s[4:7], s43 offen offset:1024 sc1 lds
  v_mfma_f32_32x32x16_bf16 v[48:63], v[108:111], a[20:23], v[48:63]
  ds_read_b128 v[104:107], v2 offset:9216
  ds_read_b128 v[108:111], v2 offset:41984
  s_waitcnt lgkmcnt(6)
  v_mfma_f32_32x32x16_bf16 v[32:47], v[112:115], a[24:27], v[32:47]
  buffer_load_dwordx4 v2, s[4:7], s43 offen offset:2048 sc1 lds
  v_mfma_f32_32x32x16_bf16 v[48:63], v[116:119], a[24:27], v[48:63]
  ds_read_b128 v[112:115], v2 offset:10240
  ds_read_b128 v[116:119], v2 offset:43008
  s_waitcnt lgkmcnt(6)
  v_mfma_f32_32x32x16_bf16 v[32:47], v[120:123], a[28:31], v[32:47]
  buffer_load_dwordx4 v2, s[4:7], s43 offen offset:3072 sc1 lds
  v_mfma_f32_32x32x16_bf16 v[48:63], v[124:127], a[28:31], v[48:63]
  ds_read_b128 v[120:123], v2 offset:11264
  ds_read_b128 v[124:127], v2 offset:44032
  s_waitcnt lgkmcnt(6)
  v_mfma_f32_32x32x16_bf16 v[32:47], v[96:99], a[32:35], v[32:47]
  v_mfma_f32_32x32x16_bf16 v[48:63], v[100:103], a[32:35], v[48:63]
  ds_read_b128 v[96:99], v2 offset:12288
  ds_read_b128 v[100:103], v2 offset:45056
  s_waitcnt lgkmcnt(6)
  v_mfma_f32_32x32x16_bf16 v[32:47], v[104:107], a[36:39], v[32:47]
  v_mfma_f32_32x32x16_bf16 v[48:63], v[108:111], a[36:39], v[48:63]
  ds_read_b128 v[104:107], v2 offset:13312
  ds_read_b128 v[108:111], v2 offset:46080
  s_waitcnt lgkmcnt(6)
  v_mfma_f32_32x32x16_bf16 v[32:47], v[112:115], a[40:43], v[32:47]
  v_mfma_f32_32x32x16_bf16 v[48:63], v[116:119], a[40:43], v[48:63]
  ds_read_b128 v[112:115], v2 offset:14336
  ds_read_b128 v[116:119], v2 offset:47104
  s_waitcnt lgkmcnt(6)
  v_mfma_f32_32x32x16_bf16 v[32:47], v[120:123], a[44:47], v[32:47]
  v_mfma_f32_32x32x16_bf16 v[48:63], v[124:127], a[44:47], v[48:63]
  ds_read_b128 v[120:123], v2 offset:15360
  ds_read_b128 v[124:127], v2 offset:48128
  s_waitcnt lgkmcnt(6)
  v_mfma_f32_32x32x16_bf16 v[32:47], v[96:99], a[48:51], v[32:47]
  v_mfma_f32_32x32x16_bf16 v[48:63], v[100:103], a[48:51], v[48:63]
  s_waitcnt lgkmcnt(4)
  v_mfma_f32_32x32x16_bf16 v[32:47], v[104:107], a[52:55], v[32:47]
  v_mfma_f32_32x32x16_bf16 v[48:63], v[108:111], a[52:55], v[48:63]
  s_waitcnt lgkmcnt(2)
  v_mfma_f32_32x32x16_bf16 v[32:47], v[112:115], a[56:59], v[32:47]
  v_mfma_f32_32x32x16_bf16 v[48:63], v[116:119], a[56:59], v[48:63]
  s_waitcnt vmcnt(0)
  s_barrier
  ds_read_b128 v[96:99], v2 offset:16384
  ds_read_b128 v[100:103], v2 offset:49152
  ds_read_b128 v[104:107], v2 offset:17408
  ds_read_b128 v[108:111], v2 offset:50176
  ds_read_b128 v[112:115], v2 offset:18432
  ds_read_b128 v[116:119], v2 offset:51200
  s_waitcnt lgkmcnt(6)
  v_mfma_f32_32x32x16_bf16 v[32:47], v[120:123], a[60:63], v[32:47]
  s_lshl_b32 s41, s18, 13
  s_add_u32 s42, s89, s41
  s_add_u32 s41, s41, 65536
  s_mov_b32 m0, s41
  s_nop 0
  buffer_load_dwordx4 v2, s[4:7], s42 offen offset:0 sc1 lds
  v_mfma_f32_32x32x16_bf16 v[48:63], v[124:127], a[60:63], v[48:63]
  ds_read_b128 v[120:123], v2 offset:19456
  ds_read_b128 v[124:127], v2 offset:52224
  s_waitcnt lgkmcnt(6)
  v_mfma_f32_32x32x16_bf16 v[32:47], v[96:99], a[64:67], v[32:47]
  buffer_load_dwordx4 v2, s[4:7], s42 offen offset:1024 sc1 lds
  v_mfma_f32_32x32x16_bf16 v[48:63], v[100:103], a[64:67], v[48:63]
  ds_read_b128 v[96:99], v2 offset:20480
  ds_read_b128 v[100:103], v2 offset:53248
  s_waitcnt lgkmcnt(6)
  v_mfma_f32_32x32x16_bf16 v[32:47], v[104:107], a[68:71], v[32:47]
  buffer_load_dwordx4 v2, s[4:7], s42 offen offset:2048 sc1 lds
  v_mfma_f32_32x32x16_bf16 v[48:63], v[108:111], a[68:71], v[48:63]
  ds_read_b128 v[104:107], v2 offset:21504
  ds_read_b128 v[108:111], v2 offset:54272
  s_waitcnt lgkmcnt(6)
  v_mfma_f32_32x32x16_bf16 v[32:47], v[112:115], a[72:75], v[32:47]
  buffer_load_dwordx4 v2, s[4:7], s42 offen offset:3072 sc1 lds
  v_mfma_f32_32x32x16_bf16 v[48:63], v[116:119], a[72:75], v[48:63]
  ds_read_b128 v[112:115], v2 offset:22528
  ds_read_b128 v[116:119], v2 offset:55296
  s_waitcnt lgkmcnt(6)
  v_mfma_f32_32x32x16_bf16 v[32:47], v[120:123], a[76:79], v[32:47]
  s_lshl_b32 s41, s18, 13
  s_add_u32 s41, s41, 4096
  s_add_u32 s42, s89, s41
  s_add_u32 s41, s41, 65536
  s_mov_b32 m0, s41
  s_nop 0
  buffer_load_dwordx4 v2, s[4:7], s42 offen offset:0 sc1 lds
  v_mfma_f32_32x32x16_bf16 v[48:63], v[124:127], a[76:79], v[48:63]
  ds_read_b128 v[120:123], v2 offset:23552
  ds_read_b128 v[124:127], v2 offset:56320
  s_waitcnt lgkmcnt(6)
  v_mfma_f32_32x32x16_bf16 v[32:47], v[96:99], a[80:83], v[32:47]
  buffer_load_dwordx4 v2, s[4:7], s42 offen offset:1024 sc1 lds
  v_mfma_f32_32x32x16_bf16 v[48:63], v[100:103], a[80:83], v[48:63]
  ds_read_b128 v[96:99], v2 offset:24576
  ds_read_b128 v[100:103], v2 offset:57344
  s_waitcnt lgkmcnt(6)
  v_mfma_f32_32x32x16_bf16 v[32:47], v[104:107], a[84:87], v[32:47]
  buffer_load_dwordx4 v2, s[4:7], s42 offen offset:2048 sc1 lds
  v_mfma_f32_32x32x16_bf16 v[48:63], v[108:111], a[84:87], v[48:63]
  ds_read_b128 v[104:107], v2 offset:25600
  ds_read_b128 v[108:111], v2 offset:58368
  s_waitcnt lgkmcnt(6)
  v_mfma_f32_32x32x16_bf16 v[32:47], v[112:115], a[88:91], v[32:47]
  buffer_load_dwordx4 v2, s[4:7], s42 offen offset:3072 sc1 lds
  v_mfma_f32_32x32x16_bf16 v[48:63], v[116:119], a[88:91], v[48:63]
  ds_read_b128 v[112:115], v2 offset:26624
  ds_read_b128 v[116:119], v2 offset:59392
  s_waitcnt lgkmcnt(6)
  v_mfma_f32_32x32x16_bf16 v[32:47], v[120:123], a[92:95], v[32:47]
  s_add_u32 s47, s60, 8192
  buffer_load_dwordx4 a[168:171], v2, s[4:7], s47 offen offset:2048 sc1
  v_mfma_f32_32x32x16_bf16 v[48:63], v[124:127], a[92:95], v[48:63]
  ds_read_b128 v[120:123], v2 offset:27648
  ds_read_b128 v[124:127], v2 offset:60416
  s_waitcnt lgkmcnt(6)
  v_mfma_f32_32x32x16_bf16 v[32:47], v[96:99], a[96:99], v[32:47]
  s_add_u32 s47, s60, 8192
  buffer_load_dwordx4 a[172:175], v2, s[4:7], s47 offen offset:3072 sc1
  v_mfma_f32_32x32x16_bf16 v[48:63], v[100:103], a[96:99], v[48:63]
  ds_read_b128 v[96:99], v2 offset:28672
  ds_read_b128 v[100:103], v2 offset:61440
  s_waitcnt lgkmcnt(6)
  v_mfma_f32_32x32x16_bf16 v[32:47], v[104:107], a[100:103], v[32:47]
  s_add_u32 s47, s60, 12288
  buffer_load_dwordx4 a[176:179], v2, s[4:7], s47 offen offset:0 sc1
  v_mfma_f32_32x32x16_bf16 v[48:63], v[108:111], a[100:103], v[48:63]
  ds_read_b128 v[104:107], v2 offset:29696
  ds_read_b128 v[108:111], v2 offset:62464
  s_waitcnt lgkmcnt(6)
  v_mfma_f32_32x32x16_bf16 v[32:47], v[112:115], a[104:107], v[32:47]
  s_add_u32 s47, s60, 12288
  buffer_load_dwordx4 a[180:183], v2, s[4:7], s47 offen offset:1024 sc1
  v_mfma_f32_32x32x16_bf16 v[48:63], v[116:119], a[104:107], v[48:63]
  ds_read_b128 v[112:115], v2 offset:30720
  ds_read_b128 v[116:119], v2 offset:63488
  s_waitcnt lgkmcnt(6)
  v_mfma_f32_32x32x16_bf16 v[32:47], v[120:123], a[108:111], v[32:47]
  s_add_u32 s47, s60, 12288
  buffer_load_dwordx4 a[184:187], v2, s[4:7], s47 offen offset:2048 sc1
  v_mfma_f32_32x32x16_bf16 v[48:63], v[124:127], a[108:111], v[48:63]
  ds_read_b128 v[120:123], v2 offset:31744
  ds_read_b128 v[124:127], v2 offset:64512
  s_waitcnt lgkmcnt(6)
  v_mfma_f32_32x32x16_bf16 v[32:47], v[96:99], a[112:115], v[32:47]
  s_add_u32 s47, s60, 12288
  buffer_load_dwordx4 a[188:191], v2, s[4:7], s47 offen offset:3072 sc1
  v_mfma_f32_32x32x16_bf16 v[48:63], v[100:103], a[112:115], v[48:63]
  s_waitcnt lgkmcnt(4)
  v_mfma_f32_32x32x16_bf16 v[32:47], v[104:107], a[116:119], v[32:47]
  s_add_u32 s47, s60, 16384
  buffer_load_dwordx4 a[192:195], v2, s[4:7], s47 offen offset:0 sc1
  v_mfma_f32_32x32x16_bf16 v[48:63], v[108:111], a[116:119], v[48:63]
  s_waitcnt lgkmcnt(2)
  v_mfma_f32_32x32x16_bf16 v[32:47], v[112:115], a[120:123], v[32:47]
  s_add_u32 s47, s60, 16384
  buffer_load_dwordx4 a[196:199], v2, s[4:7], s47 offen offset:1024 sc1
  v_mfma_f32_32x32x16_bf16 v[48:63], v[116:119], a[120:123], v[48:63]
  s_waitcnt vmcnt(8)
  s_waitcnt lgkmcnt(0)
  s_barrier
  ds_read_b32 v136, v134 offset:0
  ds_read_b32 v137, v134 offset:128
  ds_read_b32 v138, v134 offset:256
  ds_read_b32 v139, v134 offset:384
  ds_read_b128 v[96:99], v21 offset:0
  ds_read_b128 v[104:107], v21 offset:1024
  ds_read_b128 v[112:115], v21 offset:2048
  v_mfma_f32_32x32x16_bf16 v[32:47], v[120:123], a[124:127], v[32:47]
  s_add_u32 s47, s60, 16384
  buffer_load_dwordx4 a[200:203], v2, s[4:7], s47 offen offset:2048 sc1
  v_mfma_f32_32x32x16_bf16 v[48:63], v[124:127], a[124:127], v[48:63]
  ds_read_b128 v[120:123], v21 offset:3072
  s_waitcnt lgkmcnt(3)
  v_mfma_f32_32x32x16_bf16 v[64:79], v[96:99], a[0:3], 0
  s_add_u32 s47, s60, 16384
  buffer_load_dwordx4 a[204:207], v2, s[4:7], s47 offen offset:3072 sc1
  v_mfma_f32_32x32x16_bf16 v[80:95], v[96:99], a[128:131], 0
  buffer_load_dwordx2 v[176:177], v22, s[4:7], s92 offen offset:0 sc1
  ds_read_b128 v[96:99], v21 offset:4096
  s_waitcnt lgkmcnt(3)
  v_mfma_f32_32x32x16_bf16 v[64:79], v[104:107], a[4:7], v[64:79]
  s_add_u32 s47, s60, 20480
  buffer_load_dwordx4 a[208:211], v2, s[4:7], s47 offen offset:0 sc1
  v_mfma_f32_32x32x16_bf16 v[80:95], v[104:107], a[132:135], v[80:95]
  buffer_load_dwordx2 v[178:179], v22, s[4:7], s92 offen offset:256 sc1
  ds_read_b128 v[144:147], v135 offset:0
  ds_read_b128 v[160:163], v135 offset:128
  ds_read_b128 v[148:151], v135 offset:32
  ds_read_b128 v[104:107], v21 offset:5120
  s_waitcnt lgkmcnt(6)
  v_mfma_f32_32x32x16_bf16 v[64:79], v[112:115], a[8:11], v[64:79]
  s_add_u32 s47, s60, 20480
  buffer_load_dwordx4 a[212:215], v2, s[4:7], s47 offen offset:1024 sc1
  ds_read_b128 v[164:167], v135 offset:160
  ds_read_b128 v[152:155], v135 offset:64
  ds_read_b128 v[168:171], v135 offset:192
  v_mfma_f32_32x32x16_bf16 v[80:95], v[112:115], a[136:139], v[80:95]
  buffer_load_dwordx2 v[180:181], v22, s[4:7], s92 offen offset:512 sc1
  ds_read_b128 v[156:159], v135 offset:96
  ds_read_b128 v[172:175], v135 offset:224
  s_waitcnt lgkmcnt(0)
  ds_read_b128 v[112:115], v21 offset:6144
  v_mfma_f32_32x32x16_bf16 v[64:79], v[120:123], a[12:15], v[64:79]
  s_add_u32 s47, s60, 20480
  buffer_load_dwordx4 a[216:219], v2, s[4:7], s47 offen offset:2048 sc1
  v_mul_f32 v160, v160, v208
  v_fmac_f32 v160, v32, v144
  v_mul_f32 v161, v161, v208
  v_mfma_f32_32x32x16_bf16 v[80:95], v[120:123], a[140:143], v[80:95]
  buffer_load_dwordx2 v[182:183], v22, s[4:7], s92 offen offset:768 sc1
  v_fmac_f32 v161, v33, v145
  v_mul_f32 v162, v162, v208
  v_fmac_f32 v162, v34, v146
  ds_read_b128 v[120:123], v21 offset:7168
  v_mfma_f32_32x32x16_bf16 v[64:79], v[96:99], a[16:19], v[64:79]
  s_add_u32 s47, s60, 20480
  buffer_load_dwordx4 a[220:223], v2, s[4:7], s47 offen offset:3072 sc1
  v_mul_f32 v163, v163, v208
  v_fmac_f32 v163, v35, v147
  v_mul_f32 v164, v164, v208
  v_mfma_f32_32x32x16_bf16 v[80:95], v[96:99], a[144:147], v[80:95]
  buffer_load_dwordx2 v[184:185], v22, s[4:7], s92 offen offset:1024 sc1
  v_fmac_f32 v164, v36, v148
  v_mul_f32 v165, v165, v208
  v_fmac_f32 v165, v37, v149
  ds_read_b128 v[96:99], v21 offset:8192
  v_mfma_f32_32x32x16_bf16 v[64:79], v[104:107], a[20:23], v[64:79]
  s_add_u32 s47, s60, 24576
  buffer_load_dwordx4 a[224:227], v2, s[4:7], s47 offen offset:0 sc1
  v_mul_f32 v166, v166, v208
  v_fmac_f32 v166, v38, v150
  v_mul_f32 v167, v167, v208
  v_mfma_f32_32x32x16_bf16 v[80:95], v[104:107], a[148:151], v[80:95]
  buffer_load_dwordx2 v[186:187], v22, s[4:7], s92 offen offset:1280 sc1
  v_fmac_f32 v167, v39, v151
  v_mul_f32 v168, v168, v208
  v_fmac_f32 v168, v40, v152
  ds_read_b128 v[104:107], v21 offset:9216
  s_waitcnt lgkmcnt(3)
  v_mfma_f32_32x32x16_bf16 v[64:79], v[112:115], a[24:27], v[64:79]
  s_add_u32 s47, s60, 24576
  buffer_load_dwordx4 a[228:231], v2, s[4:7], s47 offen offset:1024 sc1
  v_mul_f32 v169, v169, v208
  v_fmac_f32 v169, v41, v153
  v_mul_f32 v170, v170, v208
  v_mfma_f32_32x32x16_bf16 v[80:95], v[112:115], a[152:155], v[80:95]
  buffer_load_dwordx2 v[188:189], v22, s[4:7], s92 offen offset:1536 sc1
  v_fmac_f32 v170, v42, v154
  v_mul_f32 v171, v171, v208
  v_fmac_f32 v171, v43, v155
  ds_read_b128 v[112:115], v21 offset:10240
  s_waitcnt lgkmcnt(3)
  v_mfma_f32_32x32x16_bf16 v[64:79], v[120:123], a[28:31], v[64:79]
  s_add_u32 s47, s60, 24576
  buffer_load_dwordx4 a[232:235], v2, s[4:7], s47 offen offset:2048 sc1
  v_mul_f32 v172, v172, v208
  v_fmac_f32 v172, v44, v156
  v_mul_f32 v173, v173, v208
  v_mfma_f32_32x32x16_bf16 v[80:95], v[120:123], a[156:159], v[80:95]
  buffer_load_dwordx2 v[190:191], v22, s[4:7], s92 offen offset:1792 sc1
  v_fmac_f32 v173, v45, v157
  v_mul_f32 v174, v174, v208
  v_fmac_f32 v174, v46, v158
  ds_read_b128 v[120:123], v21 offset:11264
  s_waitcnt lgkmcnt(3)
  v_mfma_f32_32x32x16_bf16 v[64:79], v[96:99], a[32:35], v[64:79]
  s_add_u32 s47, s60, 24576
  buffer_load_dwordx4 a[236:239], v2, s[4:7], s47 offen offset:3072 sc1
  v_mul_f32 v175, v175, v208
  v_fmac_f32 v175, v47, v159
  v_cvt_pk_bf16_f32 v32, v160, v161
  v_mfma_f32_32x32x16_bf16 v[80:95], v[96:99], a[160:163], v[80:95]
  v_cvt_pk_bf16_f32 v33, v162, v163
  v_cvt_pk_bf16_f32 v34, v164, v165
  v_cvt_pk_bf16_f32 v35, v166, v167
  ds_read_b128 v[96:99], v21 offset:12288
  s_waitcnt lgkmcnt(3)
  v_mfma_f32_32x32x16_bf16 v[64:79], v[104:107], a[36:39], v[64:79]
  s_add_u32 s47, s60, 28672
  buffer_load_dwordx4 a[240:243], v2, s[4:7], s47 offen offset:0 sc1
  v_cvt_pk_bf16_f32 v36, v168, v169
  v_cvt_pk_bf16_f32 v37, v170, v171
  v_cvt_pk_bf16_f32 v38, v172, v173
  v_mfma_f32_32x32x16_bf16 v[80:95], v[104:107], a[164:167], v[80:95]
  v_cvt_pk_bf16_f32 v39, v174, v175
  v_add_u32 v133, 120832, v2
  ds_write_b128 v133, v[32:35]
  ds_read_b128 v[104:107], v21 offset:13312
  s_waitcnt lgkmcnt(4)
  v_mfma_f32_32x32x16_bf16 v[64:79], v[112:115], a[40:43], v[64:79]
  s_add_u32 s47, s60, 28672
  buffer_load_dwordx4 a[244:247], v2, s[4:7], s47 offen offset:1024 sc1
  ds_write_b128 v133, v[36:39] offset:1024
  ds_read_b128 v[144:147], v135 offset:256
  ds_read_b128 v[160:163], v135 offset:384
  s_waitcnt vmcnt(27)
  v_mfma_f32_32x32x16_bf16 v[80:95], v[112:115], a[168:171], v[80:95]
  ds_read_b128 v[148:151], v135 offset:288
  ds_read_b128 v[164:167], v135 offset:416
  ds_read_b128 v[152:155], v135 offset:320
  ds_read_b128 v[112:115], v21 offset:14336
  s_waitcnt lgkmcnt(10)
  v_mfma_f32_32x32x16_bf16 v[64:79], v[120:123], a[44:47], v[64:79]
  s_add_u32 s47, s60, 28672
  buffer_load_dwordx4 a[248:251], v2, s[4:7], s47 offen offset:2048 sc1
  ds_read_b128 v[168:171], v135 offset:448
  ds_read_b128 v[156:159], v135 offset:352
  ds_read_b128 v[172:175], v135 offset:480
  s_waitcnt vmcnt(27)
  v_mfma_f32_32x32x16_bf16 v[80:95], v[120:123], a[172:175], v[80:95]
  s_waitcnt lgkmcnt(0)
  v_mul_f32 v160, v160, v208
  v_fmac_f32 v160, v48, v144
  ds_read_b128 v[120:123], v21 offset:15360
  v_mfma_f32_32x32x16_bf16 v[64:79], v[96:99], a[48:51], v[64:79]
  s_add_u32 s47, s60, 28672
  buffer_load_dwordx4 a[252:255], v2, s[4:7], s47 offen offset:3072 sc1
  v_mul_f32 v161, v161, v208
  v_fmac_f32 v161, v49, v145
  v_mul_f32 v162, v162, v208
  s_waitcnt vmcnt(27)
  v_mfma_f32_32x32x16_bf16 v[80:95], v[96:99], a[176:179], v[80:95]
  v_fmac_f32 v162, v50, v146
  v_mul_f32 v163, v163, v208
  v_fmac_f32 v163, v51, v147
  ds_read_b128 v[96:99], v21 offset:16384
  v_mfma_f32_32x32x16_bf16 v[64:79], v[104:107], a[52:55], v[64:79]
  v_mul_f32 v164, v164, v208
  v_fmac_f32 v164, v52, v148
  v_mul_f32 v165, v165, v208
  s_waitcnt vmcnt(26)
  v_mfma_f32_32x32x16_bf16 v[80:95], v[104:107], a[180:183], v[80:95]
  v_fmac_f32 v165, v53, v149
  v_mul_f32 v166, v166, v208
  v_fmac_f32 v166, v54, v150
  ds_read_b128 v[104:107], v21 offset:17408
  v_mfma_f32_32x32x16_bf16 v[64:79], v[112:115], a[56:59], v[64:79]
  v_mul_f32 v167, v167, v208
  v_fmac_f32 v167, v55, v151
  v_mul_f32 v168, v168, v208
  s_waitcnt vmcnt(25)
  v_mfma_f32_32x32x16_bf16 v[80:95], v[112:115], a[184:187], v[80:95]
  v_fmac_f32 v168, v56, v152
  v_mul_f32 v169, v169, v208
  v_fmac_f32 v169, v57, v153
  ds_read_b128 v[112:115], v21 offset:18432
  s_waitcnt lgkmcnt(3)
  v_mfma_f32_32x32x16_bf16 v[64:79], v[120:123], a[60:63], v[64:79]
  v_mul_f32 v170, v170, v208
  v_fmac_f32 v170, v58, v154
  v_mul_f32 v171, v171, v208
  s_waitcnt vmcnt(24)
  v_mfma_f32_32x32x16_bf16 v[80:95], v[120:123], a[188:191], v[80:95]
  v_fmac_f32 v171, v59, v155
  v_mul_f32 v172, v172, v208
  v_fmac_f32 v172, v60, v156
  ds_read_b128 v[120:123], v21 offset:19456
  s_waitcnt lgkmcnt(3)
  v_mfma_f32_32x32x16_bf16 v[64:79], v[96:99], a[64:67], v[64:79]
  v_mul_f32 v173, v173, v208
  v_fmac_f32 v173, v61, v157
  v_mul_f32 v174, v174, v208
  s_waitcnt vmcnt(23)
  v_mfma_f32_32x32x16_bf16 v[80:95], v[96:99], a[192:195], v[80:95]
  v_fmac_f32 v174, v62, v158
  v_mul_f32 v175, v175, v208
  v_fmac_f32 v175, v63, v159
  ds_read_b128 v[96:99], v21 offset:20480
  s_waitcnt lgkmcnt(3)
  v_mfma_f32_32x32x16_bf16 v[64:79], v[104:107], a[68:71], v[64:79]
  v_cvt_pk_bf16_f32 v48, v160, v161
  v_cvt_pk_bf16_f32 v49, v162, v163
  v_cvt_pk_bf16_f32 v50, v164, v165
  s_waitcnt vmcnt(22)
  v_mfma_f32_32x32x16_bf16 v[80:95], v[104:107], a[196:199], v[80:95]
  v_cvt_pk_bf16_f32 v51, v166, v167
  v_cvt_pk_bf16_f32 v52, v168, v169
  v_cvt_pk_bf16_f32 v53, v170, v171
  ds_read_b128 v[104:107], v21 offset:21504
  s_waitcnt lgkmcnt(3)
  v_mfma_f32_32x32x16_bf16 v[64:79], v[112:115], a[72:75], v[64:79]
  v_cvt_pk_bf16_f32 v54, v172, v173
  v_cvt_pk_bf16_f32 v55, v174, v175
  v_add_u32 v133, 124928, v2
  s_waitcnt vmcnt(21)
  v_mfma_f32_32x32x16_bf16 v[80:95], v[112:115], a[200:203], v[80:95]
  ds_write_b128 v133, v[48:51]
  ds_write_b128 v133, v[52:55] offset:1024
  s_waitcnt vmcnt(5)
  v_add_f32 v176, v176, v178
  v_add_f32 v177, v177, v179
  v_add_f32 v176, v176, v180
  ds_read_b128 v[112:115], v21 offset:22528
  s_waitcnt lgkmcnt(5)
  v_mfma_f32_32x32x16_bf16 v[64:79], v[120:123], a[76:79], v[64:79]
  v_add_f32 v177, v177, v181
  v_add_f32 v176, v176, v182
  v_add_f32 v177, v177, v183
  v_mfma_f32_32x32x16_bf16 v[80:95], v[120:123], a[204:207], v[80:95]
  v_add_f32 v176, v176, v184
  v_add_f32 v177, v177, v185
  v_add_f32 v176, v176, v186
  ds_read_b128 v[120:123], v21 offset:23552
  s_waitcnt lgkmcnt(5)
  v_mfma_f32_32x32x16_bf16 v[64:79], v[96:99], a[80:83], v[64:79]
  v_add_f32 v177, v177, v187
  v_add_f32 v176, v176, v188
  v_add_f32 v177, v177, v189
  v_mfma_f32_32x32x16_bf16 v[80:95], v[96:99], a[208:211], v[80:95]
  v_add_f32 v176, v176, v190
  v_add_f32 v177, v177, v191
  s_nop 1
  v_permlane32_swap_b32 v176, v177
  ds_read_b128 v[96:99], v21 offset:24576
  s_waitcnt lgkmcnt(5)
  v_mfma_f32_32x32x16_bf16 v[64:79], v[104:107], a[84:87], v[64:79]
  v_add_f32 v176, v176, v177
  v_mov_b32 v177, v176
  s_nop 1
  v_permlane32_swap_b32 v176, v177
  v_mfma_f32_32x32x16_bf16 v[80:95], v[104:107], a[212:215], v[80:95]
  v_mul_f32 v130, 0x3b000000, v176
  v_mul_f32 v177, 0x3b000000, v177
  v_fma_f32 v177, -v130, v130, v177
  ds_read_b128 v[104:107], v21 offset:25600
  s_waitcnt lgkmcnt(3)
  v_mfma_f32_32x32x16_bf16 v[64:79], v[112:115], a[88:91], v[64:79]
  v_add_f32 v177, 0x3727c5ac, v177
  v_rsq_f32 v131, v177
  s_nop 0
  v_mul_f32 v130, v130, v131
  v_mfma_f32_32x32x16_bf16 v[80:95], v[112:115], a[216:219], v[80:95]
  v_sub_f32 v130, 0, v130
  v_cmp_gt_u32 vcc, 32, v1
  s_nop 1
  ds_read_b128 v[112:115], v21 offset:26624
  s_waitcnt lgkmcnt(3)
  v_mfma_f32_32x32x16_bf16 v[64:79], v[120:123], a[92:95], v[64:79]
  v_cndmask_b32 v130, v130, v131, vcc
  v_add_u32 v131, 131584, v3
  ds_write_b32 v131, v130
  v_mfma_f32_32x32x16_bf16 v[80:95], v[120:123], a[220:223], v[80:95]
  ds_read_b128 v[120:123], v21 offset:27648
  s_waitcnt lgkmcnt(4)
  v_mfma_f32_32x32x16_bf16 v[64:79], v[96:99], a[96:99], v[64:79]
  v_mfma_f32_32x32x16_bf16 v[80:95], v[96:99], a[224:227], v[80:95]
  ds_read_b128 v[96:99], v21 offset:28672
  s_waitcnt lgkmcnt(4)
  v_mfma_f32_32x32x16_bf16 v[64:79], v[104:107], a[100:103], v[64:79]
  v_mfma_f32_32x32x16_bf16 v[80:95], v[104:107], a[228:231], v[80:95]
  ds_read_b128 v[104:107], v21 offset:29696
  s_waitcnt lgkmcnt(4)
  v_mfma_f32_32x32x16_bf16 v[64:79], v[112:115], a[104:107], v[64:79]
  v_mfma_f32_32x32x16_bf16 v[80:95], v[112:115], a[232:235], v[80:95]
  ds_read_b128 v[112:115], v21 offset:30720
  s_waitcnt lgkmcnt(3)
  v_mfma_f32_32x32x16_bf16 v[64:79], v[120:123], a[108:111], v[64:79]
  s_waitcnt vmcnt(4)
  v_mfma_f32_32x32x16_bf16 v[80:95], v[120:123], a[236:239], v[80:95]
  ds_read_b128 v[120:123], v21 offset:31744
  s_waitcnt lgkmcnt(3)
  v_mfma_f32_32x32x16_bf16 v[64:79], v[96:99], a[112:115], v[64:79]
  s_waitcnt vmcnt(3)
  v_mfma_f32_32x32x16_bf16 v[80:95], v[96:99], a[240:243], v[80:95]
  s_waitcnt lgkmcnt(2)
  v_mfma_f32_32x32x16_bf16 v[64:79], v[104:107], a[116:119], v[64:79]
  s_waitcnt vmcnt(2)
  v_mfma_f32_32x32x16_bf16 v[80:95], v[104:107], a[244:247], v[80:95]
  s_waitcnt lgkmcnt(1)
  v_mfma_f32_32x32x16_bf16 v[64:79], v[112:115], a[120:123], v[64:79]
  s_waitcnt vmcnt(1)
  v_mfma_f32_32x32x16_bf16 v[80:95], v[112:115], a[248:251], v[80:95]
  s_waitcnt lgkmcnt(0)
  v_mfma_f32_32x32x16_bf16 v[64:79], v[120:123], a[124:127], v[64:79]
  s_waitcnt vmcnt(0)
  v_mfma_f32_32x32x16_bf16 v[80:95], v[120:123], a[252:255], v[80:95]
  s_waitcnt lgkmcnt(0)
  ds_read_b128 v[144:147], v135 offset:512
  ds_read_b128 v[160:163], v135 offset:640
  ds_read_b128 v[148:151], v135 offset:544
  ds_read_b128 v[164:167], v135 offset:672
  ds_read_b128 v[152:155], v135 offset:576
  ds_read_b128 v[168:171], v135 offset:704
  ds_read_b128 v[156:159], v135 offset:608
  ds_read_b128 v[172:175], v135 offset:736
  s_waitcnt lgkmcnt(0)
  v_mov_b32 v128, v208
  v_pk_mul_f32 v[160:161], v[160:161], v[128:129] op_sel_hi:[1,0]
  v_pk_mul_f32 v[162:163], v[162:163], v[128:129] op_sel_hi:[1,0]
  v_pk_mul_f32 v[164:165], v[164:165], v[128:129] op_sel_hi:[1,0]
  v_pk_mul_f32 v[166:167], v[166:167], v[128:129] op_sel_hi:[1,0]
  v_pk_mul_f32 v[168:169], v[168:169], v[128:129] op_sel_hi:[1,0]
  v_pk_mul_f32 v[170:171], v[170:171], v[128:129] op_sel_hi:[1,0]
  v_pk_mul_f32 v[172:173], v[172:173], v[128:129] op_sel_hi:[1,0]
  v_pk_mul_f32 v[174:175], v[174:175], v[128:129] op_sel_hi:[1,0]
  v_pk_fma_f32 v[160:161], v[64:65], v[144:145], v[160:161]
  v_pk_fma_f32 v[162:163], v[66:67], v[146:147], v[162:163]
  v_pk_fma_f32 v[164:165], v[68:69], v[148:149], v[164:165]
  v_pk_fma_f32 v[166:167], v[70:71], v[150:151], v[166:167]
  v_pk_fma_f32 v[168:169], v[72:73], v[152:153], v[168:169]
  v_pk_fma_f32 v[170:171], v[74:75], v[154:155], v[170:171]
  v_pk_fma_f32 v[172:173], v[76:77], v[156:157], v[172:173]
  v_pk_fma_f32 v[174:175], v[78:79], v[158:159], v[174:175]
  v_cvt_pk_bf16_f32 v64, v160, v161
  v_cvt_pk_bf16_f32 v65, v162, v163
  v_cvt_pk_bf16_f32 v66, v164, v165
  v_cvt_pk_bf16_f32 v67, v166, v167
  v_cvt_pk_bf16_f32 v68, v168, v169
  v_cvt_pk_bf16_f32 v69, v170, v171
  v_cvt_pk_bf16_f32 v70, v172, v173
  v_cvt_pk_bf16_f32 v71, v174, v175
  v_add_u32 v133, 129024, v2
  ds_write_b128 v133, v[64:67]
  ds_write_b128 v133, v[68:71] offset:1024
  ds_read_b128 v[96:99], v135 offset:512
  ds_read_b128 v[112:115], v135 offset:640
  ds_read_b128 v[100:103], v135 offset:544
  ds_read_b128 v[116:119], v135 offset:672
  ds_read_b128 v[104:107], v135 offset:576
  ds_read_b128 v[120:123], v135 offset:704
  ds_read_b128 v[108:111], v135 offset:608
  ds_read_b128 v[124:127], v135 offset:736
  s_waitcnt lgkmcnt(0)
  v_mov_b32 v128, v209
  v_pk_mul_f32 v[112:113], v[112:113], v[128:129] op_sel_hi:[1,0]
  v_pk_mul_f32 v[114:115], v[114:115], v[128:129] op_sel_hi:[1,0]
  v_pk_mul_f32 v[116:117], v[116:117], v[128:129] op_sel_hi:[1,0]
  v_pk_mul_f32 v[118:119], v[118:119], v[128:129] op_sel_hi:[1,0]
  v_pk_mul_f32 v[120:121], v[120:121], v[128:129] op_sel_hi:[1,0]
  v_pk_mul_f32 v[122:123], v[122:123], v[128:129] op_sel_hi:[1,0]
  v_pk_mul_f32 v[124:125], v[124:125], v[128:129] op_sel_hi:[1,0]
  v_pk_mul_f32 v[126:127], v[126:127], v[128:129] op_sel_hi:[1,0]
  v_pk_fma_f32 v[112:113], v[80:81], v[96:97], v[112:113]
  v_pk_fma_f32 v[114:115], v[82:83], v[98:99], v[114:115]
  v_pk_fma_f32 v[116:117], v[84:85], v[100:101], v[116:117]
  v_pk_fma_f32 v[118:119], v[86:87], v[102:103], v[118:119]
  v_pk_fma_f32 v[120:121], v[88:89], v[104:105], v[120:121]
  v_pk_fma_f32 v[122:123], v[90:91], v[106:107], v[122:123]
  v_pk_fma_f32 v[124:125], v[92:93], v[108:109], v[124:125]
  v_pk_fma_f32 v[126:127], v[94:95], v[110:111], v[126:127]
  v_cvt_pk_bf16_f32 v80, v112, v113
  v_cvt_pk_bf16_f32 v81, v114, v115
  v_cvt_pk_bf16_f32 v82, v116, v117
  v_cvt_pk_bf16_f32 v83, v118, v119
  v_cvt_pk_bf16_f32 v84, v120, v121
  v_cvt_pk_bf16_f32 v85, v122, v123
  v_cvt_pk_bf16_f32 v86, v124, v125
  v_cvt_pk_bf16_f32 v87, v126, v127
  v_add_u32 v133, 126976, v2
  ds_write_b128 v133, v[80:83]
  ds_write_b128 v133, v[84:87] offset:1024
G2GD_71:
  s_waitcnt lgkmcnt(0)
  s_barrier
  s_lshl_b32 s40, s18, 10
  s_add_u32 s40, s40, 98304
  v_add_u32 v20, s40, v2
  s_lshr_b32 s41, s18, 1
  s_lshl_b32 s41, s41, 11
  s_add_u32 s41, s41, 118784
  v_add_u32 v21, s41, v2
  ds_read_b128 v[48:51], v20 offset:16384
  ds_read_b128 v[32:35], v20 offset:0
  ds_read_b128 v[40:43], v20 offset:8192
  ds_read_b128 v[36:39], v20 offset:4096
  ds_read_b128 v[44:47], v20 offset:12288
  ds_read_b128 v[52:55], v21 offset:0
  ds_read_b128 v[56:59], v21 offset:1024
  ds_read_b128 v[60:63], v21 offset:4096
  ds_read_b128 v[64:67], v21 offset:5120
  ds_read_b128 v[68:71], v21 offset:8192
  ds_read_b128 v[72:75], v21 offset:9216
  s_lshl_b32 s40, s17, 2
  s_add_u32 s40, s40, s18
  s_lshl_b32 s40, s40, 10
  s_lshl_b32 s41, s16, 16
  s_add_u32 s40, s40, s41
  s_add_u32 s40, s40, s35
  s_add_u32 s41, s40, 32768
  s_mov_b32 s88, s40
  s_mov_b32 s89, s41
  s_lshl_b32 s40, s18, 14
  s_add_u32 s62, s40, 0
  s_lshl_b32 s63, s17, 16
  s_add_u32 s63, s63, s40
  s_add_u32 s63, s63, 3702784
  s_mov_b32 m0, s62
  s_add_u32 s62, s62, 4096
  buffer_load_dwordx4 v2, s[4:7], s63 offen offset:0 sc1 lds
  buffer_load_dwordx4 v2, s[4:7], s63 offen offset:1024 sc1 lds
  buffer_load_dwordx4 v2, s[4:7], s63 offen offset:2048 sc1 lds
  buffer_load_dwordx4 v2, s[4:7], s63 offen offset:3072 sc1 lds
  s_add_u32 s63, s63, 4096
  s_mov_b32 m0, s62
  s_add_u32 s62, s62, 4096
  buffer_load_dwordx4 v2, s[4:7], s63 offen offset:0 sc1 lds
  s_waitcnt lgkmcnt(8)
  v_mfma_f32_32x32x16_bf16 v[80:95], v[40:43], v[32:35], v[212:227]
  v_mfma_f32_32x32x16_bf16 v[112:127], v[48:51], v[32:35], v[228:243]
  s_waitcnt lgkmcnt(6)
  v_mfma_f32_32x32x16_bf16 v[96:111], v[44:47], v[36:39], v[212:227]
  v_mfma_f32_32x32x16_bf16 v[128:143], v[48:51], v[36:39], v[228:243]
  buffer_load_dwordx4 v2, s[4:7], s63 offen offset:1024 sc1 lds
  buffer_load_dwordx4 v2, s[4:7], s63 offen offset:2048 sc1 lds
  buffer_load_dwordx4 v2, s[4:7], s63 offen offset:3072 sc1 lds
  s_add_u32 s63, s63, 4096
  v_mov_b32 v26, 0x3f803f80
  s_nop 2
  v_max3_f32 v22, v80, v81, v82
  v_max3_f32 v22, v22, v83, v84
  v_max3_f32 v22, v22, v85, v86
  v_max3_f32 v22, v22, v87, v88
  v_max3_f32 v22, v22, v89, v90
  v_max3_f32 v22, v22, v91, v92
  v_max3_f32 v22, v22, v93, v94
  v_max3_f32 v22, v22, v95, v116
  v_max3_f32 v22, v22, v117, v118
  v_max_f32 v22, v22, v119
  v_max3_f32 v24, v96, v97, v98
  v_max3_f32 v24, v24, v99, v100
  v_max3_f32 v24, v24, v101, v102
  v_max3_f32 v24, v24, v103, v104
  v_max3_f32 v24, v24, v105, v106
  v_max3_f32 v24, v24, v107, v108
  v_max3_f32 v24, v24, v109, v110
  v_max3_f32 v24, v24, v111, v140
  v_max3_f32 v24, v24, v141, v142
  v_max_f32 v24, v24, v143
  v_mov_b32 v23, v22
  v_mov_b32 v25, v24
  s_nop 0
  v_permlane32_swap_b32 v22, v23
  v_permlane32_swap_b32 v24, v25
  v_max_f32 v22, v22, v23
  v_max_f32 v24, v24, v25
  v_pk_add_f32 v[80:81], v[80:81], v[22:23] op_sel_hi:[1,0] neg_lo:[0,1] neg_hi:[0,1]
  v_pk_add_f32 v[82:83], v[82:83], v[22:23] op_sel_hi:[1,0] neg_lo:[0,1] neg_hi:[0,1]
  v_pk_add_f32 v[84:85], v[84:85], v[22:23] op_sel_hi:[1,0] neg_lo:[0,1] neg_hi:[0,1]
  v_pk_add_f32 v[86:87], v[86:87], v[22:23] op_sel_hi:[1,0] neg_lo:[0,1] neg_hi:[0,1]
  v_pk_add_f32 v[88:89], v[88:89], v[22:23] op_sel_hi:[1,0] neg_lo:[0,1] neg_hi:[0,1]
  v_pk_add_f32 v[90:91], v[90:91], v[22:23] op_sel_hi:[1,0] neg_lo:[0,1] neg_hi:[0,1]
  v_pk_add_f32 v[92:93], v[92:93], v[22:23] op_sel_hi:[1,0] neg_lo:[0,1] neg_hi:[0,1]
  v_pk_add_f32 v[94:95], v[94:95], v[22:23] op_sel_hi:[1,0] neg_lo:[0,1] neg_hi:[0,1]
  v_pk_add_f32 v[116:117], v[116:117], v[22:23] op_sel_hi:[1,0] neg_lo:[0,1] neg_hi:[0,1]
  v_pk_add_f32 v[118:119], v[118:119], v[22:23] op_sel_hi:[1,0] neg_lo:[0,1] neg_hi:[0,1]
  v_pk_add_f32 v[96:97], v[96:97], v[24:25] op_sel_hi:[1,0] neg_lo:[0,1] neg_hi:[0,1]
  v_pk_add_f32 v[98:99], v[98:99], v[24:25] op_sel_hi:[1,0] neg_lo:[0,1] neg_hi:[0,1]
  v_pk_add_f32 v[100:101], v[100:101], v[24:25] op_sel_hi:[1,0] neg_lo:[0,1] neg_hi:[0,1]
  v_pk_add_f32 v[102:103], v[102:103], v[24:25] op_sel_hi:[1,0] neg_lo:[0,1] neg_hi:[0,1]
  v_pk_add_f32 v[104:105], v[104:105], v[24:25] op_sel_hi:[1,0] neg_lo:[0,1] neg_hi:[0,1]
  v_pk_add_f32 v[106:107], v[106:107], v[24:25] op_sel_hi:[1,0] neg_lo:[0,1] neg_hi:[0,1]
  v_pk_add_f32 v[108:109], v[108:109], v[24:25] op_sel_hi:[1,0] neg_lo:[0,1] neg_hi:[0,1]
  v_pk_add_f32 v[110:111], v[110:111], v[24:25] op_sel_hi:[1,0] neg_lo:[0,1] neg_hi:[0,1]
  v_pk_add_f32 v[140:141], v[140:141], v[24:25] op_sel_hi:[1,0] neg_lo:[0,1] neg_hi:[0,1]
  v_pk_add_f32 v[142:143], v[142:143], v[24:25] op_sel_hi:[1,0] neg_lo:[0,1] neg_hi:[0,1]
  v_exp_f32 v80, v80
  v_exp_f32 v81, v81
  v_exp_f32 v82, v82
  v_exp_f32 v83, v83
  v_exp_f32 v84, v84
  s_mov_b32 m0, s62
  s_add_u32 s62, s62, 4096
  buffer_load_dwordx4 v2, s[4:7], s63 offen offset:0 sc1 lds
  v_exp_f32 v85, v85
  v_exp_f32 v86, v86
  v_exp_f32 v87, v87
  v_exp_f32 v88, v88
  v_exp_f32 v89, v89
  buffer_load_dwordx4 v2, s[4:7], s63 offen offset:1024 sc1 lds
  v_exp_f32 v90, v90
  v_exp_f32 v91, v91
  v_exp_f32 v92, v92
  v_exp_f32 v93, v93
  v_exp_f32 v94, v94
  buffer_load_dwordx4 v2, s[4:7], s63 offen offset:2048 sc1 lds
  v_exp_f32 v95, v95
  v_exp_f32 v116, v116
  v_exp_f32 v117, v117
  v_exp_f32 v118, v118
  v_exp_f32 v119, v119
  buffer_load_dwordx4 v2, s[4:7], s63 offen offset:3072 sc1 lds
  s_add_u32 s63, s63, 4096
  v_mov_b32 v184, 0
  v_mov_b32 v185, 0
  v_cvt_pk_bf16_f32 v176, v80, v81
  v_cvt_pk_bf16_f32 v177, v82, v83
  v_cvt_pk_bf16_f32 v178, v84, v85
  v_cvt_pk_bf16_f32 v179, v86, v87
  v_cvt_pk_bf16_f32 v180, v88, v89
  v_cvt_pk_bf16_f32 v181, v90, v91
  v_cvt_pk_bf16_f32 v182, v92, v93
  v_cvt_pk_bf16_f32 v183, v94, v95
  v_cvt_pk_bf16_f32 v186, v116, v117
  v_cvt_pk_bf16_f32 v187, v118, v119
  v_mov_b32 v22, 0
  v_mov_b32 v23, 0
  v_dot2c_f32_bf16 v22, v26, v176
  v_dot2c_f32_bf16 v23, v26, v177
  v_dot2c_f32_bf16 v22, v26, v178
  v_dot2c_f32_bf16 v23, v26, v179
  v_dot2c_f32_bf16 v22, v26, v180
  v_dot2c_f32_bf16 v23, v26, v181
  v_dot2c_f32_bf16 v22, v26, v182
  v_dot2c_f32_bf16 v23, v26, v183
  v_dot2c_f32_bf16 v22, v26, v186
  v_dot2c_f32_bf16 v23, v26, v187
  s_waitcnt lgkmcnt(0)
  v_mfma_f32_32x32x16_bf16 v[144:159], v[52:55], v[176:179], 0
  v_mfma_f32_32x32x16_bf16 v[144:159], v[56:59], v[180:183], v[144:159]
  v_mfma_f32_32x32x16_bf16 v[144:159], v[68:71], v[184:187], v[144:159]
  v_exp_f32 v96, v96
  v_exp_f32 v97, v97
  v_exp_f32 v98, v98
  v_exp_f32 v99, v99
  v_exp_f32 v100, v100
  s_mov_b32 m0, s62
  s_add_u32 s62, s62, 4096
  buffer_load_dwordx4 v2, s[4:7], s63 offen offset:0 sc1 lds
  v_exp_f32 v101, v101
  v_exp_f32 v102, v102
  v_exp_f32 v103, v103
  v_exp_f32 v104, v104
  v_exp_f32 v105, v105
  buffer_load_dwordx4 v2, s[4:7], s63 offen offset:1024 sc1 lds
  v_exp_f32 v106, v106
  v_exp_f32 v107, v107
  v_exp_f32 v108, v108
  v_exp_f32 v109, v109
  v_exp_f32 v110, v110
  buffer_load_dwordx4 v2, s[4:7], s63 offen offset:2048 sc1 lds
  v_exp_f32 v111, v111
  v_exp_f32 v140, v140
  v_exp_f32 v141, v141
  v_exp_f32 v142, v142
  v_exp_f32 v143, v143
  buffer_load_dwordx4 v2, s[4:7], s63 offen offset:3072 sc1 lds
  s_add_u32 s63, s63, 4096
  v_mov_b32 v200, 0
  v_mov_b32 v201, 0
  v_cvt_pk_bf16_f32 v192, v96, v97
  v_cvt_pk_bf16_f32 v193, v98, v99
  v_cvt_pk_bf16_f32 v194, v100, v101
  v_cvt_pk_bf16_f32 v195, v102, v103
  v_cvt_pk_bf16_f32 v196, v104, v105
  v_cvt_pk_bf16_f32 v197, v106, v107
  v_cvt_pk_bf16_f32 v198, v108, v109
  v_cvt_pk_bf16_f32 v199, v110, v111
  v_cvt_pk_bf16_f32 v202, v140, v141
  v_cvt_pk_bf16_f32 v203, v142, v143
  v_mov_b32 v24, 0
  v_mov_b32 v25, 0
  v_dot2c_f32_bf16 v24, v26, v192
  v_dot2c_f32_bf16 v25, v26, v193
  v_dot2c_f32_bf16 v24, v26, v194
  v_dot2c_f32_bf16 v25, v26, v195
  v_dot2c_f32_bf16 v24, v26, v196
  v_dot2c_f32_bf16 v25, v26, v197
  v_dot2c_f32_bf16 v24, v26, v198
  v_dot2c_f32_bf16 v25, v26, v199
  v_dot2c_f32_bf16 v24, v26, v202
  v_dot2c_f32_bf16 v25, v26, v203
  v_mfma_f32_32x32x16_bf16 v[160:175], v[60:63], v[192:195], 0
  v_mfma_f32_32x32x16_bf16 v[160:175], v[64:67], v[196:199], v[160:175]
  v_mfma_f32_32x32x16_bf16 v[160:175], v[72:75], v[200:203], v[160:175]
  v_add_f32 v22, v22, v23
  v_add_f32 v24, v24, v25
  v_mov_b32 v23, v22
  v_mov_b32 v25, v24
  s_nop 0
  v_permlane32_swap_b32 v22, v23
  v_permlane32_swap_b32 v24, v25
  v_add_f32 v22, v22, v23
  v_add_f32 v24, v24, v25
  v_rcp_f32 v22, v22
  v_rcp_f32 v24, v24
  s_bitcmp1_b32 s18, 0
  s_cbranch_scc1 ODD_76
  v_pk_mul_f32 v[144:145], v[144:145], v[22:23] op_sel_hi:[1,0]
  v_pk_mul_f32 v[146:147], v[146:147], v[22:23] op_sel_hi:[1,0]
  v_pk_mul_f32 v[148:149], v[148:149], v[22:23] op_sel_hi:[1,0]
  v_pk_mul_f32 v[150:151], v[150:151], v[22:23] op_sel_hi:[1,0]
  v_cvt_pk_bf16_f32 v28, v144, v145
  v_cvt_pk_bf16_f32 v29, v146, v147
  v_cvt_pk_bf16_f32 v30, v148, v149
  v_cvt_pk_bf16_f32 v31, v150, v151
  v_pk_mul_f32 v[160:161], v[160:161], v[24:25] op_sel_hi:[1,0]
  v_pk_mul_f32 v[162:163], v[162:163], v[24:25] op_sel_hi:[1,0]
  v_pk_mul_f32 v[164:165], v[164:165], v[24:25] op_sel_hi:[1,0]
  v_pk_mul_f32 v[166:167], v[166:167], v[24:25] op_sel_hi:[1,0]
  v_cvt_pk_bf16_f32 v32, v160, v161
  v_cvt_pk_bf16_f32 v33, v162, v163
  v_cvt_pk_bf16_f32 v34, v164, v165
  v_cvt_pk_bf16_f32 v35, v166, v167
  s_branch ODDD_77
ODD_76:
  v_pk_mul_f32 v[152:153], v[152:153], v[22:23] op_sel_hi:[1,0]
  v_pk_mul_f32 v[154:155], v[154:155], v[22:23] op_sel_hi:[1,0]
  v_pk_mul_f32 v[156:157], v[156:157], v[22:23] op_sel_hi:[1,0]
  v_pk_mul_f32 v[158:159], v[158:159], v[22:23] op_sel_hi:[1,0]
  v_cvt_pk_bf16_f32 v28, v152, v153
  v_cvt_pk_bf16_f32 v29, v154, v155
  v_cvt_pk_bf16_f32 v30, v156, v157
  v_cvt_pk_bf16_f32 v31, v158, v159
  v_pk_mul_f32 v[168:169], v[168:169], v[24:25] op_sel_hi:[1,0]
  v_pk_mul_f32 v[170:171], v[170:171], v[24:25] op_sel_hi:[1,0]
  v_pk_mul_f32 v[172:173], v[172:173], v[24:25] op_sel_hi:[1,0]
  v_pk_mul_f32 v[174:175], v[174:175], v[24:25] op_sel_hi:[1,0]
  v_cvt_pk_bf16_f32 v32, v168, v169
  v_cvt_pk_bf16_f32 v33, v170, v171
  v_cvt_pk_bf16_f32 v34, v172, v173
  v_cvt_pk_bf16_f32 v35, v174, v175
ODDD_77:
  s_cmp_eq_u32 s39, 1
  s_cbranch_scc1 FAST_78
  buffer_store_dwordx4 v[28:31], v2, s[4:7], s88 offen offset:0 sc1
  buffer_store_dwordx4 v[32:35], v2, s[4:7], s89 offen offset:0 sc1
  s_branch MDONE_79
FAST_78:
  buffer_store_dwordx4 v[28:31], v2, s[4:7], s88 offen offset:0
  buffer_store_dwordx4 v[32:35], v2, s[4:7], s89 offen offset:0
MDONE_79:
  s_cmp_eq_u32 s22, 0
  s_cbranch_scc1 NOTLAST_80
  s_lshl_b32 s61, s16, 7
  s_add_u32 s61, s61, s38
  s_add_u32 s61, s61, 8192
  s_waitcnt vmcnt(0)
  s_barrier
  s_cmp_lg_u32 s18, 0
  s_cbranch_scc1 SYNCA_81
  s_mov_b64 exec, 1
  s_cmp_eq_u32 s39, 1
  s_cbranch_scc1 FAST_83
  buffer_store_dword v245, v244, s[4:7], s61 offen sc1
  s_branch MDONE_84
FAST_83:
  buffer_store_dword v245, v244, s[4:7], s61 offen
MDONE_84:
  s_mov_b64 exec, -1
  buffer_load_dword v247, v246, s[4:7], s61 offen sc1
SYNCA_81:
  v_and_b32 v250, 31, v1
  v_lshlrev_b32 v250, 11, v250
  v_lshrrev_b32 v18, 5, v1
  v_lshl_add_u32 v250, v18, 4, v250
  s_lshl_b32 s96, s16, 6
  s_add_u32 s96, s96, s19
  s_lshl_b32 s96, s96, 10
  s_lshl_b32 s41, s27, 6
  s_add_u32 s96, s96, s41
  s_cmp_lg_u32 s18, 0
  s_cbranch_scc1 SYNC_82
  s_mov_b32 s52, 0
  s_waitcnt vmcnt(0)
  v_cmp_ne_u32 vcc, s21, v247
  s_nop 4
  s_cbranch_vccz SYNC_82
POLL_85:
  buffer_load_dword v247, v246, s[4:7], s61 offen sc1
  s_waitcnt vmcnt(0)
  v_cmp_ne_u32 vcc, s21, v247
  s_nop 4
  s_cbranch_vccz SYNC_82
  s_add_u32 s52, s52, 1
  s_cmp_lt_u32 s52, 400000
  s_cbranch_scc1 POLL_85
  s_branch L_END
SYNC_82:
  s_waitcnt vmcnt(0)
  s_barrier
  s_lshl_b32 s91, s26, 15
  s_lshl_b32 s41, s20, 14
  s_add_u32 s91, s91, s41
  s_add_u32 s91, s91, s35
  buffer_load_dwordx4 v[16:19], v2, s[4:7], s91 offen offset:0 sc1
  buffer_load_dwordx4 v[20:23], v2, s[4:7], s91 offen offset:1024 sc1
  buffer_load_dwordx4 v[24:27], v2, s[4:7], s91 offen offset:2048 sc1
  buffer_load_dwordx4 v[28:31], v2, s[4:7], s91 offen offset:3072 sc1
  s_add_u32 s91, s91, 4096
  buffer_load_dwordx4 v[32:35], v2, s[4:7], s91 offen offset:0 sc1
  buffer_load_dwordx4 v[36:39], v2, s[4:7], s91 offen offset:1024 sc1
  buffer_load_dwordx4 v[40:43], v2, s[4:7], s91 offen offset:2048 sc1
  buffer_load_dwordx4 v[44:47], v2, s[4:7], s91 offen offset:3072 sc1
  s_lshl_b32 s42, s20, 14
  s_lshl_b32 s43, s20, 15
  s_add_u32 s43, s43, s42
  s_add_u32 s43, s43, 0
  v_add_u32 v254, s43, v2
  s_xor_b32 s43, s20, 1
  s_lshl_b32 s43, s43, 15
  s_add_u32 s43, s43, s42
  s_add_u32 s43, s43, 0
  v_add_u32 v255, s43, v2
  ds_read_b128 v[112:115], v254 offset:0
  ds_read_b128 v[116:119], v255 offset:0
  ds_read_b128 v[120:123], v254 offset:1024
  ds_read_b128 v[124:127], v255 offset:1024
  ds_read_b128 v[128:131], v254 offset:2048
  ds_read_b128 v[132:135], v255 offset:2048
  ds_read_b128 v[136:139], v254 offset:3072
  ds_read_b128 v[140:143], v255 offset:3072
  s_add_u32 s91, s91, 4096
  buffer_load_dwordx4 v[48:51], v2, s[4:7], s91 offen offset:0 sc1
  s_waitcnt vmcnt(8)
  s_waitcnt lgkmcnt(6)
  v_mfma_f32_32x32x16_bf16 v[80:95], v[112:115], v[16:19], 0
  v_mfma_f32_32x32x16_bf16 v[96:111], v[116:119], v[16:19], 0
  ds_read_b128 v[112:115], v254 offset:4096
  ds_read_b128 v[116:119], v255 offset:4096
  buffer_load_dwordx4 v[52:55], v2, s[4:7], s91 offen offset:1024 sc1
  s_waitcnt vmcnt(8)
  s_waitcnt lgkmcnt(6)
  v_mfma_f32_32x32x16_bf16 v[80:95], v[120:123], v[20:23], v[80:95]
  v_mfma_f32_32x32x16_bf16 v[96:111], v[124:127], v[20:23], v[96:111]
  ds_read_b128 v[120:123], v254 offset:5120
  ds_read_b128 v[124:127], v255 offset:5120
  buffer_load_dwordx4 v[56:59], v2, s[4:7], s91 offen offset:2048 sc1
  s_waitcnt vmcnt(8)
  s_waitcnt lgkmcnt(6)
  v_mfma_f32_32x32x16_bf16 v[80:95], v[128:131], v[24:27], v[80:95]
  v_mfma_f32_32x32x16_bf16 v[96:111], v[132:135], v[24:27], v[96:111]
  ds_read_b128 v[128:131], v254 offset:6144
  ds_read_b128 v[132:135], v255 offset:6144
  buffer_load_dwordx4 v[60:63], v2, s[4:7], s91 offen offset:3072 sc1
  s_waitcnt vmcnt(8)
  s_waitcnt lgkmcnt(6)
  v_mfma_f32_32x32x16_bf16 v[80:95], v[136:139], v[28:31], v[80:95]
  v_mfma_f32_32x32x16_bf16 v[96:111], v[140:143], v[28:31], v[96:111]
  ds_read_b128 v[136:139], v254 offset:7168
  ds_read_b128 v[140:143], v255 offset:7168
  s_add_u32 s91, s91, 4096
  buffer_load_dwordx4 v[64:67], v2, s[4:7], s91 offen offset:0 sc1
  s_waitcnt vmcnt(8)
  s_waitcnt lgkmcnt(6)
  v_mfma_f32_32x32x16_bf16 v[80:95], v[112:115], v[32:35], v[80:95]
  v_mfma_f32_32x32x16_bf16 v[96:111], v[116:119], v[32:35], v[96:111]
  ds_read_b128 v[112:115], v254 offset:8192
  ds_read_b128 v[116:119], v255 offset:8192
  buffer_load_dwordx4 v[68:71], v2, s[4:7], s91 offen offset:1024 sc1
  s_waitcnt vmcnt(8)
  s_waitcnt lgkmcnt(6)
  v_mfma_f32_32x32x16_bf16 v[80:95], v[120:123], v[36:39], v[80:95]
  v_mfma_f32_32x32x16_bf16 v[96:111], v[124:127], v[36:39], v[96:111]
  ds_read_b128 v[120:123], v254 offset:9216
  ds_read_b128 v[124:127], v255 offset:9216
  buffer_load_dwordx4 v[72:75], v2, s[4:7], s91 offen offset:2048 sc1
  s_waitcnt vmcnt(8)
  s_waitcnt lgkmcnt(6)
  v_mfma_f32_32x32x16_bf16 v[80:95], v[128:131], v[40:43], v[80:95]
  v_mfma_f32_32x32x16_bf16 v[96:111], v[132:135], v[40:43], v[96:111]
  ds_read_b128 v[128:131], v254 offset:10240
  ds_read_b128 v[132:135], v255 offset:10240
  buffer_load_dwordx4 v[76:79], v2, s[4:7], s91 offen offset:3072 sc1
  s_waitcnt vmcnt(8)
  s_waitcnt lgkmcnt(6)
  v_mfma_f32_32x32x16_bf16 v[80:95], v[136:139], v[44:47], v[80:95]
  v_mfma_f32_32x32x16_bf16 v[96:111], v[140:143], v[44:47], v[96:111]
  ds_read_b128 v[136:139], v254 offset:11264
  ds_read_b128 v[140:143], v255 offset:11264
  s_waitcnt vmcnt(7)
  s_waitcnt lgkmcnt(6)
  v_mfma_f32_32x32x16_bf16 v[80:95], v[112:115], v[48:51], v[80:95]
  v_mfma_f32_32x32x16_bf16 v[96:111], v[116:119], v[48:51], v[96:111]
  ds_read_b128 v[112:115], v254 offset:12288
  ds_read_b128 v[116:119], v255 offset:12288
  s_waitcnt vmcnt(6)
  s_waitcnt lgkmcnt(6)
  v_mfma_f32_32x32x16_bf16 v[80:95], v[120:123], v[52:55], v[80:95]
  v_mfma_f32_32x32x16_bf16 v[96:111], v[124:127], v[52:55], v[96:111]
  ds_read_b128 v[120:123], v254 offset:13312
  ds_read_b128 v[124:127], v255 offset:13312
  s_waitcnt vmcnt(5)
  s_waitcnt lgkmcnt(6)
  v_mfma_f32_32x32x16_bf16 v[80:95], v[128:131], v[56:59], v[80:95]
  v_mfma_f32_32x32x16_bf16 v[96:111], v[132:135], v[56:59], v[96:111]
  ds_read_b128 v[128:131], v254 offset:14336
  ds_read_b128 v[132:135], v255 offset:14336
  s_waitcnt vmcnt(4)
  s_waitcnt lgkmcnt(6)
  v_mfma_f32_32x32x16_bf16 v[80:95], v[136:139], v[60:63], v[80:95]
  v_mfma_f32_32x32x16_bf16 v[96:111], v[140:143], v[60:63], v[96:111]
  ds_read_b128 v[136:139], v254 offset:15360
  ds_read_b128 v[140:143], v255 offset:15360
  s_waitcnt vmcnt(3)
  s_waitcnt lgkmcnt(6)
  v_mfma_f32_32x32x16_bf16 v[80:95], v[112:115], v[64:67], v[80:95]
  v_mfma_f32_32x32x16_bf16 v[96:111], v[116:119], v[64:67], v[96:111]
  s_waitcnt vmcnt(2)
  s_waitcnt lgkmcnt(4)
  v_mfma_f32_32x32x16_bf16 v[80:95], v[120:123], v[68:71], v[80:95]
  v_mfma_f32_32x32x16_bf16 v[96:111], v[124:127], v[68:71], v[96:111]
  s_waitcnt vmcnt(1)
  s_waitcnt lgkmcnt(2)
  v_mfma_f32_32x32x16_bf16 v[80:95], v[128:131], v[72:75], v[80:95]
  v_mfma_f32_32x32x16_bf16 v[96:111], v[132:135], v[72:75], v[96:111]
  s_waitcnt vmcnt(0)
  s_waitcnt lgkmcnt(0)
  v_mfma_f32_32x32x16_bf16 v[80:95], v[136:139], v[76:79], v[80:95]
  v_mfma_f32_32x32x16_bf16 v[96:111], v[140:143], v[76:79], v[96:111]
  v_lshlrev_b32 v16, 16, v4
  v_and_b32 v17, 0xffff0000, v4
  v_lshlrev_b32 v18, 16, v5
  v_and_b32 v19, 0xffff0000, v5
  v_lshlrev_b32 v20, 16, v6
  v_and_b32 v21, 0xffff0000, v6
  v_lshlrev_b32 v22, 16, v7
  v_and_b32 v23, 0xffff0000, v7
  v_lshlrev_b32 v24, 16, v8
  v_and_b32 v25, 0xffff0000, v8
  v_lshlrev_b32 v26, 16, v9
  v_and_b32 v27, 0xffff0000, v9
  v_lshlrev_b32 v28, 16, v10
  v_and_b32 v29, 0xffff0000, v10
  v_lshlrev_b32 v30, 16, v11
  v_and_b32 v31, 0xffff0000, v11
  s_lshl_b32 s40, s18, 12
  s_add_u32 s40, s40, 131072
  v_add_u32 v14, s40, v2
  s_xor_b32 s40, s40, 8192
  v_add_u32 v15, s40, v2
  ds_write_b128 v14, v[96:99] offset:0
  ds_write_b128 v14, v[100:103] offset:1024
  ds_write_b128 v14, v[104:107] offset:2048
  ds_write_b128 v14, v[108:111] offset:3072
  s_waitcnt lgkmcnt(0)
  s_barrier
  ds_read_b128 v[96:99], v15 offset:0
  ds_read_b128 v[100:103], v15 offset:1024
  ds_read_b128 v[104:107], v15 offset:2048
  ds_read_b128 v[108:111], v15 offset:3072
  s_waitcnt lgkmcnt(3)
  v_pk_add_f32 v[80:81], v[80:81], v[96:97]
  v_pk_add_f32 v[82:83], v[82:83], v[98:99]
  s_waitcnt lgkmcnt(2)
  v_pk_add_f32 v[84:85], v[84:85], v[100:101]
  v_pk_add_f32 v[86:87], v[86:87], v[102:103]
  s_waitcnt lgkmcnt(1)
  v_pk_add_f32 v[88:89], v[88:89], v[104:105]
  v_pk_add_f32 v[90:91], v[90:91], v[106:107]
  s_waitcnt lgkmcnt(0)
  v_pk_add_f32 v[92:93], v[92:93], v[108:109]
  v_pk_add_f32 v[94:95], v[94:95], v[110:111]
  v_pk_add_f32 v[80:81], v[80:81], v[16:17]
  v_pk_add_f32 v[82:83], v[82:83], v[18:19]
  v_pk_add_f32 v[84:85], v[84:85], v[20:21]
  v_pk_add_f32 v[86:87], v[86:87], v[22:23]
  v_pk_add_f32 v[88:89], v[88:89], v[24:25]
  v_pk_add_f32 v[90:91], v[90:91], v[26:27]
  v_pk_add_f32 v[92:93], v[92:93], v[28:29]
  v_pk_add_f32 v[94:95], v[94:95], v[30:31]
  v_cvt_pk_bf16_f32 v4, v80, v81
  v_cvt_pk_bf16_f32 v5, v82, v83
  v_cvt_pk_bf16_f32 v6, v84, v85
  v_cvt_pk_bf16_f32 v7, v86, v87
  v_cvt_pk_bf16_f32 v8, v88, v89
  v_cvt_pk_bf16_f32 v9, v90, v91
  v_cvt_pk_bf16_f32 v10, v92, v93
  v_cvt_pk_bf16_f32 v11, v94, v95
  v_permlane32_swap_b32 v4, v6
  v_permlane32_swap_b32 v5, v7
  v_permlane32_swap_b32 v8, v10
  v_permlane32_swap_b32 v9, v11
  buffer_store_dwordx4 v[4:7], v250, s[12:15], s96 offen offset:0
  buffer_store_dwordx4 v[8:11], v250, s[12:15], s96 offen offset:32
  s_endpgm
NOTLAST_80:
  s_lshl_b32 s61, s16, 7
  s_add_u32 s61, s61, s38
  s_add_u32 s61, s61, 8192
  s_waitcnt vmcnt(0)
  s_barrier
  s_cmp_lg_u32 s18, 0
  s_cbranch_scc1 SYNCA_86
  s_mov_b64 exec, 1
  s_cmp_eq_u32 s39, 1
  s_cbranch_scc1 FAST_88
  buffer_store_dword v245, v244, s[4:7], s61 offen sc1
  s_branch MDONE_89
FAST_88:
  buffer_store_dword v245, v244, s[4:7], s61 offen
MDONE_89:
  s_mov_b64 exec, -1
  buffer_load_dword v247, v246, s[4:7], s61 offen sc1
SYNCA_86:
  v_lshrrev_b32 v212, 5, v1
  v_lshlrev_b32 v212, 4, v212
  s_add_u32 s40, s27, 0
  s_lshl_b32 s40, s40, 7
  s_add_u32 s40, s40, 4718592
  buffer_load_dwordx4 v[180:183], v212, s[4:7], s40 offen offset:0 sc1
  buffer_load_dwordx4 v[184:187], v212, s[4:7], s40 offen offset:32 sc1
  buffer_load_dwordx4 v[188:191], v212, s[4:7], s40 offen offset:64 sc1
  buffer_load_dwordx4 v[192:195], v212, s[4:7], s40 offen offset:96 sc1
  s_mov_b32 s40, 4720640
  buffer_load_dwordx4 v[196:199], v212, s[4:7], s40 offen offset:0 sc1
  buffer_load_dwordx4 v[200:203], v212, s[4:7], s40 offen offset:32 sc1
  buffer_load_dwordx4 v[204:207], v212, s[4:7], s40 offen offset:64 sc1
  buffer_load_dwordx4 v[208:211], v212, s[4:7], s40 offen offset:96 sc1
  s_cmp_eq_u32 s19, s17
  s_cbranch_scc0 PFKV_90
  s_lshl_b32 s42, s20, 14
  s_add_u32 s40, s42, 1572864
  buffer_load_dwordx4 a[0:3], v2, s[4:7], s40 offen offset:0 sc1
  buffer_load_dwordx4 a[4:7], v2, s[4:7], s40 offen offset:1024 sc1
  buffer_load_dwordx4 a[8:11], v2, s[4:7], s40 offen offset:2048 sc1
  buffer_load_dwordx4 a[12:15], v2, s[4:7], s40 offen offset:3072 sc1
  s_add_u32 s40, s40, 4096
  buffer_load_dwordx4 a[16:19], v2, s[4:7], s40 offen offset:0 sc1
  buffer_load_dwordx4 a[20:23], v2, s[4:7], s40 offen offset:1024 sc1
  buffer_load_dwordx4 a[24:27], v2, s[4:7], s40 offen offset:2048 sc1
  buffer_load_dwordx4 a[28:31], v2, s[4:7], s40 offen offset:3072 sc1
  s_add_u32 s40, s40, 4096
  buffer_load_dwordx4 a[32:35], v2, s[4:7], s40 offen offset:0 sc1
  buffer_load_dwordx4 a[36:39], v2, s[4:7], s40 offen offset:1024 sc1
  buffer_load_dwordx4 a[40:43], v2, s[4:7], s40 offen offset:2048 sc1
  buffer_load_dwordx4 a[44:47], v2, s[4:7], s40 offen offset:3072 sc1
  s_add_u32 s40, s40, 4096
  buffer_load_dwordx4 a[48:51], v2, s[4:7], s40 offen offset:0 sc1
  buffer_load_dwordx4 a[52:55], v2, s[4:7], s40 offen offset:1024 sc1
  buffer_load_dwordx4 a[56:59], v2, s[4:7], s40 offen offset:2048 sc1
  buffer_load_dwordx4 a[60:63], v2, s[4:7], s40 offen offset:3072 sc1
PFKV_90:
  s_cmp_lg_u32 s18, 0
  s_cbranch_scc1 SYNC_87
  s_mov_b32 s52, 0
  s_waitcnt vmcnt(8)
  v_cmp_ne_u32 vcc, s21, v247
  s_nop 4
  s_cbranch_vccz SYNC_87
POLL_91:
  buffer_load_dword v247, v246, s[4:7], s61 offen sc1
  s_waitcnt vmcnt(0)
  v_cmp_ne_u32 vcc, s21, v247
  s_nop 4
  s_cbranch_vccz SYNC_87
  s_add_u32 s52, s52, 1
  s_cmp_lt_u32 s52, 400000
  s_cbranch_scc1 POLL_91
  s_branch L_END
SYNC_87:
  s_waitcnt vmcnt(0)
  s_barrier
  s_lshl_b32 s40, s18, 14
  s_add_u32 s62, s40, 65536
  s_lshl_b32 s63, s17, 16
  s_add_u32 s63, s63, s40
  s_add_u32 s63, s63, 1048576
  s_lshl_b32 s91, s26, 15
  s_lshl_b32 s41, s20, 14
  s_add_u32 s91, s91, s41
  s_add_u32 s91, s91, s35
  buffer_load_dwordx4 v[16:19], v2, s[4:7], s91 offen offset:0 sc1
  buffer_load_dwordx4 v[20:23], v2, s[4:7], s91 offen offset:1024 sc1
  buffer_load_dwordx4 v[24:27], v2, s[4:7], s91 offen offset:2048 sc1
  buffer_load_dwordx4 v[28:31], v2, s[4:7], s91 offen offset:3072 sc1
  s_add_u32 s91, s91, 4096
  buffer_load_dwordx4 v[32:35], v2, s[4:7], s91 offen offset:0 sc1
  buffer_load_dwordx4 v[36:39], v2, s[4:7], s91 offen offset:1024 sc1
  buffer_load_dwordx4 v[40:43], v2, s[4:7], s91 offen offset:2048 sc1
  buffer_load_dwordx4 v[44:47], v2, s[4:7], s91 offen offset:3072 sc1
  s_lshl_b32 s42, s20, 14
  s_lshl_b32 s43, s20, 15
  s_add_u32 s43, s43, s42
  s_add_u32 s43, s43, 0
  v_add_u32 v254, s43, v2
  s_xor_b32 s43, s20, 1
  s_lshl_b32 s43, s43, 15
  s_add_u32 s43, s43, s42
  s_add_u32 s43, s43, 0
  v_add_u32 v255, s43, v2
  ds_read_b128 v[112:115], v254 offset:0
  ds_read_b128 v[116:119], v255 offset:0
  ds_read_b128 v[120:123], v254 offset:1024
  ds_read_b128 v[124:127], v255 offset:1024
  ds_read_b128 v[128:131], v254 offset:2048
  ds_read_b128 v[132:135], v255 offset:2048
  ds_read_b128 v[136:139], v254 offset:3072
  ds_read_b128 v[140:143], v255 offset:3072
  s_add_u32 s91, s91, 4096
  buffer_load_dwordx4 v[48:51], v2, s[4:7], s91 offen offset:0 sc1
  s_waitcnt vmcnt(8)
  s_waitcnt lgkmcnt(6)
  v_mfma_f32_32x32x16_bf16 v[80:95], v[112:115], v[16:19], 0
  v_mfma_f32_32x32x16_bf16 v[96:111], v[116:119], v[16:19], 0
  ds_read_b128 v[112:115], v254 offset:4096
  ds_read_b128 v[116:119], v255 offset:4096
  buffer_load_dwordx4 v[52:55], v2, s[4:7], s91 offen offset:1024 sc1
  s_waitcnt vmcnt(8)
  s_waitcnt lgkmcnt(6)
  v_mfma_f32_32x32x16_bf16 v[80:95], v[120:123], v[20:23], v[80:95]
  v_mfma_f32_32x32x16_bf16 v[96:111], v[124:127], v[20:23], v[96:111]
  ds_read_b128 v[120:123], v254 offset:5120
  ds_read_b128 v[124:127], v255 offset:5120
  buffer_load_dwordx4 v[56:59], v2, s[4:7], s91 offen offset:2048 sc1
  s_waitcnt vmcnt(8)
  s_waitcnt lgkmcnt(6)
  v_mfma_f32_32x32x16_bf16 v[80:95], v[128:131], v[24:27], v[80:95]
  v_mfma_f32_32x32x16_bf16 v[96:111], v[132:135], v[24:27], v[96:111]
  ds_read_b128 v[128:131], v254 offset:6144
  ds_read_b128 v[132:135], v255 offset:6144
  buffer_load_dwordx4 v[60:63], v2, s[4:7], s91 offen offset:3072 sc1
  s_waitcnt vmcnt(8)
  s_waitcnt lgkmcnt(6)
  v_mfma_f32_32x32x16_bf16 v[80:95], v[136:139], v[28:31], v[80:95]
  v_mfma_f32_32x32x16_bf16 v[96:111], v[140:143], v[28:31], v[96:111]
  ds_read_b128 v[136:139], v254 offset:7168
  ds_read_b128 v[140:143], v255 offset:7168
  s_add_u32 s91, s91, 4096
  buffer_load_dwordx4 v[64:67], v2, s[4:7], s91 offen offset:0 sc1
  s_waitcnt vmcnt(8)
  s_waitcnt lgkmcnt(6)
  v_mfma_f32_32x32x16_bf16 v[80:95], v[112:115], v[32:35], v[80:95]
  v_mfma_f32_32x32x16_bf16 v[96:111], v[116:119], v[32:35], v[96:111]
  ds_read_b128 v[112:115], v254 offset:8192
  ds_read_b128 v[116:119], v255 offset:8192
  buffer_load_dwordx4 v[68:71], v2, s[4:7], s91 offen offset:1024 sc1
  s_waitcnt vmcnt(8)
  s_waitcnt lgkmcnt(6)
  v_mfma_f32_32x32x16_bf16 v[80:95], v[120:123], v[36:39], v[80:95]
  v_mfma_f32_32x32x16_bf16 v[96:111], v[124:127], v[36:39], v[96:111]
  ds_read_b128 v[120:123], v254 offset:9216
  ds_read_b128 v[124:127], v255 offset:9216
  buffer_load_dwordx4 v[72:75], v2, s[4:7], s91 offen offset:2048 sc1
  s_waitcnt vmcnt(8)
  s_waitcnt lgkmcnt(6)
  v_mfma_f32_32x32x16_bf16 v[80:95], v[128:131], v[40:43], v[80:95]
  v_mfma_f32_32x32x16_bf16 v[96:111], v[132:135], v[40:43], v[96:111]
  ds_read_b128 v[128:131], v254 offset:10240
  ds_read_b128 v[132:135], v255 offset:10240
  buffer_load_dwordx4 v[76:79], v2, s[4:7], s91 offen offset:3072 sc1
  s_waitcnt vmcnt(8)
  s_waitcnt lgkmcnt(6)
  v_mfma_f32_32x32x16_bf16 v[80:95], v[136:139], v[44:47], v[80:95]
  v_mfma_f32_32x32x16_bf16 v[96:111], v[140:143], v[44:47], v[96:111]
  ds_read_b128 v[136:139], v254 offset:11264
  ds_read_b128 v[140:143], v255 offset:11264
  s_waitcnt vmcnt(7)
  s_waitcnt lgkmcnt(6)
  v_mfma_f32_32x32x16_bf16 v[80:95], v[112:115], v[48:51], v[80:95]
  v_mfma_f32_32x32x16_bf16 v[96:111], v[116:119], v[48:51], v[96:111]
  s_mov_b32 m0, s62
  s_add_u32 s62, s62, 4096
  buffer_load_dwordx4 v2, s[4:7], s63 offen offset:0 sc1 lds
  ds_read_b128 v[112:115], v254 offset:12288
  ds_read_b128 v[116:119], v255 offset:12288
  s_waitcnt vmcnt(7)
  s_waitcnt lgkmcnt(6)
  v_mfma_f32_32x32x16_bf16 v[80:95], v[120:123], v[52:55], v[80:95]
  v_mfma_f32_32x32x16_bf16 v[96:111], v[124:127], v[52:55], v[96:111]
  buffer_load_dwordx4 v2, s[4:7], s63 offen offset:1024 sc1 lds
  ds_read_b128 v[120:123], v254 offset:13312
  ds_read_b128 v[124:127], v255 offset:13312
  s_waitcnt vmcnt(7)
  s_waitcnt lgkmcnt(6)
  v_mfma_f32_32x32x16_bf16 v[80:95], v[128:131], v[56:59], v[80:95]
  v_mfma_f32_32x32x16_bf16 v[96:111], v[132:135], v[56:59], v[96:111]
  buffer_load_dwordx4 v2, s[4:7], s63 offen offset:2048 sc1 lds
  ds_read_b128 v[128:131], v254 offset:14336
  ds_read_b128 v[132:135], v255 offset:14336
  s_waitcnt vmcnt(7)
  s_waitcnt lgkmcnt(6)
  v_mfma_f32_32x32x16_bf16 v[80:95], v[136:139], v[60:63], v[80:95]
  v_mfma_f32_32x32x16_bf16 v[96:111], v[140:143], v[60:63], v[96:111]
  buffer_load_dwordx4 v2, s[4:7], s63 offen offset:3072 sc1 lds
  s_add_u32 s63, s63, 4096
  ds_read_b128 v[136:139], v254 offset:15360
  ds_read_b128 v[140:143], v255 offset:15360
  s_waitcnt vmcnt(7)
  s_waitcnt lgkmcnt(6)
  v_mfma_f32_32x32x16_bf16 v[80:95], v[112:115], v[64:67], v[80:95]
  v_mfma_f32_32x32x16_bf16 v[96:111], v[116:119], v[64:67], v[96:111]
  s_mov_b32 m0, s62
  s_add_u32 s62, s62, 4096
  buffer_load_dwordx4 v2, s[4:7], s63 offen offset:0 sc1 lds
  s_waitcnt vmcnt(7)
  s_waitcnt lgkmcnt(4)
  v_mfma_f32_32x32x16_bf16 v[80:95], v[120:123], v[68:71], v[80:95]
  v_mfma_f32_32x32x16_bf16 v[96:111], v[124:127], v[68:71], v[96:111]
  buffer_load_dwordx4 v2, s[4:7], s63 offen offset:1024 sc1 lds
  s_waitcnt vmcnt(7)
  s_waitcnt lgkmcnt(2)
  v_mfma_f32_32x32x16_bf16 v[80:95], v[128:131], v[72:75], v[80:95]
  v_mfma_f32_32x32x16_bf16 v[96:111], v[132:135], v[72:75], v[96:111]
  buffer_load_dwordx4 v2, s[4:7], s63 offen offset:2048 sc1 lds
  s_waitcnt vmcnt(7)
  s_waitcnt lgkmcnt(0)
  v_mfma_f32_32x32x16_bf16 v[80:95], v[136:139], v[76:79], v[80:95]
  v_mfma_f32_32x32x16_bf16 v[96:111], v[140:143], v[76:79], v[96:111]
  buffer_load_dwordx4 v2, s[4:7], s63 offen offset:3072 sc1 lds
  s_add_u32 s63, s63, 4096
  v_lshlrev_b32 v16, 16, v4
  v_and_b32 v17, 0xffff0000, v4
  v_lshlrev_b32 v18, 16, v5
  v_and_b32 v19, 0xffff0000, v5
  s_mov_b32 m0, s62
  s_add_u32 s62, s62, 4096
  buffer_load_dwordx4 v2, s[4:7], s63 offen offset:0 sc1 lds
  v_lshlrev_b32 v20, 16, v6
  v_and_b32 v21, 0xffff0000, v6
  v_lshlrev_b32 v22, 16, v7
  v_and_b32 v23, 0xffff0000, v7
  buffer_load_dwordx4 v2, s[4:7], s63 offen offset:1024 sc1 lds
  v_lshlrev_b32 v24, 16, v8
  v_and_b32 v25, 0xffff0000, v8
  v_lshlrev_b32 v26, 16, v9
  v_and_b32 v27, 0xffff0000, v9
  buffer_load_dwordx4 v2, s[4:7], s63 offen offset:2048 sc1 lds
  v_lshlrev_b32 v28, 16, v10
  v_and_b32 v29, 0xffff0000, v10
  v_lshlrev_b32 v30, 16, v11
  v_and_b32 v31, 0xffff0000, v11
  buffer_load_dwordx4 v2, s[4:7], s63 offen offset:3072 sc1 lds
  s_add_u32 s63, s63, 4096
  s_lshl_b32 s40, s18, 12
  s_add_u32 s40, s40, 131072
  v_add_u32 v14, s40, v2
  s_xor_b32 s40, s40, 8192
  v_add_u32 v15, s40, v2
  ds_write_b128 v14, v[96:99] offset:0
  ds_write_b128 v14, v[100:103] offset:1024
  ds_write_b128 v14, v[104:107] offset:2048
  ds_write_b128 v14, v[108:111] offset:3072
  s_mov_b32 m0, s62
  s_add_u32 s62, s62, 4096
  buffer_load_dwordx4 v2, s[4:7], s63 offen offset:0 sc1 lds
  buffer_load_dwordx4 v2, s[4:7], s63 offen offset:1024 sc1 lds
  buffer_load_dwordx4 v2, s[4:7], s63 offen offset:2048 sc1 lds
  buffer_load_dwordx4 v2, s[4:7], s63 offen offset:3072 sc1 lds
  s_add_u32 s63, s63, 4096
  s_waitcnt lgkmcnt(0)
  s_barrier
  ds_read_b128 v[96:99], v15 offset:0
  ds_read_b128 v[100:103], v15 offset:1024
  ds_read_b128 v[104:107], v15 offset:2048
  ds_read_b128 v[108:111], v15 offset:3072
  s_waitcnt lgkmcnt(3)
  v_pk_add_f32 v[80:81], v[80:81], v[96:97]
  v_pk_add_f32 v[82:83], v[82:83], v[98:99]
  s_waitcnt lgkmcnt(2)
  v_pk_add_f32 v[84:85], v[84:85], v[100:101]
  v_pk_add_f32 v[86:87], v[86:87], v[102:103]
  s_waitcnt lgkmcnt(1)
  v_pk_add_f32 v[88:89], v[88:89], v[104:105]
  v_pk_add_f32 v[90:91], v[90:91], v[106:107]
  s_waitcnt lgkmcnt(0)
  v_pk_add_f32 v[92:93], v[92:93], v[108:109]
  v_pk_add_f32 v[94:95], v[94:95], v[110:111]
  v_pk_add_f32 v[80:81], v[80:81], v[16:17]
  v_pk_add_f32 v[82:83], v[82:83], v[18:19]
  v_pk_add_f32 v[84:85], v[84:85], v[20:21]
  v_pk_add_f32 v[86:87], v[86:87], v[22:23]
  v_pk_add_f32 v[88:89], v[88:89], v[24:25]
  v_pk_add_f32 v[90:91], v[90:91], v[26:27]
  v_pk_add_f32 v[92:93], v[92:93], v[28:29]
  v_pk_add_f32 v[94:95], v[94:95], v[30:31]
  v_cvt_pk_bf16_f32 v4, v80, v81
  v_cvt_pk_bf16_f32 v5, v82, v83
  v_cvt_pk_bf16_f32 v6, v84, v85
  v_cvt_pk_bf16_f32 v7, v86, v87
  v_cvt_pk_bf16_f32 v8, v88, v89
  v_cvt_pk_bf16_f32 v9, v90, v91
  v_cvt_pk_bf16_f32 v10, v92, v93
  v_cvt_pk_bf16_f32 v11, v94, v95
  s_add_u32 s40, s30, s24
  s_cmp_eq_u32 s39, 1
  s_cbranch_scc1 FAST_92
  buffer_store_dwordx4 v[4:7], v2, s[4:7], s40 offen offset:0 sc1
  buffer_store_dwordx4 v[8:11], v2, s[4:7], s40 offen offset:1024 sc1
  s_branch MDONE_93
FAST_92:
  buffer_store_dwordx4 v[4:7], v2, s[4:7], s40 offen offset:0
  buffer_store_dwordx4 v[8:11], v2, s[4:7], s40 offen offset:1024
MDONE_93:
  v_mov_b32 v16, 0x3f803f80
  v_mov_b32 v17, 0
  v_mov_b32 v18, 0
  v_mov_b32 v19, 0
  v_mov_b32 v20, 0
  v_dot2c_f32_bf16 v17, v16, v4
  v_dot2c_f32_bf16 v18, v4, v4
  v_dot2c_f32_bf16 v19, v16, v5
  v_dot2c_f32_bf16 v20, v5, v5
  v_dot2c_f32_bf16 v17, v16, v6
  v_dot2c_f32_bf16 v18, v6, v6
  v_dot2c_f32_bf16 v19, v16, v7
  v_dot2c_f32_bf16 v20, v7, v7
  v_dot2c_f32_bf16 v17, v16, v8
  v_dot2c_f32_bf16 v18, v8, v8
  v_dot2c_f32_bf16 v19, v16, v9
  v_dot2c_f32_bf16 v20, v9, v9
  v_dot2c_f32_bf16 v17, v16, v10
  v_dot2c_f32_bf16 v18, v10, v10
  v_dot2c_f32_bf16 v19, v16, v11
  v_dot2c_f32_bf16 v20, v11, v11
  s_nop 1
  v_add_f32 v17, v17, v19
  v_add_f32 v18, v18, v20
  s_nop 1
  v_permlane32_swap_b32 v17, v18
  v_add_f32 v17, v17, v18
  s_add_u32 s40, s33, s25
  s_cmp_eq_u32 s39, 1
  s_cbranch_scc1 FAST_94
  buffer_store_dword v17, v12, s[4:7], s40 offen offset:0 sc1
  s_branch MDONE_95
FAST_94:
  buffer_store_dword v17, v12, s[4:7], s40 offen offset:0
MDONE_95:
  s_lshl_b32 s61, s16, 7
  s_add_u32 s61, s61, s38
  s_add_u32 s61, s61, 12288
  s_waitcnt vmcnt(0)
  s_barrier
  s_cmp_lg_u32 s18, 0
  s_cbranch_scc1 SYNCA_96
  s_mov_b64 exec, 1
  s_cmp_eq_u32 s39, 1
  s_cbranch_scc1 FAST_98
  buffer_store_dword v245, v244, s[4:7], s61 offen sc1
  s_branch MDONE_99
FAST_98:
  buffer_store_dword v245, v244, s[4:7], s61 offen
MDONE_99:
  s_mov_b64 exec, -1
  buffer_load_dword v247, v246, s[4:7], s61 offen sc1
SYNCA_96:
  s_cmp_lg_u32 s18, 0
  s_cbranch_scc1 SYNC_97
  s_mov_b32 s52, 0
  s_waitcnt vmcnt(0)
  v_cmp_ne_u32 vcc, s21, v247
  s_nop 4
  s_cbranch_vccz SYNC_97
POLL_100:
  buffer_load_dword v247, v246, s[4:7], s61 offen sc1
  s_waitcnt vmcnt(0)
  v_cmp_ne_u32 vcc, s21, v247
  s_nop 4
  s_cbranch_vccz SYNC_97
  s_add_u32 s52, s52, 1
  s_cmp_lt_u32 s52, 400000
  s_cbranch_scc1 POLL_100
  s_branch L_END
SYNC_97:
  s_waitcnt vmcnt(0)
  s_barrier
  s_mov_b32 s22, 1
  s_lshl_b32 s40, s22, 22
  s_add_u32 s28, s40, 5242880
  s_add_u32 s29, s28, 0x200000
  s_add_u32 s30, s28, 0x400000
  s_lshl_b32 s40, s22, 19
  s_add_u32 s31, s40, 24117248
  s_add_u32 s32, s31, 0x40000
  s_add_u32 s33, s31, 0x80000
  s_lshl_b32 s40, s22, 21
  s_add_u32 s34, s40, 13631488
  s_add_u32 s35, s40, 17825792
  s_lshl_b32 s40, s22, 20
  s_add_u32 s36, s40, 22020096
  s_lshl_b32 s40, s22, 18
  s_add_u32 s37, s40, 25165824
  s_lshl_b32 s40, s22, 14
  s_add_u32 s38, s40, 65536
  s_lshl_b32 s40, s22, 18
  s_add_u32 s53, s40, 27262976
  s_cmp_eq_u32 s39, 0
  s_cbranch_scc1 ALIAS_101
  s_mov_b32 s34, 13631488
  s_mov_b32 s35, 13631488
  s_mov_b32 s28, 7340032
  s_mov_b32 s29, 7340032
  s_mov_b32 s30, 7340032
  s_mov_b32 s31, 24379392
  s_mov_b32 s32, 24379392
  s_mov_b32 s33, 24379392
ALIAS_101:
  s_lshl_b32 s91, s26, 15
  s_lshl_b32 s41, s20, 14
  s_add_u32 s91, s91, s41
  s_add_u32 s91, s91, s28
  buffer_load_dwordx4 v[16:19], v2, s[4:7], s91 offen offset:0 sc1
  buffer_load_dwordx4 v[20:23], v2, s[4:7], s91 offen offset:1024 sc1
  buffer_load_dwordx4 v[24:27], v2, s[4:7], s91 offen offset:2048 sc1
  buffer_load_dwordx4 v[28:31], v2, s[4:7], s91 offen offset:3072 sc1
  s_add_u32 s91, s91, 4096
  buffer_load_dwordx4 v[32:35], v2, s[4:7], s91 offen offset:0 sc1
  buffer_load_dwordx4 v[36:39], v2, s[4:7], s91 offen offset:1024 sc1
  buffer_load_dwordx4 v[40:43], v2, s[4:7], s91 offen offset:2048 sc1
  buffer_load_dwordx4 v[44:47], v2, s[4:7], s91 offen offset:3072 sc1
  v_and_b32 v176, 31, v1
  v_lshlrev_b32 v176, 3, v176
  v_lshrrev_b32 v177, 5, v1
  v_lshl_add_u32 v176, v177, 11, v176
  s_lshl_b32 s90, s26, 12
  s_add_u32 s90, s90, s31
  s_lshl_b32 s42, s20, 14
  s_lshl_b32 s43, s20, 15
  s_add_u32 s43, s43, s42
  s_add_u32 s43, s43, 65536
  v_add_u32 v254, s43, v2
  s_xor_b32 s43, s20, 1
  s_lshl_b32 s43, s43, 15
  s_add_u32 s43, s43, s42
  s_add_u32 s43, s43, 65536
  v_add_u32 v255, s43, v2
  s_cmp_eq_u32 s19, s17
  s_cbranch_scc0 G4Q_102
  s_add_u32 s91, s91, 4096
  buffer_load_dwordx4 v[48:51], v2, s[4:7], s91 offen offset:0 sc1
  s_waitcnt vmcnt(8)
  v_mfma_f32_32x32x16_bf16 v[144:159], a[0:3], v[16:19], 0
  buffer_load_dwordx4 v[52:55], v2, s[4:7], s91 offen offset:1024 sc1
  s_waitcnt vmcnt(8)
  v_mfma_f32_32x32x16_bf16 v[144:159], a[4:7], v[20:23], v[144:159]
  buffer_load_dwordx4 v[56:59], v2, s[4:7], s91 offen offset:2048 sc1
  s_waitcnt vmcnt(8)
  v_mfma_f32_32x32x16_bf16 v[144:159], a[8:11], v[24:27], v[144:159]
  buffer_load_dwordx4 v[60:63], v2, s[4:7], s91 offen offset:3072 sc1
  s_waitcnt vmcnt(8)
  v_mfma_f32_32x32x16_bf16 v[144:159], a[12:15], v[28:31], v[144:159]
  s_add_u32 s91, s91, 4096
  buffer_load_dwordx4 v[64:67], v2, s[4:7], s91 offen offset:0 sc1
  s_waitcnt vmcnt(8)
  v_mfma_f32_32x32x16_bf16 v[144:159], a[16:19], v[32:35], v[144:159]
  buffer_load_dwordx4 v[68:71], v2, s[4:7], s91 offen offset:1024 sc1
  s_waitcnt vmcnt(8)
  v_mfma_f32_32x32x16_bf16 v[144:159], a[20:23], v[36:39], v[144:159]
  buffer_load_dwordx4 v[72:75], v2, s[4:7], s91 offen offset:2048 sc1
  s_waitcnt vmcnt(8)
  v_mfma_f32_32x32x16_bf16 v[144:159], a[24:27], v[40:43], v[144:159]
  buffer_load_dwordx4 v[76:79], v2, s[4:7], s91 offen offset:3072 sc1
  s_waitcnt vmcnt(8)
  v_mfma_f32_32x32x16_bf16 v[144:159], a[28:31], v[44:47], v[144:159]
  s_waitcnt vmcnt(7)
  v_mfma_f32_32x32x16_bf16 v[144:159], a[32:35], v[48:51], v[144:159]
  buffer_load_dwordx2 v[160:161], v176, s[4:7], s90 offen offset:0 sc1
  buffer_load_dwordx2 v[162:163], v176, s[4:7], s90 offen offset:256 sc1
  s_waitcnt vmcnt(8)
  v_mfma_f32_32x32x16_bf16 v[144:159], a[36:39], v[52:55], v[144:159]
  buffer_load_dwordx2 v[164:165], v176, s[4:7], s90 offen offset:512 sc1
  buffer_load_dwordx2 v[166:167], v176, s[4:7], s90 offen offset:768 sc1
  s_waitcnt vmcnt(9)
  v_mfma_f32_32x32x16_bf16 v[144:159], a[40:43], v[56:59], v[144:159]
  buffer_load_dwordx2 v[168:169], v176, s[4:7], s90 offen offset:1024 sc1
  buffer_load_dwordx2 v[170:171], v176, s[4:7], s90 offen offset:1280 sc1
  s_waitcnt vmcnt(10)
  v_mfma_f32_32x32x16_bf16 v[144:159], a[44:47], v[60:63], v[144:159]
  buffer_load_dwordx2 v[172:173], v176, s[4:7], s90 offen offset:1536 sc1
  buffer_load_dwordx2 v[174:175], v176, s[4:7], s90 offen offset:1792 sc1
  s_waitcnt vmcnt(11)
  v_mfma_f32_32x32x16_bf16 v[144:159], a[48:51], v[64:67], v[144:159]
  s_waitcnt vmcnt(10)
  v_mfma_f32_32x32x16_bf16 v[144:159], a[52:55], v[68:71], v[144:159]
  s_waitcnt vmcnt(9)
  v_mfma_f32_32x32x16_bf16 v[144:159], a[56:59], v[72:75], v[144:159]
  s_waitcnt vmcnt(8)
  v_mfma_f32_32x32x16_bf16 v[144:159], a[60:63], v[76:79], v[144:159]
  s_cmp_eq_u32 s20, 0
  s_cbranch_scc1 G4B1_103
  v_add_u32 v14, 147456, v2
  s_nop 8
  ds_write_b128 v14, v[144:147] offset:0
  ds_write_b128 v14, v[148:151] offset:1024
  ds_write_b128 v14, v[152:155] offset:2048
  ds_write_b128 v14, v[156:159] offset:3072
  s_waitcnt lgkmcnt(0)
  s_branch G4B1_103
G4Q_102:
  s_lshl_b32 s91, s26, 15
  s_lshl_b32 s41, s20, 14
  s_add_u32 s91, s91, s41
  s_add_u32 s91, s91, s28
  s_add_u32 s91, s91, 4096
  ds_read_b128 v[112:115], v254 offset:0
  ds_read_b128 v[116:119], v255 offset:0
  ds_read_b128 v[120:123], v254 offset:1024
  ds_read_b128 v[124:127], v255 offset:1024
  ds_read_b128 v[128:131], v254 offset:2048
  ds_read_b128 v[132:135], v255 offset:2048
  ds_read_b128 v[136:139], v254 offset:3072
  ds_read_b128 v[140:143], v255 offset:3072
  s_add_u32 s91, s91, 4096
  buffer_load_dwordx4 v[48:51], v2, s[4:7], s91 offen offset:0 sc1
  s_waitcnt vmcnt(8)
  s_waitcnt lgkmcnt(6)
  v_mfma_f32_32x32x16_bf16 v[80:95], v[112:115], v[16:19], 0
  v_mfma_f32_32x32x16_bf16 v[96:111], v[116:119], v[16:19], 0
  ds_read_b128 v[112:115], v254 offset:4096
  ds_read_b128 v[116:119], v255 offset:4096
  buffer_load_dwordx4 v[52:55], v2, s[4:7], s91 offen offset:1024 sc1
  s_waitcnt vmcnt(8)
  s_waitcnt lgkmcnt(6)
  v_mfma_f32_32x32x16_bf16 v[80:95], v[120:123], v[20:23], v[80:95]
  v_mfma_f32_32x32x16_bf16 v[96:111], v[124:127], v[20:23], v[96:111]
  ds_read_b128 v[120:123], v254 offset:5120
  ds_read_b128 v[124:127], v255 offset:5120
  buffer_load_dwordx4 v[56:59], v2, s[4:7], s91 offen offset:2048 sc1
  s_waitcnt vmcnt(8)
  s_waitcnt lgkmcnt(6)
  v_mfma_f32_32x32x16_bf16 v[80:95], v[128:131], v[24:27], v[80:95]
  v_mfma_f32_32x32x16_bf16 v[96:111], v[132:135], v[24:27], v[96:111]
  ds_read_b128 v[128:131], v254 offset:6144
  ds_read_b128 v[132:135], v255 offset:6144
  buffer_load_dwordx4 v[60:63], v2, s[4:7], s91 offen offset:3072 sc1
  s_waitcnt vmcnt(8)
  s_waitcnt lgkmcnt(6)
  v_mfma_f32_32x32x16_bf16 v[80:95], v[136:139], v[28:31], v[80:95]
  v_mfma_f32_32x32x16_bf16 v[96:111], v[140:143], v[28:31], v[96:111]
  ds_read_b128 v[136:139], v254 offset:7168
  ds_read_b128 v[140:143], v255 offset:7168
  s_add_u32 s91, s91, 4096
  buffer_load_dwordx4 v[64:67], v2, s[4:7], s91 offen offset:0 sc1
  s_waitcnt vmcnt(8)
  s_waitcnt lgkmcnt(6)
  v_mfma_f32_32x32x16_bf16 v[80:95], v[112:115], v[32:35], v[80:95]
  v_mfma_f32_32x32x16_bf16 v[96:111], v[116:119], v[32:35], v[96:111]
  ds_read_b128 v[112:115], v254 offset:8192
  ds_read_b128 v[116:119], v255 offset:8192
  buffer_load_dwordx4 v[68:71], v2, s[4:7], s91 offen offset:1024 sc1
  s_waitcnt vmcnt(8)
  s_waitcnt lgkmcnt(6)
  v_mfma_f32_32x32x16_bf16 v[80:95], v[120:123], v[36:39], v[80:95]
  v_mfma_f32_32x32x16_bf16 v[96:111], v[124:127], v[36:39], v[96:111]
  ds_read_b128 v[120:123], v254 offset:9216
  ds_read_b128 v[124:127], v255 offset:9216
  buffer_load_dwordx4 v[72:75], v2, s[4:7], s91 offen offset:2048 sc1
  s_waitcnt vmcnt(8)
  s_waitcnt lgkmcnt(6)
  v_mfma_f32_32x32x16_bf16 v[80:95], v[128:131], v[40:43], v[80:95]
  v_mfma_f32_32x32x16_bf16 v[96:111], v[132:135], v[40:43], v[96:111]
  ds_read_b128 v[128:131], v254 offset:10240
  ds_read_b128 v[132:135], v255 offset:10240
  buffer_load_dwordx4 v[76:79], v2, s[4:7], s91 offen offset:3072 sc1
  s_waitcnt vmcnt(8)
  s_waitcnt lgkmcnt(6)
  v_mfma_f32_32x32x16_bf16 v[80:95], v[136:139], v[44:47], v[80:95]
  v_mfma_f32_32x32x16_bf16 v[96:111], v[140:143], v[44:47], v[96:111]
  ds_read_b128 v[136:139], v254 offset:11264
  ds_read_b128 v[140:143], v255 offset:11264
  s_waitcnt vmcnt(7)
  s_waitcnt lgkmcnt(6)
  v_mfma_f32_32x32x16_bf16 v[80:95], v[112:115], v[48:51], v[80:95]
  v_mfma_f32_32x32x16_bf16 v[96:111], v[116:119], v[48:51], v[96:111]
  buffer_load_dwordx2 v[160:161], v176, s[4:7], s90 offen offset:0 sc1
  buffer_load_dwordx2 v[162:163], v176, s[4:7], s90 offen offset:256 sc1
  ds_read_b128 v[112:115], v254 offset:12288
  ds_read_b128 v[116:119], v255 offset:12288
  s_waitcnt vmcnt(8)
  s_waitcnt lgkmcnt(6)
  v_mfma_f32_32x32x16_bf16 v[80:95], v[120:123], v[52:55], v[80:95]
  v_mfma_f32_32x32x16_bf16 v[96:111], v[124:127], v[52:55], v[96:111]
  buffer_load_dwordx2 v[164:165], v176, s[4:7], s90 offen offset:512 sc1
  buffer_load_dwordx2 v[166:167], v176, s[4:7], s90 offen offset:768 sc1
  ds_read_b128 v[120:123], v254 offset:13312
  ds_read_b128 v[124:127], v255 offset:13312
  s_waitcnt vmcnt(9)
  s_waitcnt lgkmcnt(6)
  v_mfma_f32_32x32x16_bf16 v[80:95], v[128:131], v[56:59], v[80:95]
  v_mfma_f32_32x32x16_bf16 v[96:111], v[132:135], v[56:59], v[96:111]
  buffer_load_dwordx2 v[168:169], v176, s[4:7], s90 offen offset:1024 sc1
  buffer_load_dwordx2 v[170:171], v176, s[4:7], s90 offen offset:1280 sc1
  ds_read_b128 v[128:131], v254 offset:14336
  ds_read_b128 v[132:135], v255 offset:14336
  s_waitcnt vmcnt(10)
  s_waitcnt lgkmcnt(6)
  v_mfma_f32_32x32x16_bf16 v[80:95], v[136:139], v[60:63], v[80:95]
  v_mfma_f32_32x32x16_bf16 v[96:111], v[140:143], v[60:63], v[96:111]
  buffer_load_dwordx2 v[172:173], v176, s[4:7], s90 offen offset:1536 sc1
  buffer_load_dwordx2 v[174:175], v176, s[4:7], s90 offen offset:1792 sc1
  ds_read_b128 v[136:139], v254 offset:15360
  ds_read_b128 v[140:143], v255 offset:15360
  s_waitcnt vmcnt(11)
  s_waitcnt lgkmcnt(6)
  v_mfma_f32_32x32x16_bf16 v[80:95], v[112:115], v[64:67], v[80:95]
  v_mfma_f32_32x32x16_bf16 v[96:111], v[116:119], v[64:67], v[96:111]
  s_waitcnt vmcnt(10)
  s_waitcnt lgkmcnt(4)
  v_mfma_f32_32x32x16_bf16 v[80:95], v[120:123], v[68:71], v[80:95]
  v_mfma_f32_32x32x16_bf16 v[96:111], v[124:127], v[68:71], v[96:111]
  s_waitcnt vmcnt(9)
  s_waitcnt lgkmcnt(2)
  v_mfma_f32_32x32x16_bf16 v[80:95], v[128:131], v[72:75], v[80:95]
  v_mfma_f32_32x32x16_bf16 v[96:111], v[132:135], v[72:75], v[96:111]
  s_waitcnt vmcnt(8)
  s_waitcnt lgkmcnt(0)
  v_mfma_f32_32x32x16_bf16 v[80:95], v[136:139], v[76:79], v[80:95]
  v_mfma_f32_32x32x16_bf16 v[96:111], v[140:143], v[76:79], v[96:111]
G4B1_103:
  s_waitcnt vmcnt(0)
  v_add_f32 v160, v160, v162
  v_add_f32 v161, v161, v163
  v_add_f32 v160, v160, v164
  v_add_f32 v161, v161, v165
  v_add_f32 v160, v160, v166
  v_add_f32 v161, v161, v167
  v_add_f32 v160, v160, v168
  v_add_f32 v161, v161, v169
  v_add_f32 v160, v160, v170
  v_add_f32 v161, v161, v171
  v_add_f32 v160, v160, v172
  v_add_f32 v161, v161, v173
  v_add_f32 v160, v160, v174
  v_add_f32 v161, v161, v175
  s_nop 1
  v_permlane32_swap_b32 v160, v161
  v_add_f32 v160, v160, v161
  v_mov_b32 v161, v160
  s_nop 1
  v_permlane32_swap_b32 v160, v161
  v_mul_f32 v178, 0x3b000000, v160
  v_mul_f32 v161, 0x3b000000, v161
  v_fma_f32 v161, -v178, v178, v161
  v_add_f32 v161, 0x3727c5ac, v161
  v_rsq_f32 v179, v161
  s_cmp_ge_u32 s17, 2
  s_cbranch_scc1 G4RED_105
  s_barrier
  s_cmp_eq_u32 s19, s17
  s_cbranch_scc0 G4RED_105
  s_cmp_lg_u32 s20, 0
  s_cbranch_scc1 G4Q2_104
  v_add_u32 v14, 147456, v2
  ds_read_b128 v[96:99], v14 offset:0
  ds_read_b128 v[100:103], v14 offset:1024
  ds_read_b128 v[104:107], v14 offset:2048
  ds_read_b128 v[108:111], v14 offset:3072
  v_and_b32 v216, 31, v1
  v_lshlrev_b32 v216, 5, v216
  v_lshrrev_b32 v217, 5, v1
  v_lshl_add_u32 v216, v217, 3, v216
  v_add_u32 v216, 151552, v216
  v_and_b32 v218, 15, v1
  v_bfe_u32 v219, v1, 4, 1
  v_lshlrev_b32 v219, 4, v219
  v_lshl_add_u32 v219, v217, 2, v219
  v_lshrrev_b32 v220, 2, v218
  v_add_u32 v219, v219, v220
  v_lshlrev_b32 v219, 5, v219
  v_and_b32 v220, 3, v218
  v_lshl_add_u32 v219, v220, 3, v219
  v_add_u32 v219, 151552, v219
  v_bfe_u32 v220, v1, 4, 1
  v_mul_u32_u24 v220, 544, v220
  v_mul_u32_u24 v222, 272, v217
  v_add_u32 v220, v220, v222
  v_lshl_add_u32 v220, v218, 4, v220
  s_lshl_b32 s40, s26, 10
  s_add_u32 s40, s40, s37
  s_mul_i32 s41, s26, 1088
  s_add_u32 s41, s41, s37
  s_add_u32 s41, s41, 0x10000
  v_mul_u32_u24 v222, 272, v1
  v_add_u32 v222, 256, v222
  v_mov_b32 v224, 0x3f803f80
  v_mov_b32 v225, 0x3f803f80
  v_mov_b32 v226, 0x3f803f80
  v_mov_b32 v227, 0x3f803f80
  s_mov_b64 exec, 0xf
  buffer_store_dwordx4 v[224:227], v222, s[4:7], s41 offen sc1
  s_mov_b64 exec, -1
  s_waitcnt lgkmcnt(0)
  v_mul_f32 v214, v178, v179
  v_sub_f32 v214, 0, v214
  v_mov_b32 v212, v179
  v_pk_add_f32 v[144:145], v[144:145], v[96:97]
  v_pk_add_f32 v[146:147], v[146:147], v[98:99]
  v_pk_add_f32 v[148:149], v[148:149], v[100:101]
  v_pk_add_f32 v[150:151], v[150:151], v[102:103]
  v_pk_add_f32 v[152:153], v[152:153], v[104:105]
  v_pk_add_f32 v[154:155], v[154:155], v[106:107]
  v_pk_add_f32 v[156:157], v[156:157], v[108:109]
  v_pk_add_f32 v[158:159], v[158:159], v[110:111]
  v_pk_mul_f32 v[96:97], v[196:197], v[214:215] op_sel_hi:[1,0]
  v_pk_mul_f32 v[98:99], v[198:199], v[214:215] op_sel_hi:[1,0]
  v_pk_mul_f32 v[100:101], v[200:201], v[214:215] op_sel_hi:[1,0]
  v_pk_mul_f32 v[102:103], v[202:203], v[214:215] op_sel_hi:[1,0]
  v_pk_mul_f32 v[104:105], v[204:205], v[214:215] op_sel_hi:[1,0]
  v_pk_mul_f32 v[106:107], v[206:207], v[214:215] op_sel_hi:[1,0]
  v_pk_mul_f32 v[108:109], v[208:209], v[214:215] op_sel_hi:[1,0]
  v_pk_mul_f32 v[110:111], v[210:211], v[214:215] op_sel_hi:[1,0]
  v_pk_fma_f32 v[144:145], v[144:145], v[212:213], v[96:97] op_sel_hi:[1,0,1]
  v_pk_fma_f32 v[146:147], v[146:147], v[212:213], v[98:99] op_sel_hi:[1,0,1]
  v_pk_fma_f32 v[148:149], v[148:149], v[212:213], v[100:101] op_sel_hi:[1,0,1]
  v_pk_fma_f32 v[150:151], v[150:151], v[212:213], v[102:103] op_sel_hi:[1,0,1]
  v_pk_fma_f32 v[152:153], v[152:153], v[212:213], v[104:105] op_sel_hi:[1,0,1]
  v_pk_fma_f32 v[154:155], v[154:155], v[212:213], v[106:107] op_sel_hi:[1,0,1]
  v_pk_fma_f32 v[156:157], v[156:157], v[212:213], v[108:109] op_sel_hi:[1,0,1]
  v_pk_fma_f32 v[158:159], v[158:159], v[212:213], v[110:111] op_sel_hi:[1,0,1]
  v_cvt_pk_bf16_f32 v96, v144, v145
  v_cvt_pk_bf16_f32 v97, v146, v147
  v_cvt_pk_bf16_f32 v98, v148, v149
  v_cvt_pk_bf16_f32 v99, v150, v151
  v_cvt_pk_bf16_f32 v100, v152, v153
  v_cvt_pk_bf16_f32 v101, v154, v155
  v_cvt_pk_bf16_f32 v102, v156, v157
  v_cvt_pk_bf16_f32 v103, v158, v159
  ds_write_b64 v216, v[96:97]
  ds_write_b64 v216, v[98:99] offset:16
  buffer_store_dwordx4 v[100:103], v2, s[4:7], s40 offen sc1
  s_waitcnt lgkmcnt(0)
  ds_read_b64_tr_b16 v[104:105], v219
  ds_read_b64_tr_b16 v[106:107], v219 offset:256
  s_waitcnt lgkmcnt(0)
  buffer_store_dwordx4 v[104:107], v220, s[4:7], s41 offen sc1
G4Q2_104:
  ds_read_b128 v[112:115], v254 offset:0
  ds_read_b128 v[116:119], v255 offset:0
  ds_read_b128 v[120:123], v254 offset:1024
  ds_read_b128 v[124:127], v255 offset:1024
  ds_read_b128 v[128:131], v254 offset:2048
  ds_read_b128 v[132:135], v255 offset:2048
  ds_read_b128 v[136:139], v254 offset:3072
  ds_read_b128 v[140:143], v255 offset:3072
  s_waitcnt lgkmcnt(6)
  v_mfma_f32_32x32x16_bf16 v[80:95], v[112:115], v[16:19], 0
  v_mfma_f32_32x32x16_bf16 v[96:111], v[116:119], v[16:19], 0
  ds_read_b128 v[112:115], v254 offset:4096
  ds_read_b128 v[116:119], v255 offset:4096
  s_waitcnt lgkmcnt(6)
  v_mfma_f32_32x32x16_bf16 v[80:95], v[120:123], v[20:23], v[80:95]
  v_mfma_f32_32x32x16_bf16 v[96:111], v[124:127], v[20:23], v[96:111]
  ds_read_b128 v[120:123], v254 offset:5120
  ds_read_b128 v[124:127], v255 offset:5120
  s_waitcnt lgkmcnt(6)
  v_mfma_f32_32x32x16_bf16 v[80:95], v[128:131], v[24:27], v[80:95]
  v_mfma_f32_32x32x16_bf16 v[96:111], v[132:135], v[24:27], v[96:111]
  ds_read_b128 v[128:131], v254 offset:6144
  ds_read_b128 v[132:135], v255 offset:6144
  s_waitcnt lgkmcnt(6)
  v_mfma_f32_32x32x16_bf16 v[80:95], v[136:139], v[28:31], v[80:95]
  v_mfma_f32_32x32x16_bf16 v[96:111], v[140:143], v[28:31], v[96:111]
  ds_read_b128 v[136:139], v254 offset:7168
  ds_read_b128 v[140:143], v255 offset:7168
  s_waitcnt lgkmcnt(6)
  v_mfma_f32_32x32x16_bf16 v[80:95], v[112:115], v[32:35], v[80:95]
  v_mfma_f32_32x32x16_bf16 v[96:111], v[116:119], v[32:35], v[96:111]
  ds_read_b128 v[112:115], v254 offset:8192
  ds_read_b128 v[116:119], v255 offset:8192
  s_waitcnt lgkmcnt(6)
  v_mfma_f32_32x32x16_bf16 v[80:95], v[120:123], v[36:39], v[80:95]
  v_mfma_f32_32x32x16_bf16 v[96:111], v[124:127], v[36:39], v[96:111]
  ds_read_b128 v[120:123], v254 offset:9216
  ds_read_b128 v[124:127], v255 offset:9216
  s_waitcnt lgkmcnt(6)
  v_mfma_f32_32x32x16_bf16 v[80:95], v[128:131], v[40:43], v[80:95]
  v_mfma_f32_32x32x16_bf16 v[96:111], v[132:135], v[40:43], v[96:111]
  ds_read_b128 v[128:131], v254 offset:10240
  ds_read_b128 v[132:135], v255 offset:10240
  s_waitcnt lgkmcnt(6)
  v_mfma_f32_32x32x16_bf16 v[80:95], v[136:139], v[44:47], v[80:95]
  v_mfma_f32_32x32x16_bf16 v[96:111], v[140:143], v[44:47], v[96:111]
  s_cmp_lg_u32 s20, 0
  s_cbranch_scc1 G4KF_106
  s_lshl_b32 s44, s22, 11
  s_lshl_b32 s45, s26, 2
  s_add_u32 s44, s44, s45
  s_add_u32 s44, s44, 106496
  v_lshlrev_b32 v220, 8, v1
  v_mov_b32 v221, s21
  s_waitcnt vmcnt(0)
  s_mov_b64 exec, 0xff
  buffer_store_dword v221, v220, s[4:7], s44 offen sc1
  s_mov_b64 exec, -1
G4KF_106:
  ds_read_b128 v[136:139], v254 offset:11264
  ds_read_b128 v[140:143], v255 offset:11264
  s_waitcnt lgkmcnt(6)
  v_mfma_f32_32x32x16_bf16 v[80:95], v[112:115], v[48:51], v[80:95]
  v_mfma_f32_32x32x16_bf16 v[96:111], v[116:119], v[48:51], v[96:111]
  ds_read_b128 v[112:115], v254 offset:12288
  ds_read_b128 v[116:119], v255 offset:12288
  s_waitcnt lgkmcnt(6)
  v_mfma_f32_32x32x16_bf16 v[80:95], v[120:123], v[52:55], v[80:95]
  v_mfma_f32_32x32x16_bf16 v[96:111], v[124:127], v[52:55], v[96:111]
  ds_read_b128 v[120:123], v254 offset:13312
  ds_read_b128 v[124:127], v255 offset:13312
  s_waitcnt lgkmcnt(6)
  v_mfma_f32_32x32x16_bf16 v[80:95], v[128:131], v[56:59], v[80:95]
  v_mfma_f32_32x32x16_bf16 v[96:111], v[132:135], v[56:59], v[96:111]
  ds_read_b128 v[128:131], v254 offset:14336
  ds_read_b128 v[132:135], v255 offset:14336
  s_waitcnt lgkmcnt(6)
  v_mfma_f32_32x32x16_bf16 v[80:95], v[136:139], v[60:63], v[80:95]
  v_mfma_f32_32x32x16_bf16 v[96:111], v[140:143], v[60:63], v[96:111]
  ds_read_b128 v[136:139], v254 offset:15360
  ds_read_b128 v[140:143], v255 offset:15360
  s_waitcnt lgkmcnt(6)
  v_mfma_f32_32x32x16_bf16 v[80:95], v[112:115], v[64:67], v[80:95]
  v_mfma_f32_32x32x16_bf16 v[96:111], v[116:119], v[64:67], v[96:111]
  s_waitcnt lgkmcnt(4)
  v_mfma_f32_32x32x16_bf16 v[80:95], v[120:123], v[68:71], v[80:95]
  v_mfma_f32_32x32x16_bf16 v[96:111], v[124:127], v[68:71], v[96:111]
  s_waitcnt lgkmcnt(2)
  v_mfma_f32_32x32x16_bf16 v[80:95], v[128:131], v[72:75], v[80:95]
  v_mfma_f32_32x32x16_bf16 v[96:111], v[132:135], v[72:75], v[96:111]
  s_waitcnt lgkmcnt(0)
  v_mfma_f32_32x32x16_bf16 v[80:95], v[136:139], v[76:79], v[80:95]
  v_mfma_f32_32x32x16_bf16 v[96:111], v[140:143], v[76:79], v[96:111]
G4RED_105:
  s_lshl_b32 s40, s18, 12
  s_add_u32 s40, s40, 131072
  v_add_u32 v14, s40, v2
  s_xor_b32 s40, s40, 8192
  v_add_u32 v15, s40, v2
  s_nop 6
  ds_write_b128 v14, v[96:99] offset:0
  ds_write_b128 v14, v[100:103] offset:1024
  ds_write_b128 v14, v[104:107] offset:2048
  ds_write_b128 v14, v[108:111] offset:3072
  s_waitcnt lgkmcnt(0)
  s_barrier
  ds_read_b128 v[96:99], v15 offset:0
  ds_read_b128 v[100:103], v15 offset:1024
  ds_read_b128 v[104:107], v15 offset:2048
  ds_read_b128 v[108:111], v15 offset:3072
  s_waitcnt lgkmcnt(3)
  v_pk_add_f32 v[80:81], v[80:81], v[96:97]
  v_pk_add_f32 v[82:83], v[82:83], v[98:99]
  s_waitcnt lgkmcnt(2)
  v_pk_add_f32 v[84:85], v[84:85], v[100:101]
  v_pk_add_f32 v[86:87], v[86:87], v[102:103]
  s_waitcnt lgkmcnt(1)
  v_pk_add_f32 v[88:89], v[88:89], v[104:105]
  v_pk_add_f32 v[90:91], v[90:91], v[106:107]
  s_waitcnt lgkmcnt(0)
  v_pk_add_f32 v[92:93], v[92:93], v[108:109]
  v_pk_add_f32 v[94:95], v[94:95], v[110:111]
  v_mul_f32 v214, 0x3eb8aa3b, v179
  v_mul_f32 v216, v178, v214
  v_sub_f32 v216, 0, v216
  s_lshl_b32 s40, s20, 2
  s_add_u32 s40, s40, s19
  s_lshl_b32 s40, s40, 10
  v_add_u32 v14, s40, v2
  v_pk_mul_f32 v[96:97], v[180:181], v[216:217] op_sel_hi:[1,0]
  v_pk_mul_f32 v[98:99], v[182:183], v[216:217] op_sel_hi:[1,0]
  v_pk_mul_f32 v[100:101], v[184:185], v[216:217] op_sel_hi:[1,0]
  v_pk_mul_f32 v[102:103], v[186:187], v[216:217] op_sel_hi:[1,0]
  v_pk_mul_f32 v[104:105], v[188:189], v[216:217] op_sel_hi:[1,0]
  v_pk_mul_f32 v[106:107], v[190:191], v[216:217] op_sel_hi:[1,0]
  v_pk_mul_f32 v[108:109], v[192:193], v[216:217] op_sel_hi:[1,0]
  v_pk_mul_f32 v[110:111], v[194:195], v[216:217] op_sel_hi:[1,0]
  v_pk_fma_f32 v[80:81], v[80:81], v[214:215], v[96:97] op_sel_hi:[1,0,1]
  v_pk_fma_f32 v[82:83], v[82:83], v[214:215], v[98:99] op_sel_hi:[1,0,1]
  v_pk_fma_f32 v[84:85], v[84:85], v[214:215], v[100:101] op_sel_hi:[1,0,1]
  v_pk_fma_f32 v[86:87], v[86:87], v[214:215], v[102:103] op_sel_hi:[1,0,1]
  v_pk_fma_f32 v[88:89], v[88:89], v[214:215], v[104:105] op_sel_hi:[1,0,1]
  v_pk_fma_f32 v[90:91], v[90:91], v[214:215], v[106:107] op_sel_hi:[1,0,1]
  v_pk_fma_f32 v[92:93], v[92:93], v[214:215], v[108:109] op_sel_hi:[1,0,1]
  v_pk_fma_f32 v[94:95], v[94:95], v[214:215], v[110:111] op_sel_hi:[1,0,1]
  v_cvt_pk_bf16_f32 v96, v80, v81
  v_cvt_pk_bf16_f32 v97, v82, v83
  v_cvt_pk_bf16_f32 v98, v84, v85
  v_cvt_pk_bf16_f32 v99, v86, v87
  v_cvt_pk_bf16_f32 v100, v88, v89
  v_cvt_pk_bf16_f32 v101, v90, v91
  v_cvt_pk_bf16_f32 v102, v92, v93
  v_cvt_pk_bf16_f32 v103, v94, v95
  ds_write_b128 v14, v[96:99] offset:0
  ds_write_b128 v14, v[100:103] offset:2048
  s_branch L_ATT
L_FALLBACK:
  s_mov_b32 s101, 1
  s_waitcnt vmcnt(0) lgkmcnt(0)
  v_and_b32 v187, 31, v1
  v_min_u32 v186, 16, v187
  v_lshlrev_b32 v186, 4, v186
  v_lshrrev_b32 v188, 5, v1
  v_mul_u32_u24 v188, 272, v188
  v_add_u32 v186, v186, v188
  v_and_b32 v188, 27, v187
  v_cmp_eq_u32 vcc, 16, v188
  v_cmp_gt_u32 s[48:49], 16, v187
  s_nop 1
  s_or_b64 vcc, vcc, s[48:49]
  v_mov_b32 v188, 268435456
  v_cndmask_b32 v186, v188, v186, vcc
  v_and_b32 v187, 31, v1
  v_lshlrev_b32 v187, 2, v187
  s_mov_b32 s88, 0
FBI_107:
  s_lshl_b32 s93, s18, 1
  s_add_u32 s93, s93, 2
  s_add_u32 s93, s93, s88
  s_and_b32 s93, s93, 7
  s_lshl_b32 s40, s93, 10
  v_add_u32 v185, s40, v2
  ds_read_b128 v[140:143], v185 offset:0
  v_mov_b32 v184, 0xff800000
  s_lshl_b32 s90, s18, 14
  s_add_u32 s90, s90, s37
  s_mul_i32 s92, s18, 17408
  s_add_u32 s92, s92, s37
  s_add_u32 s92, s92, 0x10000
  s_mov_b32 s89, 0
FBT_108:
  buffer_load_dwordx4 v[128:131], v2, s[4:7], s90 offen sc1
  s_waitcnt vmcnt(0) lgkmcnt(0)
  v_mfma_f32_32x32x16_bf16 v[144:159], v[128:131], v[140:143], 0
  s_nop 11
  v_max3_f32 v184, v184, v144, v145
  v_max3_f32 v184, v184, v146, v147
  v_max3_f32 v184, v184, v148, v149
  v_max3_f32 v184, v184, v150, v151
  v_max3_f32 v184, v184, v152, v153
  v_max3_f32 v184, v184, v154, v155
  v_max3_f32 v184, v184, v156, v157
  v_max3_f32 v184, v184, v158, v159
  s_add_u32 s90, s90, 1024
  s_add_u32 s92, s92, 1088
  s_add_u32 s89, s89, 1
  s_cmp_lt_u32 s89, 16
  s_cbranch_scc1 FBT_108
  v_mov_b32 v189, v184
  s_nop 1
  v_permlane32_swap_b32 v184, v189
  v_max_f32 v184, v184, v189
  s_lshl_b32 s40, s93, 9
  s_lshl_b32 s41, s18, 7
  s_add_u32 s40, s40, s41
  s_add_u32 s40, s40, 131072
  v_add_u32 v185, s40, v187
  ds_write_b32 v185, v184
  s_waitcnt lgkmcnt(0)
  s_add_u32 s88, s88, 1
  s_cmp_lt_u32 s88, 8
  s_cbranch_scc1 FBI_107
  s_barrier
  s_mov_b32 s88, 0
FBI_109:
  s_lshl_b32 s93, s18, 1
  s_add_u32 s93, s93, 2
  s_add_u32 s93, s93, s88
  s_and_b32 s93, s93, 7
  s_lshl_b32 s40, s93, 10
  v_add_u32 v185, s40, v2
  ds_read_b128 v[140:143], v185 offset:0
  s_lshl_b32 s40, s93, 9
  s_add_u32 s40, s40, 131072
  v_add_u32 v185, s40, v187
  ds_read_b32 v184, v185
  ds_read_b32 v189, v185 offset:128
  ds_read_b32 v190, v185 offset:256
  ds_read_b32 v191, v185 offset:384
  s_waitcnt lgkmcnt(0)
  v_max_f32 v184, v184, v189
  v_max_f32 v190, v190, v191
  v_max_f32 v184, v184, v190
  v_sub_f32 v168, 0, v184
  v_mov_b32 v192, 0
  v_sub_f32 v169, 0, v184
  v_mov_b32 v193, 0
  v_sub_f32 v170, 0, v184
  v_mov_b32 v194, 0
  v_sub_f32 v171, 0, v184
  v_mov_b32 v195, 0
  v_sub_f32 v172, 0, v184
  v_mov_b32 v196, 0
  v_sub_f32 v173, 0, v184
  v_mov_b32 v197, 0
  v_sub_f32 v174, 0, v184
  v_mov_b32 v198, 0
  v_sub_f32 v175, 0, v184
  v_mov_b32 v199, 0
  v_sub_f32 v176, 0, v184
  v_mov_b32 v200, 0
  v_sub_f32 v177, 0, v184
  v_mov_b32 v201, 0
  v_sub_f32 v178, 0, v184
  v_mov_b32 v202, 0
  v_sub_f32 v179, 0, v184
  v_mov_b32 v203, 0
  v_sub_f32 v180, 0, v184
  v_mov_b32 v204, 0
  v_sub_f32 v181, 0, v184
  v_mov_b32 v205, 0
  v_sub_f32 v182, 0, v184
  v_mov_b32 v206, 0
  v_sub_f32 v183, 0, v184
  v_mov_b32 v207, 0
  s_lshl_b32 s90, s18, 14
  s_add_u32 s90, s90, s37
  s_mul_i32 s92, s18, 17408
  s_add_u32 s92, s92, s37
  s_add_u32 s92, s92, 0x10000
  s_mov_b32 s89, 0
FBT_110:
  buffer_load_dwordx4 v[128:131], v2, s[4:7], s90 offen sc1
  buffer_load_dwordx4 v[132:135], v186, s[4:7], s92 offen sc1
  buffer_load_dwordx4 v[136:139], v186, s[4:7], s92 offen offset:544 sc1
  s_waitcnt vmcnt(0) lgkmcnt(0)
  v_mfma_f32_32x32x16_bf16 v[144:159], v[128:131], v[140:143], v[168:183]
  s_nop 11
  v_exp_f32 v144, v144
  v_exp_f32 v145, v145
  v_exp_f32 v146, v146
  v_exp_f32 v147, v147
  v_exp_f32 v148, v148
  v_exp_f32 v149, v149
  v_exp_f32 v150, v150
  v_exp_f32 v151, v151
  v_exp_f32 v152, v152
  v_exp_f32 v153, v153
  v_exp_f32 v154, v154
  v_exp_f32 v155, v155
  v_exp_f32 v156, v156
  v_exp_f32 v157, v157
  v_exp_f32 v158, v158
  v_exp_f32 v159, v159
  v_cvt_pk_bf16_f32 v160, v144, v145
  v_cvt_pk_bf16_f32 v161, v146, v147
  v_cvt_pk_bf16_f32 v162, v148, v149
  v_cvt_pk_bf16_f32 v163, v150, v151
  v_cvt_pk_bf16_f32 v164, v152, v153
  v_cvt_pk_bf16_f32 v165, v154, v155
  v_cvt_pk_bf16_f32 v166, v156, v157
  v_cvt_pk_bf16_f32 v167, v158, v159
  v_mfma_f32_32x32x16_bf16 v[192:207], v[132:135], v[160:163], v[192:207]
  s_nop 0
  v_mfma_f32_32x32x16_bf16 v[192:207], v[136:139], v[164:167], v[192:207]
  s_add_u32 s90, s90, 1024
  s_add_u32 s92, s92, 1088
  s_add_u32 s89, s89, 1
  s_cmp_lt_u32 s89, 16
  s_cbranch_scc1 FBT_110
  s_cmp_eq_u32 s88, 6
  s_cbranch_scc1 FB6_111
  s_cmp_eq_u32 s88, 7
  s_cbranch_scc1 FB7_112
  s_mul_i32 s40, s18, 6
  s_add_u32 s40, s40, s88
  s_mul_i32 s40, s40, 2304
  s_add_u32 s40, s40, 8192
  v_add_u32 v185, s40, v2
  s_add_u32 s40, s40, 2048
  v_add_u32 v188, s40, v3
  ds_write_b128 v185, v[192:195]
  ds_write_b128 v185, v[196:199] offset:1024
  ds_write_b32 v188, v200
  s_waitcnt lgkmcnt(0)
  s_branch FBN_113
FB6_111:
  s_nop 4
  v_mov_b32 v80, v192
  v_mov_b32 v81, v193
  v_mov_b32 v82, v194
  v_mov_b32 v83, v195
  v_mov_b32 v84, v196
  v_mov_b32 v85, v197
  v_mov_b32 v86, v198
  v_mov_b32 v87, v199
  v_mov_b32 v88, v200
  s_branch FBN_113
FB7_112:
  s_nop 2
  v_mov_b32 v96, v192
  v_mov_b32 v97, v193
  v_mov_b32 v98, v194
  v_mov_b32 v99, v195
  v_mov_b32 v100, v196
  v_mov_b32 v101, v197
  v_mov_b32 v102, v198
  v_mov_b32 v103, v199
  v_mov_b32 v104, v200
FBN_113:
  s_add_u32 s88, s88, 1
  s_cmp_lt_u32 s88, 8
  s_cbranch_scc1 FBI_109
  s_waitcnt vmcnt(0) lgkmcnt(0)
  s_branch L_ATT_TAIL
L_END:
  s_endpgm
L_CODE_END:
.section .rodata,"a"
.p2align 6
.amdhsa_kernel interleave_layers__grouped_kv_mqa__sliding_local_dilated__prompt_kernel
  .amdhsa_next_free_vgpr 512
  .amdhsa_next_free_sgpr 102
  .amdhsa_accum_offset 256
  .amdhsa_group_segment_fixed_size 0
  .amdhsa_kernarg_size 88
  .amdhsa_user_sgpr_count 2
  .amdhsa_user_sgpr_kernarg_segment_ptr 1
  .amdhsa_system_sgpr_workgroup_id_x 1
.end_amdhsa_kernel
```
